```python
import torch

def _softmax(x, axis=-1):
    return torch.softmax(x, dim=axis)
def _gelu(x):
    return torch.nn.functional.gelu(x, approximate="tanh")
def _silu(x):
    return torch.nn.functional.silu(x)
def _sigmoid(x):
    return torch.sigmoid(x)
def _layernorm(x, axis=-1, eps=1e-5):
    m = x.mean(dim=axis, keepdim=True)
    v = x.var(dim=axis, keepdim=True, unbiased=False)
    return (x - m) / torch.sqrt(v + eps)
def _scatter_add(tgt, idx, src, axis=0):
    return tgt.clone().index_add_(axis, idx, src)
def _segment_sum(src, seg, n):
    out = torch.zeros((n,) + src.shape[1:], dtype=src.dtype)
    return out.index_add_(0, seg, src)
def _pad(x, pw):
    flat = tuple(v for pair in reversed(pw) for v in pair)
    return torch.nn.functional.pad(x, flat)

kernel_name = 'standalone__mha_softmax__near_ridge'

def setup_inputs():

    _w = (lambda a: (lambda t: t.to(torch.bfloat16) if t.is_floating_point() else t)(torch.as_tensor(a)))
    B, H, Sq, Sk, D = 16, 16, 512, 512, 256
    return {
        "q": _w((lambda *s: torch.randn(*s, dtype=torch.bfloat16) * 0.8)(B, H, Sq, D)),
        "k": _w((lambda *s: torch.randn(*s, dtype=torch.bfloat16) * 0.8)(B, H, Sk, D)),
        "v": _w((lambda *s: torch.randn(*s, dtype=torch.bfloat16) * 0.05)(B, H, Sk, D)),
    }

def reference(q, k, v):
    scale = q.shape[-1] ** -0.5
    scores = torch.einsum("bhqd,bhkd->bhqk", q, k) * scale
    p = _softmax(scores, axis=-1)
    return torch.einsum("bhqk,bhkd->bhqd", p, v)
```

```asm
; @launch grid=(256,1,1) block=(256,1,1) lds=163840
.amdgcn_target "amdgcn-amd-amdhsa--gfx950"
.text
.globl standalone__mha_softmax__near_ridge_kernel
.p2align 8
.type standalone__mha_softmax__near_ridge_kernel,@function
standalone__mha_softmax__near_ridge_kernel:
 s_cmp_ge_u32 s2, 256
 s_cbranch_scc1 L_done
 s_load_dwordx4 s[4:7], s[0:1], 0
 s_load_dwordx4 s[8:11], s[0:1], 16
 s_getpc_b64 s[44:45]
L_pc:
 s_sub_u32 s44, s44, L_pc-standalone__mha_softmax__near_ridge_kernel
 s_subb_u32 s45, s45, 0
 s_bfe_u32 s46, s2, 262147
 s_min_u32 s46, s46, 11
 s_lshl_b32 s46, s46, 12
 v_lshlrev_b32 v252, 4, v0
 v_add_u32 v252, s46, v252
 global_load_dwordx4 v[124:127], v252, s[44:45]
 v_lshrrev_b32 v20, 6, v0
 v_and_b32 v3, 63, v0
 v_readfirstlane_b32 s28, v20
 v_lshrrev_b32 v23, 5, v3
 v_lshlrev_b32 v2, 13, v23
 v_and_b32 v23, 31, v3
 v_lshlrev_b32 v23, 4, v23
 v_add_u32 v2, v2, v23
 v_lshlrev_b32 v23, 11, v20
 v_add_u32 v2, v2, v23
 v_lshrrev_b32 v23, 3, v3
 v_lshlrev_b32 v4, 9, v23
 v_and_b32 v23, 7, v3
 v_lshrrev_b32 v22, 4, v3
 v_xor_b32 v23, v23, v22
 v_lshlrev_b32 v23, 4, v23
 v_add_u32 v4, v4, v23
 v_xor_b32 v5, 64, v4
 s_mul_i32 s31, s28, 4224
 s_lshl_b32 s32, s28, 12
 s_lshr_b32 s44, s2, 4
 s_lshl_b32 s44, s44, 3
 s_and_b32 s45, s2, 7
 s_add_u32 s44, s44, s45
 s_bfe_u32 s46, s2, 65539
 s_lshl_b32 s34, s44, 18
 s_lshl_b32 s46, s46, 17
 s_lshl_b32 s47, s28, 15
 s_add_u32 s46, s46, s47
 s_add_u32 s36, s34, s46
 s_waitcnt lgkmcnt(0)
 s_mov_b32 s16, s6
 s_and_b32 s17, s7, 65535
 s_mov_b32 s18, 67108864
 s_mov_b32 s19, 131072
 s_mov_b32 s12, s4
 s_and_b32 s13, s5, 65535
 s_mov_b32 s14, 67108864
 s_mov_b32 s15, 131072
 s_add_u32 s38, s34, 0
 s_add_u32 m0, s31, 0
 s_nop 0
 buffer_load_dwordx4 v2, s[16:19], s38 offen nt lds
 s_add_u32 m0, s31, 544
 s_nop 0
 buffer_load_dwordx4 v2, s[16:19], s38 offen offset:512 nt lds
 s_add_u32 m0, s31, 1088
 s_nop 0
 buffer_load_dwordx4 v2, s[16:19], s38 offen offset:1024 nt lds
 s_add_u32 m0, s31, 1632
 s_nop 0
 buffer_load_dwordx4 v2, s[16:19], s38 offen offset:1536 nt lds
 s_mov_b32 s44, s36
 s_mov_b32 s47, 16384
 s_mov_b32 s48, 262144
L_q:
 s_bfe_u32 s46, 0x87654231, s48
 s_sub_u32 s45, s46, 7
 s_max_i32 s45, s45, 0
 s_lshl_b32 s45, s45, 9
 s_mul_i32 s46, s46, 16896
 s_sub_u32 s46, s46, s45
 s_add_u32 s46, s46, s32
 s_add_u32 m0, s46, 0
 s_add_u32 s45, s44, 0
 buffer_load_dwordx4 v4, s[12:15], s45 offen nt lds
 s_add_u32 m0, s46, 1024
 s_add_u32 s45, s44, 4096
 buffer_load_dwordx4 v5, s[12:15], s45 offen nt lds
 s_add_u32 m0, s46, 2048
 s_add_u32 s45, s44, 8192
 buffer_load_dwordx4 v4, s[12:15], s45 offen nt lds
 s_add_u32 m0, s46, 3072
 s_add_u32 s45, s44, 12288
 buffer_load_dwordx4 v5, s[12:15], s45 offen nt lds
 s_add_u32 s44, s44, s47
 s_xor_b32 s47, s47, 4294934656
 s_add_u32 s48, s48, 4
 s_cmp_lt_u32 s48, 262176
 s_cbranch_scc1 L_q
 v_and_b32 v21, 15, v3
 v_mul_u32_u24 v25, 1056, v21
 v_lshlrev_b32 v23, 4, v22
 v_add_u32 v0, v25, v23
 v_lshlrev_b32 v23, 2, v22
 v_bfe_u32 v24, v3, 2, 2
 v_add_u32 v23, v23, v24
 v_mul_u32_u24 v25, 1056, v23
 v_and_b32 v23, 3, v3
 v_lshlrev_b32 v23, 3, v23
 v_add_u32 v25, v25, v23
 v_add_u32 v1, 50688, v25
 v_bfe_u32 v23, v3, 1, 3
 v_xor_b32 v23, v23, v22
 v_lshlrev_b32 v23, 4, v23
 v_lshlrev_b32 v24, 7, v21
 v_add_u32 v23, v23, v24
 v_lshlrev_b32 v24, 12, v20
 v_add_u32 v18, v23, v24
 v_xor_b32 v19, 64, v18
 s_mov_b32 s29, 1035512379
 s_mov_b32 s30, 0x43800000
 s_lshl_b32 s33, s28, 11
 s_add_u32 s35, s34, 33554432
 s_mov_b32 s37, s36
 s_mov_b32 s92, 0
 s_mov_b32 s20, s8
 s_and_b32 s21, s9, 65535
 s_mov_b32 s22, 67108864
 s_mov_b32 s23, 131072
 s_mov_b32 s24, s10
 s_and_b32 s25, s11, 65535
 s_mov_b32 s26, 67108864
 s_mov_b32 s27, 131072
 s_mov_b32 s80, s6
 s_and_b32 s81, s7, 65535
 s_mov_b32 s82, 67108864
 s_mov_b32 s83, 131072
 s_mov_b32 s84, s8
 s_and_b32 s85, s9, 65535
 s_mov_b32 s86, 67108864
 s_mov_b32 s87, 131072
 s_add_u32 s36, s36, 33554432
 s_mov_b32 s7, s36
 s_add_u32 s8, s32, 118272
 s_mov_b32 s45, s37
 s_add_u32 s44, s33, 4294934528
 s_mov_b32 s9, 0
 s_waitcnt vmcnt(24)
 s_barrier
 ds_read_b128 v[28:31], v0
 ds_read_b128 v[32:35], v0 offset:64
 ds_read_b128 v[36:39], v0 offset:512
 v_add_u32 v26, 16896, v18
 v_add_u32 v27, 16896, v19
 ds_read_b128 a[0:3], v26
 ds_read_b128 a[4:7], v27
 ds_read_b128 a[32:35], v26 offset:2048
 ds_read_b128 a[36:39], v27 offset:2048
 v_add_u32 v26, 50688, v18
 v_add_u32 v27, 50688, v19
 ds_read_b128 a[64:67], v26
 ds_read_b128 a[68:71], v27
 ds_read_b128 a[96:99], v26 offset:2048
 ds_read_b128 a[100:103], v27 offset:2048
 s_waitcnt lgkmcnt(7)
 v_mfma_f32_16x16x32_bf16 v[60:63], v[28:31], a[0:3], 0
 s_waitcnt lgkmcnt(6)
 v_mfma_f32_16x16x32_bf16 v[60:63], v[32:35], a[4:7], v[60:63]
 s_waitcnt lgkmcnt(5)
 v_mfma_f32_16x16x32_bf16 v[68:71], v[28:31], a[32:35], 0
 s_waitcnt lgkmcnt(4)
 v_mfma_f32_16x16x32_bf16 v[68:71], v[32:35], a[36:39], v[68:71]
 ds_read_b128 v[40:43], v0 offset:576
 s_waitcnt lgkmcnt(4)
 v_mfma_f32_16x16x32_bf16 v[76:79], v[28:31], a[64:67], 0
 s_waitcnt lgkmcnt(3)
 v_mfma_f32_16x16x32_bf16 v[76:79], v[32:35], a[68:71], v[76:79]
 s_waitcnt lgkmcnt(2)
 v_mfma_f32_16x16x32_bf16 v[84:87], v[28:31], a[96:99], 0
 s_waitcnt lgkmcnt(1)
 v_mfma_f32_16x16x32_bf16 v[84:87], v[32:35], a[100:103], v[84:87]
 ds_read_b128 v[28:31], v0 offset:128
 v_mfma_f32_16x16x32_bf16 v[64:67], v[36:39], a[0:3], 0
 s_waitcnt lgkmcnt(1)
 v_mfma_f32_16x16x32_bf16 v[64:67], v[40:43], a[4:7], v[64:67]
 v_mfma_f32_16x16x32_bf16 v[72:75], v[36:39], a[32:35], 0
 v_mfma_f32_16x16x32_bf16 v[72:75], v[40:43], a[36:39], v[72:75]
 ds_read_b128 v[32:35], v0 offset:192
 v_mfma_f32_16x16x32_bf16 v[80:83], v[36:39], a[64:67], 0
 v_mfma_f32_16x16x32_bf16 v[80:83], v[40:43], a[68:71], v[80:83]
 v_mfma_f32_16x16x32_bf16 v[88:91], v[36:39], a[96:99], 0
 v_mfma_f32_16x16x32_bf16 v[88:91], v[40:43], a[100:103], v[88:91]
 s_waitcnt lgkmcnt(1)
 ds_read_b128 v[36:39], v0 offset:640
 s_waitcnt vmcnt(16)
 v_add_u32 v26, 33792, v18
 v_add_u32 v27, 33792, v19
 ds_read_b128 a[8:11], v26
 ds_read_b128 a[12:15], v27
 ds_read_b128 a[40:43], v26 offset:2048
 ds_read_b128 a[44:47], v27 offset:2048
 v_add_u32 v26, 67584, v18
 v_add_u32 v27, 67584, v19
 ds_read_b128 a[72:75], v26
 ds_read_b128 a[76:79], v27
 ds_read_b128 a[104:107], v26 offset:2048
 ds_read_b128 a[108:111], v27 offset:2048
 s_waitcnt lgkmcnt(7)
 v_mfma_f32_16x16x32_bf16 v[60:63], v[28:31], a[8:11], v[60:63]
 s_waitcnt lgkmcnt(6)
 v_mfma_f32_16x16x32_bf16 v[60:63], v[32:35], a[12:15], v[60:63]
 s_waitcnt lgkmcnt(5)
 v_mfma_f32_16x16x32_bf16 v[68:71], v[28:31], a[40:43], v[68:71]
 s_waitcnt lgkmcnt(4)
 v_mfma_f32_16x16x32_bf16 v[68:71], v[32:35], a[44:47], v[68:71]
 ds_read_b128 v[40:43], v0 offset:704
 s_waitcnt lgkmcnt(4)
 v_mfma_f32_16x16x32_bf16 v[76:79], v[28:31], a[72:75], v[76:79]
 s_waitcnt lgkmcnt(0)
 s_barrier
 v_mfma_f32_16x16x32_bf16 v[76:79], v[32:35], a[76:79], v[76:79]
 s_add_u32 s38, s34, 16384
 s_add_u32 m0, s31, 16896
 v_mfma_f32_16x16x32_bf16 v[84:87], v[28:31], a[104:107], v[84:87]
 buffer_load_dwordx4 v2, s[16:19], s38 offen nt lds
 s_add_u32 m0, s31, 17440
 v_mfma_f32_16x16x32_bf16 v[84:87], v[32:35], a[108:111], v[84:87]
 buffer_load_dwordx4 v2, s[16:19], s38 offen offset:512 nt lds
 ds_read_b128 v[28:31], v0 offset:256
 s_add_u32 m0, s31, 17984
 v_mfma_f32_16x16x32_bf16 v[64:67], v[36:39], a[8:11], v[64:67]
 buffer_load_dwordx4 v2, s[16:19], s38 offen offset:1024 nt lds
 s_add_u32 m0, s31, 18528
 v_mfma_f32_16x16x32_bf16 v[64:67], v[40:43], a[12:15], v[64:67]
 buffer_load_dwordx4 v2, s[16:19], s38 offen offset:1536 nt lds
 s_add_u32 s39, s34, 0
 s_add_u32 m0, s31, 50688
 v_mfma_f32_16x16x32_bf16 v[72:75], v[36:39], a[40:43], v[72:75]
 buffer_load_dwordx4 v2, s[20:23], s39 offen nt lds
 s_add_u32 m0, s31, 51232
 v_mfma_f32_16x16x32_bf16 v[72:75], v[40:43], a[44:47], v[72:75]
 buffer_load_dwordx4 v2, s[20:23], s39 offen offset:512 nt lds
 ds_read_b128 v[32:35], v0 offset:320
 s_add_u32 m0, s31, 51776
 v_mfma_f32_16x16x32_bf16 v[80:83], v[36:39], a[72:75], v[80:83]
 buffer_load_dwordx4 v2, s[20:23], s39 offen offset:1024 nt lds
 s_add_u32 m0, s31, 52320
 v_mfma_f32_16x16x32_bf16 v[80:83], v[40:43], a[76:79], v[80:83]
 buffer_load_dwordx4 v2, s[20:23], s39 offen offset:1536 nt lds
 s_add_u32 s38, s34, 32768
 s_add_u32 m0, s31, 33792
 v_mfma_f32_16x16x32_bf16 v[88:91], v[36:39], a[104:107], v[88:91]
 buffer_load_dwordx4 v2, s[16:19], s38 offen nt lds
 s_add_u32 m0, s31, 34336
 v_mfma_f32_16x16x32_bf16 v[88:91], v[40:43], a[108:111], v[88:91]
 s_waitcnt lgkmcnt(1)
 buffer_load_dwordx4 v2, s[16:19], s38 offen offset:512 nt lds
 ds_read_b128 v[36:39], v0 offset:768
 s_add_u32 m0, s31, 34880
 s_waitcnt vmcnt(18)
 v_add_u32 v26, 84480, v18
 v_add_u32 v27, 84480, v19
 ds_read_b128 a[16:19], v26
 ds_read_b128 a[20:23], v27
 ds_read_b128 a[48:51], v26 offset:2048
 ds_read_b128 a[52:55], v27 offset:2048
 v_add_u32 v26, 101376, v18
 v_add_u32 v27, 101376, v19
 ds_read_b128 a[80:83], v26
 ds_read_b128 a[84:87], v27
 ds_read_b128 a[112:115], v26 offset:2048
 ds_read_b128 a[116:119], v27 offset:2048
 s_waitcnt lgkmcnt(7)
 v_mfma_f32_16x16x32_bf16 v[60:63], v[28:31], a[16:19], v[60:63]
 buffer_load_dwordx4 v2, s[16:19], s38 offen offset:1024 nt lds
 s_add_u32 m0, s31, 35424
 s_waitcnt lgkmcnt(6)
 v_mfma_f32_16x16x32_bf16 v[60:63], v[32:35], a[20:23], v[60:63]
 buffer_load_dwordx4 v2, s[16:19], s38 offen offset:1536 nt lds
 s_waitcnt lgkmcnt(5)
 v_mfma_f32_16x16x32_bf16 v[68:71], v[28:31], a[48:51], v[68:71]
 s_waitcnt lgkmcnt(4)
 v_mfma_f32_16x16x32_bf16 v[68:71], v[32:35], a[52:55], v[68:71]
 ds_read_b128 v[40:43], v0 offset:832
 s_waitcnt lgkmcnt(4)
 v_mfma_f32_16x16x32_bf16 v[76:79], v[28:31], a[80:83], v[76:79]
 s_waitcnt lgkmcnt(0)
 s_barrier
 v_mfma_f32_16x16x32_bf16 v[76:79], v[32:35], a[84:87], v[76:79]
 s_add_u32 s39, s34, 16384
 s_add_u32 m0, s31, 67584
 v_mfma_f32_16x16x32_bf16 v[84:87], v[28:31], a[112:115], v[84:87]
 buffer_load_dwordx4 v2, s[20:23], s39 offen nt lds
 s_add_u32 m0, s31, 68128
 v_mfma_f32_16x16x32_bf16 v[84:87], v[32:35], a[116:119], v[84:87]
 buffer_load_dwordx4 v2, s[20:23], s39 offen offset:512 nt lds
 ds_read_b128 v[28:31], v0 offset:384
 s_add_u32 m0, s31, 68672
 v_mfma_f32_16x16x32_bf16 v[64:67], v[36:39], a[16:19], v[64:67]
 buffer_load_dwordx4 v2, s[20:23], s39 offen offset:1024 nt lds
 s_add_u32 m0, s31, 69216
 v_mfma_f32_16x16x32_bf16 v[64:67], v[40:43], a[20:23], v[64:67]
 buffer_load_dwordx4 v2, s[20:23], s39 offen offset:1536 nt lds
 s_add_u32 s39, s34, 32768
 s_add_u32 m0, s31, 84480
 v_mfma_f32_16x16x32_bf16 v[72:75], v[36:39], a[48:51], v[72:75]
 buffer_load_dwordx4 v2, s[20:23], s39 offen nt lds
 s_add_u32 m0, s31, 85024
 v_mfma_f32_16x16x32_bf16 v[72:75], v[40:43], a[52:55], v[72:75]
 buffer_load_dwordx4 v2, s[20:23], s39 offen offset:512 nt lds
 ds_read_b128 v[32:35], v0 offset:448
 s_add_u32 m0, s31, 85568
 v_mfma_f32_16x16x32_bf16 v[80:83], v[36:39], a[80:83], v[80:83]
 buffer_load_dwordx4 v2, s[20:23], s39 offen offset:1024 nt lds
 s_add_u32 m0, s31, 86112
 v_mfma_f32_16x16x32_bf16 v[80:83], v[40:43], a[84:87], v[80:83]
 buffer_load_dwordx4 v2, s[20:23], s39 offen offset:1536 nt lds
 v_mfma_f32_16x16x32_bf16 v[88:91], v[36:39], a[112:115], v[88:91]
 v_mfma_f32_16x16x32_bf16 v[88:91], v[40:43], a[116:119], v[88:91]
 s_waitcnt lgkmcnt(1)
 ds_read_b128 v[36:39], v0 offset:896
 s_waitcnt vmcnt(20)
 v_add_u32 v26, 118272, v18
 v_add_u32 v27, 118272, v19
 ds_read_b128 a[24:27], v26
 ds_read_b128 a[28:31], v27
 ds_read_b128 a[56:59], v26 offset:2048
 ds_read_b128 a[60:63], v27 offset:2048
 v_add_u32 v26, 134656, v18
 v_add_u32 v27, 134656, v19
 ds_read_b128 a[88:91], v26
 ds_read_b128 a[92:95], v27
 ds_read_b128 a[120:123], v26 offset:2048
 ds_read_b128 a[124:127], v27 offset:2048
 s_waitcnt lgkmcnt(7)
 v_mfma_f32_16x16x32_bf16 v[60:63], v[28:31], a[24:27], v[60:63]
 s_waitcnt lgkmcnt(6)
 v_mfma_f32_16x16x32_bf16 v[60:63], v[32:35], a[28:31], v[60:63]
 s_waitcnt lgkmcnt(5)
 v_mfma_f32_16x16x32_bf16 v[68:71], v[28:31], a[56:59], v[68:71]
 s_waitcnt lgkmcnt(0)
 s_waitcnt vmcnt(16)
 s_barrier
 v_mfma_f32_16x16x32_bf16 v[68:71], v[32:35], a[60:63], v[68:71]
 ds_read_b128 v[40:43], v0 offset:960
 v_mfma_f32_16x16x32_bf16 v[76:79], v[28:31], a[88:91], v[76:79]
 v_add_u32 v0, 16896, v0
 v_mfma_f32_16x16x32_bf16 v[76:79], v[32:35], a[92:95], v[76:79]
 v_mfma_f32_16x16x32_bf16 v[84:87], v[28:31], a[120:123], v[84:87]
 v_mfma_f32_16x16x32_bf16 v[84:87], v[32:35], a[124:127], v[84:87]
 ds_read_b128 v[28:31], v0
 v_mfma_f32_16x16x32_bf16 v[64:67], v[36:39], a[24:27], v[64:67]
 s_waitcnt lgkmcnt(1)
 v_mfma_f32_16x16x32_bf16 v[64:67], v[40:43], a[28:31], v[64:67]
 v_mfma_f32_16x16x32_bf16 v[72:75], v[36:39], a[56:59], v[72:75]
 v_mfma_f32_16x16x32_bf16 v[72:75], v[40:43], a[60:63], v[72:75]
 ds_read_b128 v[32:35], v0 offset:64
 v_mfma_f32_16x16x32_bf16 v[80:83], v[36:39], a[88:91], v[80:83]
 v_mfma_f32_16x16x32_bf16 v[80:83], v[40:43], a[92:95], v[80:83]
 v_mfma_f32_16x16x32_bf16 v[88:91], v[36:39], a[120:123], v[88:91]
 v_mfma_f32_16x16x32_bf16 v[88:91], v[40:43], a[124:127], v[88:91]
 s_waitcnt lgkmcnt(1)
 ds_read_b128 v[36:39], v0 offset:512
 s_add_u32 s52, s34, 32768
 s_add_u32 s53, s34, 32768
 s_mov_b32 s4, 16896
 s_mov_b32 s5, 33792
 s_mov_b32 s6, 0
 s_mov_b32 s55, 16896
 s_mov_b32 s88, 0
 s_mov_b32 s91, 2
 s_mov_b32 s9, 1
 v_mfma_f32_16x16x32_bf16 v[92:95], v[28:31], a[0:3], 0
 s_waitcnt vmcnt(12)
 s_barrier
 s_waitcnt lgkmcnt(1)
 v_mfma_f32_16x16x32_bf16 v[92:95], v[32:35], a[4:7], v[92:95]
 s_add_u32 s52, s52, 16384
 s_add_u32 m0, s31, 0
 v_mfma_f32_16x16x32_bf16 v[100:103], v[28:31], a[32:35], 0
 buffer_load_dwordx4 v2, s[16:19], s52 offen nt lds
 v_mfma_f32_16x16x32_bf16 v[100:103], v[32:35], a[36:39], v[100:103]
 ds_read_b128 v[40:43], v0 offset:576
 v_max3_f32 v20, v60, v61, v62
 v_max3_f32 v21, v68, v69, v70
 v_max3_f32 v22, v76, v77, v78
 v_max3_f32 v23, v84, v85, v86
 v_mfma_f32_16x16x32_bf16 v[108:111], v[28:31], a[64:67], 0
 v_max3_f32 v20, v20, v63, v64
 v_max3_f32 v21, v21, v71, v72
 v_max3_f32 v22, v22, v79, v80
 v_mfma_f32_16x16x32_bf16 v[108:111], v[32:35], a[68:71], v[108:111]
 s_add_u32 m0, s31, 544
 v_max3_f32 v23, v23, v87, v88
 v_max3_f32 v20, v20, v65, v66
 v_max3_f32 v21, v21, v73, v74
 v_mfma_f32_16x16x32_bf16 v[116:119], v[28:31], a[96:99], 0
 buffer_load_dwordx4 v2, s[16:19], s52 offen offset:512 nt lds
 v_max3_f32 v22, v22, v81, v82
 v_max3_f32 v23, v23, v89, v90
 v_max_f32 v20, v20, v67
 v_mfma_f32_16x16x32_bf16 v[116:119], v[32:35], a[100:103], v[116:119]
 s_waitcnt lgkmcnt(1)
 ds_read_b128 v[28:31], v0 offset:128
 v_max_f32 v21, v21, v75
 v_max_f32 v22, v22, v83
 v_max_f32 v23, v23, v91
 v_mfma_f32_16x16x32_bf16 v[96:99], v[36:39], a[0:3], 0
 s_waitcnt lgkmcnt(1)
 v_mov_b32 v24, v20
 v_mov_b32 v25, v21
 v_mov_b32 v26, v22
 v_mfma_f32_16x16x32_bf16 v[96:99], v[40:43], a[4:7], v[96:99]
 s_add_u32 m0, s31, 1088
 v_mov_b32 v27, v23
 v_permlane16_swap_b32 v20, v24
 v_permlane16_swap_b32 v21, v25
 v_mfma_f32_16x16x32_bf16 v[104:107], v[36:39], a[32:35], 0
 buffer_load_dwordx4 v2, s[16:19], s52 offen offset:1024 nt lds
 v_permlane16_swap_b32 v22, v26
 v_permlane16_swap_b32 v23, v27
 v_max_f32 v20, v20, v24
 v_max_f32 v21, v21, v25
 v_mfma_f32_16x16x32_bf16 v[104:107], v[40:43], a[36:39], v[104:107]
 ds_read_b128 v[32:35], v0 offset:192
 v_max_f32 v22, v22, v26
 v_max_f32 v23, v23, v27
 v_mov_b32 v24, v20
 v_mfma_f32_16x16x32_bf16 v[112:115], v[36:39], a[64:67], 0
 v_mov_b32 v25, v21
 v_mov_b32 v26, v22
 v_mov_b32 v27, v23
 v_mfma_f32_16x16x32_bf16 v[112:115], v[40:43], a[68:71], v[112:115]
 s_add_u32 m0, s31, 1632
 v_permlane32_swap_b32 v20, v24
 v_permlane32_swap_b32 v21, v25
 v_permlane32_swap_b32 v22, v26
 v_mfma_f32_16x16x32_bf16 v[120:123], v[36:39], a[96:99], 0
 buffer_load_dwordx4 v2, s[16:19], s52 offen offset:1536 nt lds
 v_permlane32_swap_b32 v23, v27
 v_max_f32 v20, v20, v24
 v_max_f32 v21, v21, v25
 v_mfma_f32_16x16x32_bf16 v[120:123], v[40:43], a[100:103], v[120:123]
 s_waitcnt lgkmcnt(1)
 ds_read_b128 v[36:39], v0 offset:640
 v_max_f32 v22, v22, v26
 v_max_f32 v23, v23, v27
 v_mul_f32 v6, s29, v20
 v_mfma_f32_16x16x32_bf16 v[92:95], v[28:31], a[8:11], v[92:95]
 s_waitcnt lgkmcnt(1)
 v_mul_f32 v7, s29, v21
 v_mul_f32 v8, s29, v22
 v_mul_f32 v9, s29, v23
 v_mfma_f32_16x16x32_bf16 v[92:95], v[32:35], a[12:15], v[92:95]
 v_mov_b32 v10, 0
 v_mov_b32 v11, 0
 v_mov_b32 v12, 0
 v_mfma_f32_16x16x32_bf16 v[100:103], v[28:31], a[40:43], v[100:103]
 v_mov_b32 v13, 0
 v_fma_f32 v60, v60, s29, -v6
 v_fma_f32 v61, v61, s29, -v6
 v_fma_f32 v62, v62, s29, -v6
 v_mfma_f32_16x16x32_bf16 v[100:103], v[32:35], a[44:47], v[100:103]
 ds_read_b128 v[40:43], v0 offset:704
 v_fma_f32 v63, v63, s29, -v6
 v_fma_f32 v64, v64, s29, -v6
 v_fma_f32 v65, v65, s29, -v6
 v_mfma_f32_16x16x32_bf16 v[108:111], v[28:31], a[72:75], v[108:111]
 v_fma_f32 v66, v66, s29, -v6
 v_fma_f32 v67, v67, s29, -v6
 v_fma_f32 v68, v68, s29, -v7
 v_mfma_f32_16x16x32_bf16 v[108:111], v[32:35], a[76:79], v[108:111]
 v_fma_f32 v69, v69, s29, -v7
 v_fma_f32 v70, v70, s29, -v7
 v_fma_f32 v71, v71, s29, -v7
 v_mfma_f32_16x16x32_bf16 v[116:119], v[28:31], a[104:107], v[116:119]
 v_fma_f32 v72, v72, s29, -v7
 v_fma_f32 v73, v73, s29, -v7
 v_fma_f32 v74, v74, s29, -v7
 v_mfma_f32_16x16x32_bf16 v[116:119], v[32:35], a[108:111], v[116:119]
 s_waitcnt lgkmcnt(1)
 ds_read_b128 v[28:31], v0 offset:256
 v_fma_f32 v75, v75, s29, -v7
 v_fma_f32 v76, v76, s29, -v8
 v_fma_f32 v77, v77, s29, -v8
 v_mfma_f32_16x16x32_bf16 v[96:99], v[36:39], a[8:11], v[96:99]
 s_waitcnt lgkmcnt(1)
 v_fma_f32 v78, v78, s29, -v8
 v_fma_f32 v79, v79, s29, -v8
 v_fma_f32 v80, v80, s29, -v8
 v_mfma_f32_16x16x32_bf16 v[96:99], v[40:43], a[12:15], v[96:99]
 v_fma_f32 v81, v81, s29, -v8
 v_fma_f32 v82, v82, s29, -v8
 v_fma_f32 v83, v83, s29, -v8
 v_fma_f32 v84, v84, s29, -v9
 v_mfma_f32_16x16x32_bf16 v[104:107], v[36:39], a[40:43], v[104:107]
 v_fma_f32 v85, v85, s29, -v9
 v_fma_f32 v86, v86, s29, -v9
 v_fma_f32 v87, v87, s29, -v9
 v_mfma_f32_16x16x32_bf16 v[104:107], v[40:43], a[44:47], v[104:107]
 ds_read_b128 v[32:35], v0 offset:320
 v_fma_f32 v88, v88, s29, -v9
 v_fma_f32 v89, v89, s29, -v9
 v_fma_f32 v90, v90, s29, -v9
 v_mfma_f32_16x16x32_bf16 v[112:115], v[36:39], a[72:75], v[112:115]
 v_fma_f32 v91, v91, s29, -v9
 v_exp_f32 v20, v60
 v_mfma_f32_16x16x32_bf16 v[112:115], v[40:43], a[76:79], v[112:115]
 v_exp_f32 v21, v61
 v_exp_f32 v22, v62
 v_mfma_f32_16x16x32_bf16 v[120:123], v[36:39], a[104:107], v[120:123]
 v_exp_f32 v23, v63
 v_mfma_f32_16x16x32_bf16 v[120:123], v[40:43], a[108:111], v[120:123]
 s_waitcnt lgkmcnt(1)
 ds_read_b128 v[36:39], v0 offset:768
 v_add_f32 v14, v20, v21
 v_cvt_pk_bf16_f32 v44, v20, v21
 v_exp_f32 v20, v64
 v_mfma_f32_16x16x32_bf16 v[92:95], v[28:31], a[16:19], v[92:95]
 s_waitcnt lgkmcnt(1)
 v_exp_f32 v21, v65
 v_mfma_f32_16x16x32_bf16 v[92:95], v[32:35], a[20:23], v[92:95]
 v_add_f32 v14, v14, v22
 v_add_f32 v14, v14, v23
 v_cvt_pk_bf16_f32 v45, v22, v23
 v_exp_f32 v22, v66
 v_mfma_f32_16x16x32_bf16 v[100:103], v[28:31], a[48:51], v[100:103]
 v_exp_f32 v23, v67
 v_mfma_f32_16x16x32_bf16 v[100:103], v[32:35], a[52:55], v[100:103]
 ds_read_b128 v[40:43], v0 offset:832
 v_add_f32 v14, v14, v20
 v_add_f32 v14, v14, v21
 v_cvt_pk_bf16_f32 v46, v20, v21
 v_mfma_f32_16x16x32_bf16 v[108:111], v[28:31], a[80:83], v[108:111]
 v_exp_f32 v20, v68
 v_exp_f32 v21, v69
 v_mfma_f32_16x16x32_bf16 v[108:111], v[32:35], a[84:87], v[108:111]
 v_add_f32 v14, v14, v22
 v_add_f32 v14, v14, v23
 v_mfma_f32_16x16x32_bf16 v[116:119], v[28:31], a[112:115], v[116:119]
 v_cvt_pk_bf16_f32 v47, v22, v23
 v_exp_f32 v22, v70
 v_mfma_f32_16x16x32_bf16 v[116:119], v[32:35], a[116:119], v[116:119]
 s_waitcnt lgkmcnt(1)
 ds_read_b128 v[28:31], v0 offset:384
 v_exp_f32 v23, v71
 v_add_f32 v15, v20, v21
 v_mfma_f32_16x16x32_bf16 v[96:99], v[36:39], a[16:19], v[96:99]
 s_waitcnt lgkmcnt(1)
 v_cvt_pk_bf16_f32 v48, v20, v21
 v_exp_f32 v20, v72
 v_exp_f32 v21, v73
 v_mfma_f32_16x16x32_bf16 v[96:99], v[40:43], a[20:23], v[96:99]
 v_add_f32 v15, v15, v22
 v_add_f32 v15, v15, v23
 v_mfma_f32_16x16x32_bf16 v[104:107], v[36:39], a[48:51], v[104:107]
 v_cvt_pk_bf16_f32 v49, v22, v23
 v_exp_f32 v22, v74
 v_mfma_f32_16x16x32_bf16 v[104:107], v[40:43], a[52:55], v[104:107]
 ds_read_b128 v[32:35], v0 offset:448
 v_exp_f32 v23, v75
 v_add_f32 v15, v15, v20
 v_mfma_f32_16x16x32_bf16 v[112:115], v[36:39], a[80:83], v[112:115]
 v_add_f32 v15, v15, v21
 v_cvt_pk_bf16_f32 v50, v20, v21
 v_exp_f32 v20, v76
 v_mfma_f32_16x16x32_bf16 v[112:115], v[40:43], a[84:87], v[112:115]
 v_exp_f32 v21, v77
 v_mfma_f32_16x16x32_bf16 v[120:123], v[36:39], a[112:115], v[120:123]
 v_add_f32 v15, v15, v22
 v_add_f32 v15, v15, v23
 v_cvt_pk_bf16_f32 v51, v22, v23
 v_mfma_f32_16x16x32_bf16 v[120:123], v[40:43], a[116:119], v[120:123]
 s_waitcnt lgkmcnt(1)
 ds_read_b128 v[36:39], v0 offset:896
 v_exp_f32 v22, v78
 v_exp_f32 v23, v79
 v_mfma_f32_16x16x32_bf16 v[92:95], v[28:31], a[24:27], v[92:95]
 s_waitcnt lgkmcnt(1)
 v_add_f32 v16, v20, v21
 v_cvt_pk_bf16_f32 v52, v20, v21
 v_exp_f32 v20, v80
 v_mfma_f32_16x16x32_bf16 v[92:95], v[32:35], a[28:31], v[92:95]
 v_exp_f32 v21, v81
 v_mfma_f32_16x16x32_bf16 v[100:103], v[28:31], a[56:59], v[100:103]
 v_add_f32 v16, v16, v22
 v_add_f32 v16, v16, v23
 v_cvt_pk_bf16_f32 v53, v22, v23
 v_mfma_f32_16x16x32_bf16 v[100:103], v[32:35], a[60:63], v[100:103]
 ds_read_b128 v[40:43], v0 offset:960
 v_exp_f32 v22, v82
 v_exp_f32 v23, v83
 v_mfma_f32_16x16x32_bf16 v[108:111], v[28:31], a[88:91], v[108:111]
 v_add_f32 v16, v16, v20
 v_add_f32 v16, v16, v21
 v_mfma_f32_16x16x32_bf16 v[108:111], v[32:35], a[92:95], v[108:111]
 v_cvt_pk_bf16_f32 v54, v20, v21
 v_exp_f32 v20, v84
 v_mfma_f32_16x16x32_bf16 v[116:119], v[28:31], a[120:123], v[116:119]
 v_exp_f32 v21, v85
 v_add_f32 v16, v16, v22
 v_mfma_f32_16x16x32_bf16 v[116:119], v[32:35], a[124:127], v[116:119]
 s_waitcnt lgkmcnt(1)
 ds_read_b64_tr_b16 v[28:29], v1
 v_add_f32 v16, v16, v23
 v_cvt_pk_bf16_f32 v55, v22, v23
 v_exp_f32 v22, v86
 v_mfma_f32_16x16x32_bf16 v[96:99], v[36:39], a[24:27], v[96:99]
 s_waitcnt lgkmcnt(1)
 ds_read_b64_tr_b16 v[30:31], v1 offset:512
 v_exp_f32 v23, v87
 v_add_f32 v17, v20, v21
 v_mfma_f32_16x16x32_bf16 v[96:99], v[40:43], a[28:31], v[96:99]
 v_cvt_pk_bf16_f32 v56, v20, v21
 v_exp_f32 v20, v88
 v_mfma_f32_16x16x32_bf16 v[104:107], v[36:39], a[56:59], v[104:107]
 v_exp_f32 v21, v89
 v_add_f32 v17, v17, v22
 v_mfma_f32_16x16x32_bf16 v[104:107], v[40:43], a[60:63], v[104:107]
 ds_read_b64_tr_b16 v[32:33], v1 offset:32
 v_add_f32 v17, v17, v23
 v_cvt_pk_bf16_f32 v57, v22, v23
 v_exp_f32 v22, v90
 v_mfma_f32_16x16x32_bf16 v[112:115], v[36:39], a[88:91], v[112:115]
 ds_read_b64_tr_b16 v[34:35], v1 offset:544
 v_exp_f32 v23, v91
 v_mfma_f32_16x16x32_bf16 v[112:115], v[40:43], a[92:95], v[112:115]
 v_add_f32 v17, v17, v20
 v_add_f32 v17, v17, v21
 v_cvt_pk_bf16_f32 v58, v20, v21
 v_mfma_f32_16x16x32_bf16 v[120:123], v[36:39], a[120:123], v[120:123]
 v_add_f32 v17, v17, v22
 v_add_f32 v17, v17, v23
 v_cvt_pk_bf16_f32 v59, v22, v23
 v_mfma_f32_16x16x32_bf16 v[120:123], v[40:43], a[124:127], v[120:123]
 s_waitcnt lgkmcnt(2)
 ds_read_b64_tr_b16 v[36:37], v1 offset:64
 v_mfma_f32_16x16x32_bf16 v[124:127], v[28:31], v[44:47], 0
 s_waitcnt vmcnt(8)
 s_barrier
 s_waitcnt lgkmcnt(1)
 ds_read_b64_tr_b16 v[38:39], v1 offset:576
 v_mfma_f32_16x16x32_bf16 v[128:131], v[32:35], v[44:47], 0
 s_add_u32 s53, s53, 16384
 s_add_u32 m0, s31, 101376
 v_add_f32 v10, v10, v14
 v_add_f32 v11, v11, v15
 v_mfma_f32_16x16x32_bf16 v[188:191], v[28:31], v[48:51], 0
 buffer_load_dwordx4 v2, s[20:23], s53 offen nt lds
 v_add_f32 v12, v12, v16
 v_mfma_f32_16x16x32_bf16 v[192:195], v[32:35], v[48:51], 0
 ds_read_b64_tr_b16 v[40:41], v1 offset:96
 v_add_f32 v13, v13, v17
 v_mfma_f32_16x16x32_bf16 a[128:131], v[28:31], v[52:55], 0
 ds_read_b64_tr_b16 v[42:43], v1 offset:608
 v_mfma_f32_16x16x32_bf16 a[132:135], v[32:35], v[52:55], 0
 s_add_u32 m0, s31, 101920
 v_mfma_f32_16x16x32_bf16 a[192:195], v[28:31], v[56:59], 0
 buffer_load_dwordx4 v2, s[20:23], s53 offen offset:512 nt lds
 v_mfma_f32_16x16x32_bf16 a[196:199], v[32:35], v[56:59], 0
 s_waitcnt lgkmcnt(2)
 ds_read_b64_tr_b16 v[28:29], v1 offset:128
 v_mfma_f32_16x16x32_bf16 v[132:135], v[36:39], v[44:47], 0
 s_waitcnt lgkmcnt(1)
 ds_read_b64_tr_b16 v[30:31], v1 offset:640
 v_mfma_f32_16x16x32_bf16 v[136:139], v[40:43], v[44:47], 0
 s_add_u32 m0, s31, 102464
 v_mfma_f32_16x16x32_bf16 v[196:199], v[36:39], v[48:51], 0
 buffer_load_dwordx4 v2, s[20:23], s53 offen offset:1024 nt lds
 v_mfma_f32_16x16x32_bf16 v[200:203], v[40:43], v[48:51], 0
 ds_read_b64_tr_b16 v[32:33], v1 offset:160
 v_mfma_f32_16x16x32_bf16 a[136:139], v[36:39], v[52:55], 0
 ds_read_b64_tr_b16 v[34:35], v1 offset:672
 v_mfma_f32_16x16x32_bf16 a[140:143], v[40:43], v[52:55], 0
 s_add_u32 m0, s31, 103008
 v_mfma_f32_16x16x32_bf16 a[200:203], v[36:39], v[56:59], 0
 buffer_load_dwordx4 v2, s[20:23], s53 offen offset:1536 nt lds
 v_mfma_f32_16x16x32_bf16 a[204:207], v[40:43], v[56:59], 0
 s_waitcnt lgkmcnt(2)
 ds_read_b64_tr_b16 v[36:37], v1 offset:192
 v_mfma_f32_16x16x32_bf16 v[140:143], v[28:31], v[44:47], 0
 s_waitcnt lgkmcnt(1)
 ds_read_b64_tr_b16 v[38:39], v1 offset:704
 v_mfma_f32_16x16x32_bf16 v[144:147], v[32:35], v[44:47], 0
 s_add_u32 s52, s52, 16384
 s_add_u32 m0, s31, 16896
 v_mfma_f32_16x16x32_bf16 v[204:207], v[28:31], v[48:51], 0
 buffer_load_dwordx4 v2, s[16:19], s52 offen nt lds
 v_mfma_f32_16x16x32_bf16 v[208:211], v[32:35], v[48:51], 0
 ds_read_b64_tr_b16 v[40:41], v1 offset:224
 v_mfma_f32_16x16x32_bf16 a[144:147], v[28:31], v[52:55], 0
 ds_read_b64_tr_b16 v[42:43], v1 offset:736
 v_fma_f32 v92, v92, s29, -v6
 v_mfma_f32_16x16x32_bf16 a[148:151], v[32:35], v[52:55], 0
 s_add_u32 m0, s31, 17440
 v_fma_f32 v93, v93, s29, -v6
 v_fma_f32 v94, v94, s29, -v6
 v_mfma_f32_16x16x32_bf16 a[208:211], v[28:31], v[56:59], 0
 buffer_load_dwordx4 v2, s[16:19], s52 offen offset:512 nt lds
 v_fma_f32 v95, v95, s29, -v6
 v_mfma_f32_16x16x32_bf16 a[212:215], v[32:35], v[56:59], 0
 s_waitcnt lgkmcnt(2)
 ds_read_b64_tr_b16 v[28:29], v1 offset:256
 v_fma_f32 v96, v96, s29, -v6
 v_mfma_f32_16x16x32_bf16 v[148:151], v[36:39], v[44:47], 0
 s_waitcnt lgkmcnt(1)
 ds_read_b64_tr_b16 v[30:31], v1 offset:768
 v_fma_f32 v97, v97, s29, -v6
 v_mfma_f32_16x16x32_bf16 v[152:155], v[40:43], v[44:47], 0
 s_add_u32 m0, s31, 17984
 v_fma_f32 v98, v98, s29, -v6
 v_fma_f32 v99, v99, s29, -v6
 v_mfma_f32_16x16x32_bf16 v[212:215], v[36:39], v[48:51], 0
 buffer_load_dwordx4 v2, s[16:19], s52 offen offset:1024 nt lds
 v_fma_f32 v100, v100, s29, -v7
 v_mfma_f32_16x16x32_bf16 v[216:219], v[40:43], v[48:51], 0
 ds_read_b64_tr_b16 v[32:33], v1 offset:288
 v_fma_f32 v101, v101, s29, -v7
 v_mfma_f32_16x16x32_bf16 a[152:155], v[36:39], v[52:55], 0
 ds_read_b64_tr_b16 v[34:35], v1 offset:800
 v_fma_f32 v102, v102, s29, -v7
 v_mfma_f32_16x16x32_bf16 a[156:159], v[40:43], v[52:55], 0
 s_add_u32 m0, s31, 18528
 v_fma_f32 v103, v103, s29, -v7
 v_fma_f32 v104, v104, s29, -v7
 v_mfma_f32_16x16x32_bf16 a[216:219], v[36:39], v[56:59], 0
 buffer_load_dwordx4 v2, s[16:19], s52 offen offset:1536 nt lds
 v_add_u32 v0, 16896, v0
 v_mfma_f32_16x16x32_bf16 a[220:223], v[40:43], v[56:59], 0
 s_waitcnt lgkmcnt(2)
 ds_read_b64_tr_b16 v[36:37], v1 offset:320
 v_fma_f32 v105, v105, s29, -v7
 v_mfma_f32_16x16x32_bf16 v[156:159], v[28:31], v[44:47], 0
 s_waitcnt lgkmcnt(1)
 ds_read_b64_tr_b16 v[38:39], v1 offset:832
 v_fma_f32 v106, v106, s29, -v7
 v_mfma_f32_16x16x32_bf16 v[160:163], v[32:35], v[44:47], 0
 v_fma_f32 v107, v107, s29, -v7
 v_fma_f32 v108, v108, s29, -v8
 v_mfma_f32_16x16x32_bf16 v[220:223], v[28:31], v[48:51], 0
 v_fma_f32 v109, v109, s29, -v8
 v_fma_f32 v110, v110, s29, -v8
 v_mfma_f32_16x16x32_bf16 v[224:227], v[32:35], v[48:51], 0
 ds_read_b64_tr_b16 v[40:41], v1 offset:352
 v_fma_f32 v111, v111, s29, -v8
 v_mfma_f32_16x16x32_bf16 a[160:163], v[28:31], v[52:55], 0
 ds_read_b64_tr_b16 v[42:43], v1 offset:864
 v_fma_f32 v112, v112, s29, -v8
 v_mfma_f32_16x16x32_bf16 a[164:167], v[32:35], v[52:55], 0
 v_fma_f32 v113, v113, s29, -v8
 v_fma_f32 v114, v114, s29, -v8
 v_mfma_f32_16x16x32_bf16 a[224:227], v[28:31], v[56:59], 0
 v_fma_f32 v115, v115, s29, -v8
 v_fma_f32 v116, v116, s29, -v9
 v_mfma_f32_16x16x32_bf16 a[228:231], v[32:35], v[56:59], 0
 s_waitcnt lgkmcnt(2)
 ds_read_b64_tr_b16 v[28:29], v1 offset:384
 v_fma_f32 v117, v117, s29, -v9
 v_mfma_f32_16x16x32_bf16 v[164:167], v[36:39], v[44:47], 0
 s_waitcnt lgkmcnt(1)
 ds_read_b64_tr_b16 v[30:31], v1 offset:896
 v_fma_f32 v118, v118, s29, -v9
 v_mfma_f32_16x16x32_bf16 v[168:171], v[40:43], v[44:47], 0
 v_fma_f32 v119, v119, s29, -v9
 v_fma_f32 v120, v120, s29, -v9
 v_mfma_f32_16x16x32_bf16 v[228:231], v[36:39], v[48:51], 0
 v_fma_f32 v121, v121, s29, -v9
 v_fma_f32 v122, v122, s29, -v9
 v_mfma_f32_16x16x32_bf16 v[232:235], v[40:43], v[48:51], 0
 ds_read_b64_tr_b16 v[32:33], v1 offset:416
 v_fma_f32 v123, v123, s29, -v9
 v_mfma_f32_16x16x32_bf16 a[168:171], v[36:39], v[52:55], 0
 ds_read_b64_tr_b16 v[34:35], v1 offset:928
 v_mfma_f32_16x16x32_bf16 a[172:175], v[40:43], v[52:55], 0
 v_mfma_f32_16x16x32_bf16 a[232:235], v[36:39], v[56:59], 0
 v_mfma_f32_16x16x32_bf16 a[236:239], v[40:43], v[56:59], 0
 s_waitcnt lgkmcnt(2)
 ds_read_b64_tr_b16 v[36:37], v1 offset:448
 v_mfma_f32_16x16x32_bf16 v[172:175], v[28:31], v[44:47], 0
 s_waitcnt lgkmcnt(1)
 ds_read_b64_tr_b16 v[38:39], v1 offset:960
 v_mfma_f32_16x16x32_bf16 v[176:179], v[32:35], v[44:47], 0
 v_mfma_f32_16x16x32_bf16 v[236:239], v[28:31], v[48:51], 0
 v_mfma_f32_16x16x32_bf16 v[240:243], v[32:35], v[48:51], 0
 ds_read_b64_tr_b16 v[40:41], v1 offset:480
 v_mfma_f32_16x16x32_bf16 a[176:179], v[28:31], v[52:55], 0
 ds_read_b64_tr_b16 v[42:43], v1 offset:992
 v_mfma_f32_16x16x32_bf16 a[180:183], v[32:35], v[52:55], 0
 v_mfma_f32_16x16x32_bf16 a[240:243], v[28:31], v[56:59], 0
 v_add_u32 v1, 16896, v1
 v_mfma_f32_16x16x32_bf16 a[244:247], v[32:35], v[56:59], 0
 s_waitcnt lgkmcnt(2)
 ds_read_b128 v[28:31], v0
 v_mfma_f32_16x16x32_bf16 v[180:183], v[36:39], v[44:47], 0
 s_waitcnt lgkmcnt(1)
 v_mfma_f32_16x16x32_bf16 v[184:187], v[40:43], v[44:47], 0
 v_mfma_f32_16x16x32_bf16 v[244:247], v[36:39], v[48:51], 0
 v_mfma_f32_16x16x32_bf16 v[248:251], v[40:43], v[48:51], 0
 ds_read_b128 v[32:35], v0 offset:64
 v_mfma_f32_16x16x32_bf16 a[184:187], v[36:39], v[52:55], 0
 v_exp_f32 v20, v92
 v_mfma_f32_16x16x32_bf16 a[188:191], v[40:43], v[52:55], 0
 v_exp_f32 v21, v93
 v_mfma_f32_16x16x32_bf16 a[248:251], v[36:39], v[56:59], 0
 v_add_f32 v14, v20, v21
 v_mfma_f32_16x16x32_bf16 a[252:255], v[40:43], v[56:59], 0
 s_waitcnt lgkmcnt(1)
 ds_read_b128 v[36:39], v0 offset:512
 v_cvt_pk_bf16_f32 v44, v20, v21
L_first:
 v_mfma_f32_16x16x32_bf16 v[60:63], v[28:31], a[0:3], 0
 s_waitcnt lgkmcnt(1)
 v_exp_f32 v22, v94
 v_mfma_f32_16x16x32_bf16 v[60:63], v[32:35], a[4:7], v[60:63]
 v_exp_f32 v23, v95
 v_mfma_f32_16x16x32_bf16 v[68:71], v[28:31], a[32:35], 0
 v_add_f32 v14, v14, v22
 v_add_f32 v14, v14, v23
 v_mfma_f32_16x16x32_bf16 v[68:71], v[32:35], a[36:39], v[68:71]
 ds_read_b128 v[40:43], v0 offset:576
 v_cvt_pk_bf16_f32 v45, v22, v23
 v_mfma_f32_16x16x32_bf16 v[76:79], v[28:31], a[64:67], 0
 v_exp_f32 v20, v96
 v_mfma_f32_16x16x32_bf16 v[76:79], v[32:35], a[68:71], v[76:79]
 v_exp_f32 v21, v97
 v_mfma_f32_16x16x32_bf16 v[84:87], v[28:31], a[96:99], 0
 v_add_f32 v14, v14, v20
 v_add_f32 v14, v14, v21
 v_mfma_f32_16x16x32_bf16 v[84:87], v[32:35], a[100:103], v[84:87]
 s_waitcnt lgkmcnt(1)
 ds_read_b128 v[28:31], v0 offset:128
 v_cvt_pk_bf16_f32 v46, v20, v21
 v_mfma_f32_16x16x32_bf16 v[64:67], v[36:39], a[0:3], 0
 s_waitcnt lgkmcnt(1)
 v_exp_f32 v22, v98
 v_mfma_f32_16x16x32_bf16 v[64:67], v[40:43], a[4:7], v[64:67]
 v_exp_f32 v23, v99
 v_mfma_f32_16x16x32_bf16 v[72:75], v[36:39], a[32:35], 0
 v_add_f32 v14, v14, v22
 v_add_f32 v14, v14, v23
 v_mfma_f32_16x16x32_bf16 v[72:75], v[40:43], a[36:39], v[72:75]
 ds_read_b128 v[32:35], v0 offset:192
 v_cvt_pk_bf16_f32 v47, v22, v23
 v_mfma_f32_16x16x32_bf16 v[80:83], v[36:39], a[64:67], 0
 v_exp_f32 v20, v100
 v_mfma_f32_16x16x32_bf16 v[80:83], v[40:43], a[68:71], v[80:83]
 v_exp_f32 v21, v101
 v_mfma_f32_16x16x32_bf16 v[88:91], v[36:39], a[96:99], 0
 v_add_f32 v15, v20, v21
 v_mfma_f32_16x16x32_bf16 v[88:91], v[40:43], a[100:103], v[88:91]
 s_waitcnt lgkmcnt(1)
 ds_read_b128 v[36:39], v0 offset:640
 v_cvt_pk_bf16_f32 v48, v20, v21
 v_mfma_f32_16x16x32_bf16 v[60:63], v[28:31], a[8:11], v[60:63]
 s_waitcnt lgkmcnt(1)
 v_exp_f32 v22, v102
 v_mfma_f32_16x16x32_bf16 v[60:63], v[32:35], a[12:15], v[60:63]
 v_exp_f32 v23, v103
 v_mfma_f32_16x16x32_bf16 v[68:71], v[28:31], a[40:43], v[68:71]
 v_add_f32 v15, v15, v22
 v_add_f32 v15, v15, v23
 v_mfma_f32_16x16x32_bf16 v[68:71], v[32:35], a[44:47], v[68:71]
 ds_read_b128 v[40:43], v0 offset:704
 v_cvt_pk_bf16_f32 v49, v22, v23
 v_mfma_f32_16x16x32_bf16 v[76:79], v[28:31], a[72:75], v[76:79]
 v_exp_f32 v20, v104
 v_mfma_f32_16x16x32_bf16 v[76:79], v[32:35], a[76:79], v[76:79]
 v_exp_f32 v21, v105
 v_mfma_f32_16x16x32_bf16 v[84:87], v[28:31], a[104:107], v[84:87]
 v_add_f32 v15, v15, v20
 v_add_f32 v15, v15, v21
 v_mfma_f32_16x16x32_bf16 v[84:87], v[32:35], a[108:111], v[84:87]
 s_waitcnt lgkmcnt(1)
 ds_read_b128 v[28:31], v0 offset:256
 v_cvt_pk_bf16_f32 v50, v20, v21
 v_mfma_f32_16x16x32_bf16 v[64:67], v[36:39], a[8:11], v[64:67]
 s_waitcnt lgkmcnt(1)
 v_exp_f32 v22, v106
 v_mfma_f32_16x16x32_bf16 v[64:67], v[40:43], a[12:15], v[64:67]
 v_exp_f32 v23, v107
 v_mfma_f32_16x16x32_bf16 v[72:75], v[36:39], a[40:43], v[72:75]
 v_add_f32 v15, v15, v22
 v_add_f32 v15, v15, v23
 v_mfma_f32_16x16x32_bf16 v[72:75], v[40:43], a[44:47], v[72:75]
 ds_read_b128 v[32:35], v0 offset:320
 v_cvt_pk_bf16_f32 v51, v22, v23
 v_mfma_f32_16x16x32_bf16 v[80:83], v[36:39], a[72:75], v[80:83]
 v_exp_f32 v20, v108
 v_mfma_f32_16x16x32_bf16 v[80:83], v[40:43], a[76:79], v[80:83]
 v_exp_f32 v21, v109
 v_mfma_f32_16x16x32_bf16 v[88:91], v[36:39], a[104:107], v[88:91]
 v_add_f32 v16, v20, v21
 v_mfma_f32_16x16x32_bf16 v[88:91], v[40:43], a[108:111], v[88:91]
 s_waitcnt lgkmcnt(1)
 ds_read_b128 v[36:39], v0 offset:768
 v_cvt_pk_bf16_f32 v52, v20, v21
 v_mfma_f32_16x16x32_bf16 v[60:63], v[28:31], a[16:19], v[60:63]
 s_waitcnt lgkmcnt(1)
 v_exp_f32 v22, v110
 v_mfma_f32_16x16x32_bf16 v[60:63], v[32:35], a[20:23], v[60:63]
 v_exp_f32 v23, v111
 v_mfma_f32_16x16x32_bf16 v[68:71], v[28:31], a[48:51], v[68:71]
 v_add_f32 v16, v16, v22
 v_add_f32 v16, v16, v23
 v_mfma_f32_16x16x32_bf16 v[68:71], v[32:35], a[52:55], v[68:71]
 ds_read_b128 v[40:43], v0 offset:832
 v_cvt_pk_bf16_f32 v53, v22, v23
 v_mfma_f32_16x16x32_bf16 v[76:79], v[28:31], a[80:83], v[76:79]
 v_exp_f32 v20, v112
 v_mfma_f32_16x16x32_bf16 v[76:79], v[32:35], a[84:87], v[76:79]
 v_exp_f32 v21, v113
 v_mfma_f32_16x16x32_bf16 v[84:87], v[28:31], a[112:115], v[84:87]
 v_add_f32 v16, v16, v20
 v_add_f32 v16, v16, v21
 v_mfma_f32_16x16x32_bf16 v[84:87], v[32:35], a[116:119], v[84:87]
 s_waitcnt lgkmcnt(1)
 ds_read_b128 v[28:31], v0 offset:384
 v_cvt_pk_bf16_f32 v54, v20, v21
 v_mfma_f32_16x16x32_bf16 v[64:67], v[36:39], a[16:19], v[64:67]
 s_waitcnt lgkmcnt(1)
 v_exp_f32 v22, v114
 v_mfma_f32_16x16x32_bf16 v[64:67], v[40:43], a[20:23], v[64:67]
 v_exp_f32 v23, v115
 v_mfma_f32_16x16x32_bf16 v[72:75], v[36:39], a[48:51], v[72:75]
 v_add_f32 v16, v16, v22
 v_add_f32 v16, v16, v23
 v_mfma_f32_16x16x32_bf16 v[72:75], v[40:43], a[52:55], v[72:75]
 ds_read_b128 v[32:35], v0 offset:448
 v_cvt_pk_bf16_f32 v55, v22, v23
 v_mfma_f32_16x16x32_bf16 v[80:83], v[36:39], a[80:83], v[80:83]
 v_exp_f32 v20, v116
 v_mfma_f32_16x16x32_bf16 v[80:83], v[40:43], a[84:87], v[80:83]
 v_exp_f32 v21, v117
 v_mfma_f32_16x16x32_bf16 v[88:91], v[36:39], a[112:115], v[88:91]
 v_add_f32 v17, v20, v21
 v_mfma_f32_16x16x32_bf16 v[88:91], v[40:43], a[116:119], v[88:91]
 s_waitcnt lgkmcnt(1)
 ds_read_b128 v[36:39], v0 offset:896
 v_cvt_pk_bf16_f32 v56, v20, v21
 v_mfma_f32_16x16x32_bf16 v[60:63], v[28:31], a[24:27], v[60:63]
 s_waitcnt lgkmcnt(1)
 v_exp_f32 v22, v118
 v_mfma_f32_16x16x32_bf16 v[60:63], v[32:35], a[28:31], v[60:63]
 v_exp_f32 v23, v119
 v_mfma_f32_16x16x32_bf16 v[68:71], v[28:31], a[56:59], v[68:71]
 v_add_f32 v17, v17, v22
 v_add_f32 v17, v17, v23
 v_mfma_f32_16x16x32_bf16 v[68:71], v[32:35], a[60:63], v[68:71]
 ds_read_b128 v[40:43], v0 offset:960
 v_cvt_pk_bf16_f32 v57, v22, v23
 v_mfma_f32_16x16x32_bf16 v[76:79], v[28:31], a[88:91], v[76:79]
 v_exp_f32 v20, v120
 v_mfma_f32_16x16x32_bf16 v[76:79], v[32:35], a[92:95], v[76:79]
 v_exp_f32 v21, v121
 v_mfma_f32_16x16x32_bf16 v[84:87], v[28:31], a[120:123], v[84:87]
 v_add_f32 v17, v17, v20
 v_add_f32 v17, v17, v21
 v_mfma_f32_16x16x32_bf16 v[84:87], v[32:35], a[124:127], v[84:87]
 s_waitcnt lgkmcnt(1)
 ds_read_b64_tr_b16 v[28:29], v1
 v_cvt_pk_bf16_f32 v58, v20, v21
 v_mfma_f32_16x16x32_bf16 v[64:67], v[36:39], a[24:27], v[64:67]
 s_waitcnt lgkmcnt(1)
 ds_read_b64_tr_b16 v[30:31], v1 offset:512
 v_exp_f32 v22, v122
 v_mfma_f32_16x16x32_bf16 v[64:67], v[40:43], a[28:31], v[64:67]
 v_exp_f32 v23, v123
 v_mfma_f32_16x16x32_bf16 v[72:75], v[36:39], a[56:59], v[72:75]
 v_add_f32 v17, v17, v22
 v_add_f32 v17, v17, v23
 v_mfma_f32_16x16x32_bf16 v[72:75], v[40:43], a[60:63], v[72:75]
 ds_read_b64_tr_b16 v[32:33], v1 offset:32
 v_cvt_pk_bf16_f32 v59, v22, v23
 v_mfma_f32_16x16x32_bf16 v[80:83], v[36:39], a[88:91], v[80:83]
 ds_read_b64_tr_b16 v[34:35], v1 offset:544
 v_max3_f32 v252, v14, v15, v16
 v_max_f32 v252, v252, v17
 v_mfma_f32_16x16x32_bf16 v[80:83], v[40:43], a[92:95], v[80:83]
 v_cmp_lt_f32 vcc, s30, v252
 v_mfma_f32_16x16x32_bf16 v[88:91], v[36:39], a[120:123], v[88:91]
 v_mfma_f32_16x16x32_bf16 v[88:91], v[40:43], a[124:127], v[88:91]
 s_waitcnt lgkmcnt(2)
 ds_read_b64_tr_b16 v[36:37], v1 offset:64
 s_cbranch_vccnz L_rare_F1
L_back_F1:
 s_sub_u32 s54, s6, s5
 s_add_u32 s90, s31, s5
 s_add_u32 s89, s31, s88
 v_mfma_f32_16x16x32_bf16 v[124:127], v[28:31], v[44:47], v[124:127]
 s_waitcnt vmcnt(8)
 s_barrier
 s_waitcnt lgkmcnt(1)
 ds_read_b64_tr_b16 v[38:39], v1 offset:576
 v_mfma_f32_16x16x32_bf16 v[128:131], v[32:35], v[44:47], v[128:131]
 s_add_u32 s53, s53, 16384
 s_add_u32 m0, s89, 50688
 v_add_f32 v10, v10, v14
 v_add_f32 v11, v11, v15
 v_mfma_f32_16x16x32_bf16 v[188:191], v[28:31], v[48:51], v[188:191]
 buffer_load_dwordx4 v2, s[20:23], s53 offen nt lds
 v_add_f32 v12, v12, v16
 v_mfma_f32_16x16x32_bf16 v[192:195], v[32:35], v[48:51], v[192:195]
 ds_read_b64_tr_b16 v[40:41], v1 offset:96
 v_add_f32 v13, v13, v17
 v_mfma_f32_16x16x32_bf16 a[128:131], v[28:31], v[52:55], a[128:131]
 ds_read_b64_tr_b16 v[42:43], v1 offset:608
 v_mfma_f32_16x16x32_bf16 a[132:135], v[32:35], v[52:55], a[132:135]
 s_add_u32 m0, s89, 51232
 v_mfma_f32_16x16x32_bf16 a[192:195], v[28:31], v[56:59], a[192:195]
 buffer_load_dwordx4 v2, s[20:23], s53 offen offset:512 nt lds
 v_mfma_f32_16x16x32_bf16 a[196:199], v[32:35], v[56:59], a[196:199]
 s_waitcnt lgkmcnt(2)
 ds_read_b64_tr_b16 v[28:29], v1 offset:128
 v_mfma_f32_16x16x32_bf16 v[132:135], v[36:39], v[44:47], v[132:135]
 s_waitcnt lgkmcnt(1)
 ds_read_b64_tr_b16 v[30:31], v1 offset:640
 v_mfma_f32_16x16x32_bf16 v[136:139], v[40:43], v[44:47], v[136:139]
 s_add_u32 m0, s89, 51776
 v_mfma_f32_16x16x32_bf16 v[196:199], v[36:39], v[48:51], v[196:199]
 buffer_load_dwordx4 v2, s[20:23], s53 offen offset:1024 nt lds
 v_mfma_f32_16x16x32_bf16 v[200:203], v[40:43], v[48:51], v[200:203]
 ds_read_b64_tr_b16 v[32:33], v1 offset:160
 v_mfma_f32_16x16x32_bf16 a[136:139], v[36:39], v[52:55], a[136:139]
 ds_read_b64_tr_b16 v[34:35], v1 offset:672
 v_mfma_f32_16x16x32_bf16 a[140:143], v[40:43], v[52:55], a[140:143]
 s_add_u32 m0, s89, 52320
 v_mfma_f32_16x16x32_bf16 a[200:203], v[36:39], v[56:59], a[200:203]
 buffer_load_dwordx4 v2, s[20:23], s53 offen offset:1536 nt lds
 v_mfma_f32_16x16x32_bf16 a[204:207], v[40:43], v[56:59], a[204:207]
 s_waitcnt lgkmcnt(2)
 ds_read_b64_tr_b16 v[36:37], v1 offset:192
 v_mfma_f32_16x16x32_bf16 v[140:143], v[28:31], v[44:47], v[140:143]
 s_waitcnt lgkmcnt(1)
 ds_read_b64_tr_b16 v[38:39], v1 offset:704
 v_mfma_f32_16x16x32_bf16 v[144:147], v[32:35], v[44:47], v[144:147]
 s_add_u32 s52, s52, 16384
 s_add_u32 m0, s90, 0
 v_mfma_f32_16x16x32_bf16 v[204:207], v[28:31], v[48:51], v[204:207]
 buffer_load_dwordx4 v2, s[16:19], s52 offen nt lds
 v_mfma_f32_16x16x32_bf16 v[208:211], v[32:35], v[48:51], v[208:211]
 ds_read_b64_tr_b16 v[40:41], v1 offset:224
 v_mfma_f32_16x16x32_bf16 a[144:147], v[28:31], v[52:55], a[144:147]
 ds_read_b64_tr_b16 v[42:43], v1 offset:736
 v_fma_f32 v60, v60, s29, -v6
 v_mfma_f32_16x16x32_bf16 a[148:151], v[32:35], v[52:55], a[148:151]
 s_add_u32 m0, s90, 544
 v_fma_f32 v61, v61, s29, -v6
 v_fma_f32 v62, v62, s29, -v6
 v_mfma_f32_16x16x32_bf16 a[208:211], v[28:31], v[56:59], a[208:211]
 buffer_load_dwordx4 v2, s[16:19], s52 offen offset:512 nt lds
 v_fma_f32 v63, v63, s29, -v6
 v_mfma_f32_16x16x32_bf16 a[212:215], v[32:35], v[56:59], a[212:215]
 s_waitcnt lgkmcnt(2)
 ds_read_b64_tr_b16 v[28:29], v1 offset:256
 v_fma_f32 v64, v64, s29, -v6
 v_mfma_f32_16x16x32_bf16 v[148:151], v[36:39], v[44:47], v[148:151]
 s_waitcnt lgkmcnt(1)
 ds_read_b64_tr_b16 v[30:31], v1 offset:768
 v_fma_f32 v65, v65, s29, -v6
 v_mfma_f32_16x16x32_bf16 v[152:155], v[40:43], v[44:47], v[152:155]
 s_add_u32 m0, s90, 1088
 v_fma_f32 v66, v66, s29, -v6
 v_fma_f32 v67, v67, s29, -v6
 v_mfma_f32_16x16x32_bf16 v[212:215], v[36:39], v[48:51], v[212:215]
 buffer_load_dwordx4 v2, s[16:19], s52 offen offset:1024 nt lds
 v_fma_f32 v68, v68, s29, -v7
 v_mfma_f32_16x16x32_bf16 v[216:219], v[40:43], v[48:51], v[216:219]
 ds_read_b64_tr_b16 v[32:33], v1 offset:288
 v_fma_f32 v69, v69, s29, -v7
 v_mfma_f32_16x16x32_bf16 a[152:155], v[36:39], v[52:55], a[152:155]
 ds_read_b64_tr_b16 v[34:35], v1 offset:800
 v_fma_f32 v70, v70, s29, -v7
 v_mfma_f32_16x16x32_bf16 a[156:159], v[40:43], v[52:55], a[156:159]
 s_add_u32 m0, s90, 1632
 v_fma_f32 v71, v71, s29, -v7
 v_fma_f32 v72, v72, s29, -v7
 v_mfma_f32_16x16x32_bf16 a[216:219], v[36:39], v[56:59], a[216:219]
 buffer_load_dwordx4 v2, s[16:19], s52 offen offset:1536 nt lds
 v_add_u32 v0, s54, v0
 v_mfma_f32_16x16x32_bf16 a[220:223], v[40:43], v[56:59], a[220:223]
 s_waitcnt lgkmcnt(2)
 ds_read_b64_tr_b16 v[36:37], v1 offset:320
 v_fma_f32 v73, v73, s29, -v7
 v_mfma_f32_16x16x32_bf16 v[156:159], v[28:31], v[44:47], v[156:159]
 s_waitcnt lgkmcnt(1)
 ds_read_b64_tr_b16 v[38:39], v1 offset:832
 v_fma_f32 v74, v74, s29, -v7
 v_mfma_f32_16x16x32_bf16 v[160:163], v[32:35], v[44:47], v[160:163]
 v_fma_f32 v75, v75, s29, -v7
 v_fma_f32 v76, v76, s29, -v8
 v_mfma_f32_16x16x32_bf16 v[220:223], v[28:31], v[48:51], v[220:223]
 v_fma_f32 v77, v77, s29, -v8
 v_fma_f32 v78, v78, s29, -v8
 v_mfma_f32_16x16x32_bf16 v[224:227], v[32:35], v[48:51], v[224:227]
 ds_read_b64_tr_b16 v[40:41], v1 offset:352
 v_fma_f32 v79, v79, s29, -v8
 v_mfma_f32_16x16x32_bf16 a[160:163], v[28:31], v[52:55], a[160:163]
 ds_read_b64_tr_b16 v[42:43], v1 offset:864
 s_bitcmp1_b32 s9, 1
 s_cbranch_scc1 L_o_dr0a
L_b_dr0a:
 v_mfma_f32_16x16x32_bf16 a[164:167], v[32:35], v[52:55], a[164:167]
 v_fma_f32 v80, v80, s29, -v8
 v_fma_f32 v81, v81, s29, -v8
 v_mfma_f32_16x16x32_bf16 a[224:227], v[28:31], v[56:59], a[224:227]
 v_fma_f32 v82, v82, s29, -v8
 v_fma_f32 v83, v83, s29, -v8
 v_mfma_f32_16x16x32_bf16 a[228:231], v[32:35], v[56:59], a[228:231]
 s_waitcnt lgkmcnt(2)
 ds_read_b64_tr_b16 v[28:29], v1 offset:384
 v_fma_f32 v84, v84, s29, -v9
 v_mfma_f32_16x16x32_bf16 v[164:167], v[36:39], v[44:47], v[164:167]
 s_waitcnt lgkmcnt(1)
 ds_read_b64_tr_b16 v[30:31], v1 offset:896
 v_fma_f32 v85, v85, s29, -v9
 v_mfma_f32_16x16x32_bf16 v[168:171], v[40:43], v[44:47], v[168:171]
 v_fma_f32 v86, v86, s29, -v9
 v_fma_f32 v87, v87, s29, -v9
 v_mfma_f32_16x16x32_bf16 v[228:231], v[36:39], v[48:51], v[228:231]
 v_fma_f32 v88, v88, s29, -v9
 v_fma_f32 v89, v89, s29, -v9
 v_mfma_f32_16x16x32_bf16 v[232:235], v[40:43], v[48:51], v[232:235]
 ds_read_b64_tr_b16 v[32:33], v1 offset:416
 v_fma_f32 v90, v90, s29, -v9
 v_mfma_f32_16x16x32_bf16 a[168:171], v[36:39], v[52:55], a[168:171]
 ds_read_b64_tr_b16 v[34:35], v1 offset:928
 v_fma_f32 v91, v91, s29, -v9
 v_mfma_f32_16x16x32_bf16 a[172:175], v[40:43], v[52:55], a[172:175]
 v_mfma_f32_16x16x32_bf16 a[232:235], v[36:39], v[56:59], a[232:235]
 s_bitcmp1_b32 s9, 1
 s_cbranch_scc1 L_o_dr0b
L_b_dr0b:
 v_mfma_f32_16x16x32_bf16 a[236:239], v[40:43], v[56:59], a[236:239]
 s_waitcnt lgkmcnt(2)
 ds_read_b64_tr_b16 v[36:37], v1 offset:448
 v_mfma_f32_16x16x32_bf16 v[172:175], v[28:31], v[44:47], v[172:175]
 s_waitcnt lgkmcnt(1)
 ds_read_b64_tr_b16 v[38:39], v1 offset:960
 v_mfma_f32_16x16x32_bf16 v[176:179], v[32:35], v[44:47], v[176:179]
 v_mfma_f32_16x16x32_bf16 v[236:239], v[28:31], v[48:51], v[236:239]
 v_mfma_f32_16x16x32_bf16 v[240:243], v[32:35], v[48:51], v[240:243]
 ds_read_b64_tr_b16 v[40:41], v1 offset:480
 v_mfma_f32_16x16x32_bf16 a[176:179], v[28:31], v[52:55], a[176:179]
 ds_read_b64_tr_b16 v[42:43], v1 offset:992
 v_mfma_f32_16x16x32_bf16 a[180:183], v[32:35], v[52:55], a[180:183]
 v_mfma_f32_16x16x32_bf16 a[240:243], v[28:31], v[56:59], a[240:243]
 v_add_u32 v1, s55, v1
 v_mfma_f32_16x16x32_bf16 a[244:247], v[32:35], v[56:59], a[244:247]
 s_waitcnt lgkmcnt(2)
 ds_read_b128 v[28:31], v0
 v_mfma_f32_16x16x32_bf16 v[180:183], v[36:39], v[44:47], v[180:183]
 s_waitcnt lgkmcnt(1)
 s_bitcmp1_b32 s9, 0
 s_cbranch_scc1 L_o_xq
L_b_xq:
 v_mfma_f32_16x16x32_bf16 v[184:187], v[40:43], v[44:47], v[184:187]
 v_mfma_f32_16x16x32_bf16 v[244:247], v[36:39], v[48:51], v[244:247]
 v_mfma_f32_16x16x32_bf16 v[248:251], v[40:43], v[48:51], v[248:251]
 ds_read_b128 v[32:35], v0 offset:64
 v_mfma_f32_16x16x32_bf16 a[184:187], v[36:39], v[52:55], a[184:187]
 v_exp_f32 v20, v60
 v_mfma_f32_16x16x32_bf16 a[188:191], v[40:43], v[52:55], a[188:191]
 v_exp_f32 v21, v61
 s_mov_b32 s38, s4
 s_mov_b32 s4, s5
 s_mov_b32 s5, s6
 s_mov_b32 s6, s38
 v_mfma_f32_16x16x32_bf16 a[248:251], v[36:39], v[56:59], a[248:251]
 v_add_f32 v14, v20, v21
 v_mfma_f32_16x16x32_bf16 a[252:255], v[40:43], v[56:59], a[252:255]
 s_waitcnt lgkmcnt(1)
 ds_read_b128 v[36:39], v0 offset:512
 v_cvt_pk_bf16_f32 v44, v20, v21
 v_mfma_f32_16x16x32_bf16 v[92:95], v[28:31], a[0:3], 0
 s_waitcnt lgkmcnt(1)
 v_exp_f32 v22, v62
 v_mfma_f32_16x16x32_bf16 v[92:95], v[32:35], a[4:7], v[92:95]
 v_exp_f32 v23, v63
 v_mfma_f32_16x16x32_bf16 v[100:103], v[28:31], a[32:35], 0
 v_add_f32 v14, v14, v22
 v_add_f32 v14, v14, v23
 v_mfma_f32_16x16x32_bf16 v[100:103], v[32:35], a[36:39], v[100:103]
 ds_read_b128 v[40:43], v0 offset:576
 v_cvt_pk_bf16_f32 v45, v22, v23
 v_mfma_f32_16x16x32_bf16 v[108:111], v[28:31], a[64:67], 0
 v_exp_f32 v20, v64
 v_mfma_f32_16x16x32_bf16 v[108:111], v[32:35], a[68:71], v[108:111]
 v_exp_f32 v21, v65
 v_mfma_f32_16x16x32_bf16 v[116:119], v[28:31], a[96:99], 0
 v_add_f32 v14, v14, v20
 v_add_f32 v14, v14, v21
 v_mfma_f32_16x16x32_bf16 v[116:119], v[32:35], a[100:103], v[116:119]
 s_waitcnt lgkmcnt(1)
 ds_read_b128 v[28:31], v0 offset:128
 v_cvt_pk_bf16_f32 v46, v20, v21
 v_mfma_f32_16x16x32_bf16 v[96:99], v[36:39], a[0:3], 0
 s_waitcnt lgkmcnt(1)
 v_exp_f32 v22, v66
 v_mfma_f32_16x16x32_bf16 v[96:99], v[40:43], a[4:7], v[96:99]
 v_exp_f32 v23, v67
 v_mfma_f32_16x16x32_bf16 v[104:107], v[36:39], a[32:35], 0
 v_add_f32 v14, v14, v22
 v_add_f32 v14, v14, v23
 v_mfma_f32_16x16x32_bf16 v[104:107], v[40:43], a[36:39], v[104:107]
 ds_read_b128 v[32:35], v0 offset:192
 v_cvt_pk_bf16_f32 v47, v22, v23
 v_mfma_f32_16x16x32_bf16 v[112:115], v[36:39], a[64:67], 0
 v_exp_f32 v20, v68
 v_mfma_f32_16x16x32_bf16 v[112:115], v[40:43], a[68:71], v[112:115]
 v_exp_f32 v21, v69
 v_mfma_f32_16x16x32_bf16 v[120:123], v[36:39], a[96:99], 0
 v_add_f32 v15, v20, v21
 v_mfma_f32_16x16x32_bf16 v[120:123], v[40:43], a[100:103], v[120:123]
 s_waitcnt lgkmcnt(1)
 ds_read_b128 v[36:39], v0 offset:640
 v_cvt_pk_bf16_f32 v48, v20, v21
 v_mfma_f32_16x16x32_bf16 v[92:95], v[28:31], a[8:11], v[92:95]
 s_waitcnt lgkmcnt(1)
 v_exp_f32 v22, v70
 v_mfma_f32_16x16x32_bf16 v[92:95], v[32:35], a[12:15], v[92:95]
 v_exp_f32 v23, v71
 v_mfma_f32_16x16x32_bf16 v[100:103], v[28:31], a[40:43], v[100:103]
 v_add_f32 v15, v15, v22
 v_add_f32 v15, v15, v23
 v_mfma_f32_16x16x32_bf16 v[100:103], v[32:35], a[44:47], v[100:103]
 ds_read_b128 v[40:43], v0 offset:704
 v_cvt_pk_bf16_f32 v49, v22, v23
 v_mfma_f32_16x16x32_bf16 v[108:111], v[28:31], a[72:75], v[108:111]
 v_exp_f32 v20, v72
 v_mfma_f32_16x16x32_bf16 v[108:111], v[32:35], a[76:79], v[108:111]
 v_exp_f32 v21, v73
 v_mfma_f32_16x16x32_bf16 v[116:119], v[28:31], a[104:107], v[116:119]
 v_add_f32 v15, v15, v20
 v_add_f32 v15, v15, v21
 v_mfma_f32_16x16x32_bf16 v[116:119], v[32:35], a[108:111], v[116:119]
 s_waitcnt lgkmcnt(1)
 ds_read_b128 v[28:31], v0 offset:256
 v_cvt_pk_bf16_f32 v50, v20, v21
 v_mfma_f32_16x16x32_bf16 v[96:99], v[36:39], a[8:11], v[96:99]
 s_waitcnt lgkmcnt(1)
 v_exp_f32 v22, v74
 v_mfma_f32_16x16x32_bf16 v[96:99], v[40:43], a[12:15], v[96:99]
 v_exp_f32 v23, v75
 v_mfma_f32_16x16x32_bf16 v[104:107], v[36:39], a[40:43], v[104:107]
 v_add_f32 v15, v15, v22
 v_add_f32 v15, v15, v23
 v_mfma_f32_16x16x32_bf16 v[104:107], v[40:43], a[44:47], v[104:107]
 ds_read_b128 v[32:35], v0 offset:320
 v_cvt_pk_bf16_f32 v51, v22, v23
 v_mfma_f32_16x16x32_bf16 v[112:115], v[36:39], a[72:75], v[112:115]
 v_exp_f32 v20, v76
 v_mfma_f32_16x16x32_bf16 v[112:115], v[40:43], a[76:79], v[112:115]
 v_exp_f32 v21, v77
 v_mfma_f32_16x16x32_bf16 v[120:123], v[36:39], a[104:107], v[120:123]
 v_add_f32 v16, v20, v21
 v_mfma_f32_16x16x32_bf16 v[120:123], v[40:43], a[108:111], v[120:123]
 s_waitcnt lgkmcnt(1)
 ds_read_b128 v[36:39], v0 offset:768
 v_cvt_pk_bf16_f32 v52, v20, v21
 v_mfma_f32_16x16x32_bf16 v[92:95], v[28:31], a[16:19], v[92:95]
 s_waitcnt lgkmcnt(1)
 v_exp_f32 v22, v78
 v_mfma_f32_16x16x32_bf16 v[92:95], v[32:35], a[20:23], v[92:95]
 v_exp_f32 v23, v79
 v_mfma_f32_16x16x32_bf16 v[100:103], v[28:31], a[48:51], v[100:103]
 v_add_f32 v16, v16, v22
 v_add_f32 v16, v16, v23
 v_mfma_f32_16x16x32_bf16 v[100:103], v[32:35], a[52:55], v[100:103]
 ds_read_b128 v[40:43], v0 offset:832
 v_cvt_pk_bf16_f32 v53, v22, v23
 v_mfma_f32_16x16x32_bf16 v[108:111], v[28:31], a[80:83], v[108:111]
 v_exp_f32 v20, v80
 v_mfma_f32_16x16x32_bf16 v[108:111], v[32:35], a[84:87], v[108:111]
 v_exp_f32 v21, v81
 v_mfma_f32_16x16x32_bf16 v[116:119], v[28:31], a[112:115], v[116:119]
 v_add_f32 v16, v16, v20
 v_add_f32 v16, v16, v21
 v_mfma_f32_16x16x32_bf16 v[116:119], v[32:35], a[116:119], v[116:119]
 s_waitcnt lgkmcnt(1)
 ds_read_b128 v[28:31], v0 offset:384
 v_cvt_pk_bf16_f32 v54, v20, v21
 v_mfma_f32_16x16x32_bf16 v[96:99], v[36:39], a[16:19], v[96:99]
 s_waitcnt lgkmcnt(1)
 v_exp_f32 v22, v82
 v_mfma_f32_16x16x32_bf16 v[96:99], v[40:43], a[20:23], v[96:99]
 v_exp_f32 v23, v83
 v_mfma_f32_16x16x32_bf16 v[104:107], v[36:39], a[48:51], v[104:107]
 v_add_f32 v16, v16, v22
 v_add_f32 v16, v16, v23
 v_mfma_f32_16x16x32_bf16 v[104:107], v[40:43], a[52:55], v[104:107]
 ds_read_b128 v[32:35], v0 offset:448
 v_cvt_pk_bf16_f32 v55, v22, v23
 v_mfma_f32_16x16x32_bf16 v[112:115], v[36:39], a[80:83], v[112:115]
 v_exp_f32 v20, v84
 v_mfma_f32_16x16x32_bf16 v[112:115], v[40:43], a[84:87], v[112:115]
 v_exp_f32 v21, v85
 v_mfma_f32_16x16x32_bf16 v[120:123], v[36:39], a[112:115], v[120:123]
 v_add_f32 v17, v20, v21
 v_mfma_f32_16x16x32_bf16 v[120:123], v[40:43], a[116:119], v[120:123]
 s_waitcnt lgkmcnt(1)
 ds_read_b128 v[36:39], v0 offset:896
 v_cvt_pk_bf16_f32 v56, v20, v21
 v_mfma_f32_16x16x32_bf16 v[92:95], v[28:31], a[24:27], v[92:95]
 s_waitcnt lgkmcnt(1)
 v_exp_f32 v22, v86
 v_mfma_f32_16x16x32_bf16 v[92:95], v[32:35], a[28:31], v[92:95]
 v_exp_f32 v23, v87
 v_mfma_f32_16x16x32_bf16 v[100:103], v[28:31], a[56:59], v[100:103]
 v_add_f32 v17, v17, v22
 v_add_f32 v17, v17, v23
 v_mfma_f32_16x16x32_bf16 v[100:103], v[32:35], a[60:63], v[100:103]
 ds_read_b128 v[40:43], v0 offset:960
 v_cvt_pk_bf16_f32 v57, v22, v23
 v_mfma_f32_16x16x32_bf16 v[108:111], v[28:31], a[88:91], v[108:111]
 v_exp_f32 v20, v88
 v_mfma_f32_16x16x32_bf16 v[108:111], v[32:35], a[92:95], v[108:111]
 v_exp_f32 v21, v89
 v_mfma_f32_16x16x32_bf16 v[116:119], v[28:31], a[120:123], v[116:119]
 v_add_f32 v17, v17, v20
 v_add_f32 v17, v17, v21
 v_mfma_f32_16x16x32_bf16 v[116:119], v[32:35], a[124:127], v[116:119]
 s_waitcnt lgkmcnt(1)
 ds_read_b64_tr_b16 v[28:29], v1
 v_cvt_pk_bf16_f32 v58, v20, v21
 v_mfma_f32_16x16x32_bf16 v[96:99], v[36:39], a[24:27], v[96:99]
 s_waitcnt lgkmcnt(1)
 ds_read_b64_tr_b16 v[30:31], v1 offset:512
 v_exp_f32 v22, v90
 v_mfma_f32_16x16x32_bf16 v[96:99], v[40:43], a[28:31], v[96:99]
 v_exp_f32 v23, v91
 v_mfma_f32_16x16x32_bf16 v[104:107], v[36:39], a[56:59], v[104:107]
 v_add_f32 v17, v17, v22
 v_add_f32 v17, v17, v23
 v_mfma_f32_16x16x32_bf16 v[104:107], v[40:43], a[60:63], v[104:107]
 ds_read_b64_tr_b16 v[32:33], v1 offset:32
 v_cvt_pk_bf16_f32 v59, v22, v23
 v_mfma_f32_16x16x32_bf16 v[112:115], v[36:39], a[88:91], v[112:115]
 ds_read_b64_tr_b16 v[34:35], v1 offset:544
 v_max3_f32 v252, v14, v15, v16
 v_max_f32 v252, v252, v17
 v_mfma_f32_16x16x32_bf16 v[112:115], v[40:43], a[92:95], v[112:115]
 v_cmp_lt_f32 vcc, s30, v252
 v_mfma_f32_16x16x32_bf16 v[120:123], v[36:39], a[120:123], v[120:123]
 v_mfma_f32_16x16x32_bf16 v[120:123], v[40:43], a[124:127], v[120:123]
 s_waitcnt lgkmcnt(2)
 ds_read_b64_tr_b16 v[36:37], v1 offset:64
 s_cbranch_vccnz L_rare_F0
L_back_F0:
 s_sub_u32 s54, s6, s5
 s_add_u32 s90, s31, s5
 v_mfma_f32_16x16x32_bf16 v[124:127], v[28:31], v[44:47], v[124:127]
 s_waitcnt vmcnt(12)
 s_barrier
 s_waitcnt lgkmcnt(1)
 ds_read_b64_tr_b16 v[38:39], v1 offset:576
 v_mfma_f32_16x16x32_bf16 v[128:131], v[32:35], v[44:47], v[128:131]
 s_add_u32 s53, s53, 16384
 s_add_u32 m0, s89, 67584
 v_add_f32 v10, v10, v14
 v_add_f32 v11, v11, v15
 v_mfma_f32_16x16x32_bf16 v[188:191], v[28:31], v[48:51], v[188:191]
 buffer_load_dwordx4 v2, s[20:23], s53 offen nt lds
 v_add_f32 v12, v12, v16
 v_mfma_f32_16x16x32_bf16 v[192:195], v[32:35], v[48:51], v[192:195]
 ds_read_b64_tr_b16 v[40:41], v1 offset:96
 v_add_f32 v13, v13, v17
 v_mfma_f32_16x16x32_bf16 a[128:131], v[28:31], v[52:55], a[128:131]
 ds_read_b64_tr_b16 v[42:43], v1 offset:608
 v_mfma_f32_16x16x32_bf16 a[132:135], v[32:35], v[52:55], a[132:135]
 s_add_u32 m0, s89, 68128
 v_mfma_f32_16x16x32_bf16 a[192:195], v[28:31], v[56:59], a[192:195]
 buffer_load_dwordx4 v2, s[20:23], s53 offen offset:512 nt lds
 v_mfma_f32_16x16x32_bf16 a[196:199], v[32:35], v[56:59], a[196:199]
 s_waitcnt lgkmcnt(2)
 ds_read_b64_tr_b16 v[28:29], v1 offset:128
 v_mfma_f32_16x16x32_bf16 v[132:135], v[36:39], v[44:47], v[132:135]
 s_waitcnt lgkmcnt(1)
 ds_read_b64_tr_b16 v[30:31], v1 offset:640
 v_mfma_f32_16x16x32_bf16 v[136:139], v[40:43], v[44:47], v[136:139]
 s_add_u32 m0, s89, 68672
 v_mfma_f32_16x16x32_bf16 v[196:199], v[36:39], v[48:51], v[196:199]
 buffer_load_dwordx4 v2, s[20:23], s53 offen offset:1024 nt lds
 v_mfma_f32_16x16x32_bf16 v[200:203], v[40:43], v[48:51], v[200:203]
 ds_read_b64_tr_b16 v[32:33], v1 offset:160
 v_mfma_f32_16x16x32_bf16 a[136:139], v[36:39], v[52:55], a[136:139]
 ds_read_b64_tr_b16 v[34:35], v1 offset:672
 v_mfma_f32_16x16x32_bf16 a[140:143], v[40:43], v[52:55], a[140:143]
 s_add_u32 m0, s89, 69216
 v_mfma_f32_16x16x32_bf16 a[200:203], v[36:39], v[56:59], a[200:203]
 buffer_load_dwordx4 v2, s[20:23], s53 offen offset:1536 nt lds
 v_mfma_f32_16x16x32_bf16 a[204:207], v[40:43], v[56:59], a[204:207]
 s_waitcnt lgkmcnt(2)
 ds_read_b64_tr_b16 v[36:37], v1 offset:192
 v_mfma_f32_16x16x32_bf16 v[140:143], v[28:31], v[44:47], v[140:143]
 s_waitcnt lgkmcnt(1)
 ds_read_b64_tr_b16 v[38:39], v1 offset:704
 v_mfma_f32_16x16x32_bf16 v[144:147], v[32:35], v[44:47], v[144:147]
 s_add_u32 s52, s52, 16384
 s_add_u32 m0, s90, 0
 v_mfma_f32_16x16x32_bf16 v[204:207], v[28:31], v[48:51], v[204:207]
 buffer_load_dwordx4 v2, s[16:19], s52 offen nt lds
 v_mfma_f32_16x16x32_bf16 v[208:211], v[32:35], v[48:51], v[208:211]
 ds_read_b64_tr_b16 v[40:41], v1 offset:224
 v_mfma_f32_16x16x32_bf16 a[144:147], v[28:31], v[52:55], a[144:147]
 ds_read_b64_tr_b16 v[42:43], v1 offset:736
 v_fma_f32 v92, v92, s29, -v6
 v_mfma_f32_16x16x32_bf16 a[148:151], v[32:35], v[52:55], a[148:151]
 s_add_u32 m0, s90, 544
 v_fma_f32 v93, v93, s29, -v6
 v_fma_f32 v94, v94, s29, -v6
 v_mfma_f32_16x16x32_bf16 a[208:211], v[28:31], v[56:59], a[208:211]
 buffer_load_dwordx4 v2, s[16:19], s52 offen offset:512 nt lds
 v_fma_f32 v95, v95, s29, -v6
 v_mfma_f32_16x16x32_bf16 a[212:215], v[32:35], v[56:59], a[212:215]
 s_waitcnt lgkmcnt(2)
 ds_read_b64_tr_b16 v[28:29], v1 offset:256
 v_fma_f32 v96, v96, s29, -v6
 v_mfma_f32_16x16x32_bf16 v[148:151], v[36:39], v[44:47], v[148:151]
 s_waitcnt lgkmcnt(1)
 ds_read_b64_tr_b16 v[30:31], v1 offset:768
 v_fma_f32 v97, v97, s29, -v6
 v_mfma_f32_16x16x32_bf16 v[152:155], v[40:43], v[44:47], v[152:155]
 s_add_u32 m0, s90, 1088
 v_fma_f32 v98, v98, s29, -v6
 v_fma_f32 v99, v99, s29, -v6
 v_mfma_f32_16x16x32_bf16 v[212:215], v[36:39], v[48:51], v[212:215]
 buffer_load_dwordx4 v2, s[16:19], s52 offen offset:1024 nt lds
 v_fma_f32 v100, v100, s29, -v7
 v_mfma_f32_16x16x32_bf16 v[216:219], v[40:43], v[48:51], v[216:219]
 ds_read_b64_tr_b16 v[32:33], v1 offset:288
 v_fma_f32 v101, v101, s29, -v7
 v_mfma_f32_16x16x32_bf16 a[152:155], v[36:39], v[52:55], a[152:155]
 ds_read_b64_tr_b16 v[34:35], v1 offset:800
 v_fma_f32 v102, v102, s29, -v7
 v_mfma_f32_16x16x32_bf16 a[156:159], v[40:43], v[52:55], a[156:159]
 s_add_u32 m0, s90, 1632
 v_fma_f32 v103, v103, s29, -v7
 v_fma_f32 v104, v104, s29, -v7
 v_mfma_f32_16x16x32_bf16 a[216:219], v[36:39], v[56:59], a[216:219]
 buffer_load_dwordx4 v2, s[16:19], s52 offen offset:1536 nt lds
 v_add_u32 v0, s54, v0
 v_mfma_f32_16x16x32_bf16 a[220:223], v[40:43], v[56:59], a[220:223]
 s_waitcnt lgkmcnt(2)
 ds_read_b64_tr_b16 v[36:37], v1 offset:320
 v_fma_f32 v105, v105, s29, -v7
 v_mfma_f32_16x16x32_bf16 v[156:159], v[28:31], v[44:47], v[156:159]
 s_waitcnt lgkmcnt(1)
 ds_read_b64_tr_b16 v[38:39], v1 offset:832
 v_fma_f32 v106, v106, s29, -v7
 v_mfma_f32_16x16x32_bf16 v[160:163], v[32:35], v[44:47], v[160:163]
 v_fma_f32 v107, v107, s29, -v7
 v_fma_f32 v108, v108, s29, -v8
 v_mfma_f32_16x16x32_bf16 v[220:223], v[28:31], v[48:51], v[220:223]
 v_fma_f32 v109, v109, s29, -v8
 v_fma_f32 v110, v110, s29, -v8
 v_mfma_f32_16x16x32_bf16 v[224:227], v[32:35], v[48:51], v[224:227]
 ds_read_b64_tr_b16 v[40:41], v1 offset:352
 v_fma_f32 v111, v111, s29, -v8
 v_mfma_f32_16x16x32_bf16 a[160:163], v[28:31], v[52:55], a[160:163]
 ds_read_b64_tr_b16 v[42:43], v1 offset:864
 s_bitcmp1_b32 s9, 1
 s_cbranch_scc1 L_o_dr1a
L_b_dr1a:
 v_mfma_f32_16x16x32_bf16 a[164:167], v[32:35], v[52:55], a[164:167]
 v_fma_f32 v112, v112, s29, -v8
 v_fma_f32 v113, v113, s29, -v8
 v_mfma_f32_16x16x32_bf16 a[224:227], v[28:31], v[56:59], a[224:227]
 v_fma_f32 v114, v114, s29, -v8
 v_fma_f32 v115, v115, s29, -v8
 v_mfma_f32_16x16x32_bf16 a[228:231], v[32:35], v[56:59], a[228:231]
 s_waitcnt lgkmcnt(2)
 ds_read_b64_tr_b16 v[28:29], v1 offset:384
 v_fma_f32 v116, v116, s29, -v9
 v_mfma_f32_16x16x32_bf16 v[164:167], v[36:39], v[44:47], v[164:167]
 s_waitcnt lgkmcnt(1)
 ds_read_b64_tr_b16 v[30:31], v1 offset:896
 v_fma_f32 v117, v117, s29, -v9
 v_mfma_f32_16x16x32_bf16 v[168:171], v[40:43], v[44:47], v[168:171]
 v_fma_f32 v118, v118, s29, -v9
 v_fma_f32 v119, v119, s29, -v9
 v_mfma_f32_16x16x32_bf16 v[228:231], v[36:39], v[48:51], v[228:231]
 v_fma_f32 v120, v120, s29, -v9
 v_fma_f32 v121, v121, s29, -v9
 v_mfma_f32_16x16x32_bf16 v[232:235], v[40:43], v[48:51], v[232:235]
 ds_read_b64_tr_b16 v[32:33], v1 offset:416
 v_fma_f32 v122, v122, s29, -v9
 v_mfma_f32_16x16x32_bf16 a[168:171], v[36:39], v[52:55], a[168:171]
 ds_read_b64_tr_b16 v[34:35], v1 offset:928
 v_fma_f32 v123, v123, s29, -v9
 v_mfma_f32_16x16x32_bf16 a[172:175], v[40:43], v[52:55], a[172:175]
 v_mfma_f32_16x16x32_bf16 a[232:235], v[36:39], v[56:59], a[232:235]
 s_bitcmp1_b32 s9, 1
 s_cbranch_scc1 L_o_dr1b
L_b_dr1b:
 v_mfma_f32_16x16x32_bf16 a[236:239], v[40:43], v[56:59], a[236:239]
 s_waitcnt lgkmcnt(2)
 ds_read_b64_tr_b16 v[36:37], v1 offset:448
 v_mfma_f32_16x16x32_bf16 v[172:175], v[28:31], v[44:47], v[172:175]
 s_waitcnt lgkmcnt(1)
 ds_read_b64_tr_b16 v[38:39], v1 offset:960
 v_mfma_f32_16x16x32_bf16 v[176:179], v[32:35], v[44:47], v[176:179]
 v_mfma_f32_16x16x32_bf16 v[236:239], v[28:31], v[48:51], v[236:239]
 v_mfma_f32_16x16x32_bf16 v[240:243], v[32:35], v[48:51], v[240:243]
 ds_read_b64_tr_b16 v[40:41], v1 offset:480
 v_mfma_f32_16x16x32_bf16 a[176:179], v[28:31], v[52:55], a[176:179]
 ds_read_b64_tr_b16 v[42:43], v1 offset:992
 v_mfma_f32_16x16x32_bf16 a[180:183], v[32:35], v[52:55], a[180:183]
 v_mfma_f32_16x16x32_bf16 a[240:243], v[28:31], v[56:59], a[240:243]
 v_add_u32 v1, 16896, v1
 v_mfma_f32_16x16x32_bf16 a[244:247], v[32:35], v[56:59], a[244:247]
 s_waitcnt lgkmcnt(2)
 ds_read_b128 v[28:31], v0
 v_mfma_f32_16x16x32_bf16 v[180:183], v[36:39], v[44:47], v[180:183]
 s_waitcnt lgkmcnt(1)
 v_mfma_f32_16x16x32_bf16 v[184:187], v[40:43], v[44:47], v[184:187]
 v_mfma_f32_16x16x32_bf16 v[244:247], v[36:39], v[48:51], v[244:247]
 v_mfma_f32_16x16x32_bf16 v[248:251], v[40:43], v[48:51], v[248:251]
 ds_read_b128 v[32:35], v0 offset:64
 v_mfma_f32_16x16x32_bf16 a[184:187], v[36:39], v[52:55], a[184:187]
 v_exp_f32 v20, v92
 v_mfma_f32_16x16x32_bf16 a[188:191], v[40:43], v[52:55], a[188:191]
 v_exp_f32 v21, v93
 s_mov_b32 s38, s4
 s_mov_b32 s4, s5
 s_mov_b32 s5, s6
 s_mov_b32 s6, s38
 s_xor_b32 s88, s88, 33792
 s_xor_b32 s55, s55, 4294932480
 v_mfma_f32_16x16x32_bf16 a[248:251], v[36:39], v[56:59], a[248:251]
 v_add_f32 v14, v20, v21
 v_mfma_f32_16x16x32_bf16 a[252:255], v[40:43], v[56:59], a[252:255]
 s_waitcnt lgkmcnt(1)
 ds_read_b128 v[36:39], v0 offset:512
 v_cvt_pk_bf16_f32 v44, v20, v21
 s_sub_u32 s91, s91, 1
 s_cmp_lg_u32 s91, 0
 s_cselect_b32 s91, s91, 3
 s_cbranch_scc1 L_first
.p2align 3
L_loop:
 v_mfma_f32_16x16x32_bf16 v[60:63], v[28:31], a[0:3], 0
 s_waitcnt lgkmcnt(1)
 v_exp_f32 v22, v94
 v_mfma_f32_16x16x32_bf16 v[60:63], v[32:35], a[4:7], v[60:63]
 v_exp_f32 v23, v95
 v_mfma_f32_16x16x32_bf16 v[68:71], v[28:31], a[32:35], 0
 v_add_f32 v14, v14, v22
 v_add_f32 v14, v14, v23
 v_mfma_f32_16x16x32_bf16 v[68:71], v[32:35], a[36:39], v[68:71]
 ds_read_b128 v[40:43], v0 offset:576
 v_cvt_pk_bf16_f32 v45, v22, v23
 v_mfma_f32_16x16x32_bf16 v[76:79], v[28:31], a[64:67], 0
 v_exp_f32 v20, v96
 v_mfma_f32_16x16x32_bf16 v[76:79], v[32:35], a[68:71], v[76:79]
 v_exp_f32 v21, v97
 v_mfma_f32_16x16x32_bf16 v[84:87], v[28:31], a[96:99], 0
 v_add_f32 v14, v14, v20
 v_add_f32 v14, v14, v21
 v_mfma_f32_16x16x32_bf16 v[84:87], v[32:35], a[100:103], v[84:87]
 s_waitcnt lgkmcnt(1)
 ds_read_b128 v[28:31], v0 offset:128
 v_cvt_pk_bf16_f32 v46, v20, v21
 v_mfma_f32_16x16x32_bf16 v[64:67], v[36:39], a[0:3], 0
 s_waitcnt lgkmcnt(1)
 v_exp_f32 v22, v98
 v_mfma_f32_16x16x32_bf16 v[64:67], v[40:43], a[4:7], v[64:67]
 v_exp_f32 v23, v99
 v_mfma_f32_16x16x32_bf16 v[72:75], v[36:39], a[32:35], 0
 v_add_f32 v14, v14, v22
 v_add_f32 v14, v14, v23
 v_mfma_f32_16x16x32_bf16 v[72:75], v[40:43], a[36:39], v[72:75]
 ds_read_b128 v[32:35], v0 offset:192
 v_cvt_pk_bf16_f32 v47, v22, v23
 v_mfma_f32_16x16x32_bf16 v[80:83], v[36:39], a[64:67], 0
 v_exp_f32 v20, v100
 v_mfma_f32_16x16x32_bf16 v[80:83], v[40:43], a[68:71], v[80:83]
 v_exp_f32 v21, v101
 v_mfma_f32_16x16x32_bf16 v[88:91], v[36:39], a[96:99], 0
 v_add_f32 v15, v20, v21
 v_mfma_f32_16x16x32_bf16 v[88:91], v[40:43], a[100:103], v[88:91]
 s_waitcnt lgkmcnt(1)
 ds_read_b128 v[36:39], v0 offset:640
 v_cvt_pk_bf16_f32 v48, v20, v21
 v_mfma_f32_16x16x32_bf16 v[60:63], v[28:31], a[8:11], v[60:63]
 s_waitcnt lgkmcnt(1)
 v_exp_f32 v22, v102
 v_mfma_f32_16x16x32_bf16 v[60:63], v[32:35], a[12:15], v[60:63]
 v_exp_f32 v23, v103
 v_mfma_f32_16x16x32_bf16 v[68:71], v[28:31], a[40:43], v[68:71]
 v_add_f32 v15, v15, v22
 v_add_f32 v15, v15, v23
 v_mfma_f32_16x16x32_bf16 v[68:71], v[32:35], a[44:47], v[68:71]
 ds_read_b128 v[40:43], v0 offset:704
 v_cvt_pk_bf16_f32 v49, v22, v23
 v_mfma_f32_16x16x32_bf16 v[76:79], v[28:31], a[72:75], v[76:79]
 v_exp_f32 v20, v104
 v_mfma_f32_16x16x32_bf16 v[76:79], v[32:35], a[76:79], v[76:79]
 v_exp_f32 v21, v105
 v_mfma_f32_16x16x32_bf16 v[84:87], v[28:31], a[104:107], v[84:87]
 v_add_f32 v15, v15, v20
 v_add_f32 v15, v15, v21
 v_mfma_f32_16x16x32_bf16 v[84:87], v[32:35], a[108:111], v[84:87]
 s_waitcnt lgkmcnt(1)
 ds_read_b128 v[28:31], v0 offset:256
 v_cvt_pk_bf16_f32 v50, v20, v21
 v_mfma_f32_16x16x32_bf16 v[64:67], v[36:39], a[8:11], v[64:67]
 s_waitcnt lgkmcnt(1)
 v_exp_f32 v22, v106
 v_mfma_f32_16x16x32_bf16 v[64:67], v[40:43], a[12:15], v[64:67]
 v_exp_f32 v23, v107
 v_mfma_f32_16x16x32_bf16 v[72:75], v[36:39], a[40:43], v[72:75]
 v_add_f32 v15, v15, v22
 v_add_f32 v15, v15, v23
 v_mfma_f32_16x16x32_bf16 v[72:75], v[40:43], a[44:47], v[72:75]
 ds_read_b128 v[32:35], v0 offset:320
 v_cvt_pk_bf16_f32 v51, v22, v23
 v_mfma_f32_16x16x32_bf16 v[80:83], v[36:39], a[72:75], v[80:83]
 v_exp_f32 v20, v108
 v_mfma_f32_16x16x32_bf16 v[80:83], v[40:43], a[76:79], v[80:83]
 v_exp_f32 v21, v109
 v_mfma_f32_16x16x32_bf16 v[88:91], v[36:39], a[104:107], v[88:91]
 v_add_f32 v16, v20, v21
 v_mfma_f32_16x16x32_bf16 v[88:91], v[40:43], a[108:111], v[88:91]
 s_waitcnt lgkmcnt(1)
 ds_read_b128 v[36:39], v0 offset:768
 v_cvt_pk_bf16_f32 v52, v20, v21
 v_mfma_f32_16x16x32_bf16 v[60:63], v[28:31], a[16:19], v[60:63]
 s_waitcnt lgkmcnt(1)
 v_exp_f32 v22, v110
 v_mfma_f32_16x16x32_bf16 v[60:63], v[32:35], a[20:23], v[60:63]
 v_exp_f32 v23, v111
 v_mfma_f32_16x16x32_bf16 v[68:71], v[28:31], a[48:51], v[68:71]
 v_add_f32 v16, v16, v22
 v_add_f32 v16, v16, v23
 v_mfma_f32_16x16x32_bf16 v[68:71], v[32:35], a[52:55], v[68:71]
 ds_read_b128 v[40:43], v0 offset:832
 v_cvt_pk_bf16_f32 v53, v22, v23
 v_mfma_f32_16x16x32_bf16 v[76:79], v[28:31], a[80:83], v[76:79]
 v_exp_f32 v20, v112
 v_mfma_f32_16x16x32_bf16 v[76:79], v[32:35], a[84:87], v[76:79]
 v_exp_f32 v21, v113
 v_mfma_f32_16x16x32_bf16 v[84:87], v[28:31], a[112:115], v[84:87]
 v_add_f32 v16, v16, v20
 v_add_f32 v16, v16, v21
 v_mfma_f32_16x16x32_bf16 v[84:87], v[32:35], a[116:119], v[84:87]
 s_waitcnt lgkmcnt(1)
 ds_read_b128 v[28:31], v0 offset:384
 v_cvt_pk_bf16_f32 v54, v20, v21
 v_mfma_f32_16x16x32_bf16 v[64:67], v[36:39], a[16:19], v[64:67]
 s_waitcnt lgkmcnt(1)
 v_exp_f32 v22, v114
 v_mfma_f32_16x16x32_bf16 v[64:67], v[40:43], a[20:23], v[64:67]
 v_exp_f32 v23, v115
 v_mfma_f32_16x16x32_bf16 v[72:75], v[36:39], a[48:51], v[72:75]
 v_add_f32 v16, v16, v22
 v_add_f32 v16, v16, v23
 v_mfma_f32_16x16x32_bf16 v[72:75], v[40:43], a[52:55], v[72:75]
 ds_read_b128 v[32:35], v0 offset:448
 v_cvt_pk_bf16_f32 v55, v22, v23
 v_mfma_f32_16x16x32_bf16 v[80:83], v[36:39], a[80:83], v[80:83]
 v_exp_f32 v20, v116
 v_mfma_f32_16x16x32_bf16 v[80:83], v[40:43], a[84:87], v[80:83]
 v_exp_f32 v21, v117
 v_mfma_f32_16x16x32_bf16 v[88:91], v[36:39], a[112:115], v[88:91]
 v_add_f32 v17, v20, v21
 v_mfma_f32_16x16x32_bf16 v[88:91], v[40:43], a[116:119], v[88:91]
 s_waitcnt lgkmcnt(1)
 ds_read_b128 v[36:39], v0 offset:896
 v_cvt_pk_bf16_f32 v56, v20, v21
 v_mfma_f32_16x16x32_bf16 v[60:63], v[28:31], a[24:27], v[60:63]
 s_waitcnt lgkmcnt(1)
 v_exp_f32 v22, v118
 v_mfma_f32_16x16x32_bf16 v[60:63], v[32:35], a[28:31], v[60:63]
 v_exp_f32 v23, v119
 v_mfma_f32_16x16x32_bf16 v[68:71], v[28:31], a[56:59], v[68:71]
 v_add_f32 v17, v17, v22
 v_add_f32 v17, v17, v23
 v_mfma_f32_16x16x32_bf16 v[68:71], v[32:35], a[60:63], v[68:71]
 ds_read_b128 v[40:43], v0 offset:960
 v_cvt_pk_bf16_f32 v57, v22, v23
 v_mfma_f32_16x16x32_bf16 v[76:79], v[28:31], a[88:91], v[76:79]
 v_exp_f32 v20, v120
 v_mfma_f32_16x16x32_bf16 v[76:79], v[32:35], a[92:95], v[76:79]
 v_exp_f32 v21, v121
 v_mfma_f32_16x16x32_bf16 v[84:87], v[28:31], a[120:123], v[84:87]
 v_add_f32 v17, v17, v20
 v_add_f32 v17, v17, v21
 v_mfma_f32_16x16x32_bf16 v[84:87], v[32:35], a[124:127], v[84:87]
 s_waitcnt lgkmcnt(1)
 ds_read_b64_tr_b16 v[28:29], v1
 v_cvt_pk_bf16_f32 v58, v20, v21
 v_mfma_f32_16x16x32_bf16 v[64:67], v[36:39], a[24:27], v[64:67]
 s_waitcnt lgkmcnt(1)
 ds_read_b64_tr_b16 v[30:31], v1 offset:512
 v_exp_f32 v22, v122
 v_mfma_f32_16x16x32_bf16 v[64:67], v[40:43], a[28:31], v[64:67]
 v_exp_f32 v23, v123
 v_mfma_f32_16x16x32_bf16 v[72:75], v[36:39], a[56:59], v[72:75]
 v_add_f32 v17, v17, v22
 v_add_f32 v17, v17, v23
 v_mfma_f32_16x16x32_bf16 v[72:75], v[40:43], a[60:63], v[72:75]
 ds_read_b64_tr_b16 v[32:33], v1 offset:32
 v_cvt_pk_bf16_f32 v59, v22, v23
 v_mfma_f32_16x16x32_bf16 v[80:83], v[36:39], a[88:91], v[80:83]
 ds_read_b64_tr_b16 v[34:35], v1 offset:544
 v_max3_f32 v252, v14, v15, v16
 v_max_f32 v252, v252, v17
 v_mfma_f32_16x16x32_bf16 v[80:83], v[40:43], a[92:95], v[80:83]
 v_cmp_lt_f32 vcc, s30, v252
 v_mfma_f32_16x16x32_bf16 v[88:91], v[36:39], a[120:123], v[88:91]
 v_mfma_f32_16x16x32_bf16 v[88:91], v[40:43], a[124:127], v[88:91]
 s_waitcnt lgkmcnt(2)
 ds_read_b64_tr_b16 v[36:37], v1 offset:64
 s_cbranch_vccnz L_rare_L1
L_back_L1:
 s_sub_u32 s54, s6, s5
 s_add_u32 s90, s31, s5
 s_add_u32 s89, s31, s88
 v_mfma_f32_16x16x32_bf16 v[124:127], v[28:31], v[44:47], v[124:127]
 s_waitcnt vmcnt(8)
 s_barrier
 s_waitcnt lgkmcnt(1)
 ds_read_b64_tr_b16 v[38:39], v1 offset:576
 v_mfma_f32_16x16x32_bf16 v[128:131], v[32:35], v[44:47], v[128:131]
 s_add_u32 s53, s53, 16384
 s_add_u32 m0, s89, 50688
 v_add_f32 v10, v10, v14
 v_add_f32 v11, v11, v15
 v_mfma_f32_16x16x32_bf16 v[188:191], v[28:31], v[48:51], v[188:191]
 buffer_load_dwordx4 v2, s[20:23], s53 offen nt lds
 v_add_f32 v12, v12, v16
 v_mfma_f32_16x16x32_bf16 v[192:195], v[32:35], v[48:51], v[192:195]
 ds_read_b64_tr_b16 v[40:41], v1 offset:96
 v_add_f32 v13, v13, v17
 v_mfma_f32_16x16x32_bf16 a[128:131], v[28:31], v[52:55], a[128:131]
 ds_read_b64_tr_b16 v[42:43], v1 offset:608
 v_mfma_f32_16x16x32_bf16 a[132:135], v[32:35], v[52:55], a[132:135]
 s_add_u32 m0, s89, 51232
 v_mfma_f32_16x16x32_bf16 a[192:195], v[28:31], v[56:59], a[192:195]
 buffer_load_dwordx4 v2, s[20:23], s53 offen offset:512 nt lds
 v_mfma_f32_16x16x32_bf16 a[196:199], v[32:35], v[56:59], a[196:199]
 s_waitcnt lgkmcnt(2)
 ds_read_b64_tr_b16 v[28:29], v1 offset:128
 v_mfma_f32_16x16x32_bf16 v[132:135], v[36:39], v[44:47], v[132:135]
 s_waitcnt lgkmcnt(1)
 ds_read_b64_tr_b16 v[30:31], v1 offset:640
 v_mfma_f32_16x16x32_bf16 v[136:139], v[40:43], v[44:47], v[136:139]
 s_add_u32 m0, s89, 51776
 v_mfma_f32_16x16x32_bf16 v[196:199], v[36:39], v[48:51], v[196:199]
 buffer_load_dwordx4 v2, s[20:23], s53 offen offset:1024 nt lds
 v_mfma_f32_16x16x32_bf16 v[200:203], v[40:43], v[48:51], v[200:203]
 ds_read_b64_tr_b16 v[32:33], v1 offset:160
 v_mfma_f32_16x16x32_bf16 a[136:139], v[36:39], v[52:55], a[136:139]
 ds_read_b64_tr_b16 v[34:35], v1 offset:672
 v_mfma_f32_16x16x32_bf16 a[140:143], v[40:43], v[52:55], a[140:143]
 s_add_u32 m0, s89, 52320
 v_mfma_f32_16x16x32_bf16 a[200:203], v[36:39], v[56:59], a[200:203]
 buffer_load_dwordx4 v2, s[20:23], s53 offen offset:1536 nt lds
 v_mfma_f32_16x16x32_bf16 a[204:207], v[40:43], v[56:59], a[204:207]
 s_waitcnt lgkmcnt(2)
 ds_read_b64_tr_b16 v[36:37], v1 offset:192
 v_mfma_f32_16x16x32_bf16 v[140:143], v[28:31], v[44:47], v[140:143]
 s_waitcnt lgkmcnt(1)
 ds_read_b64_tr_b16 v[38:39], v1 offset:704
 v_mfma_f32_16x16x32_bf16 v[144:147], v[32:35], v[44:47], v[144:147]
 s_add_u32 s52, s52, 16384
 s_add_u32 m0, s90, 0
 v_mfma_f32_16x16x32_bf16 v[204:207], v[28:31], v[48:51], v[204:207]
 buffer_load_dwordx4 v2, s[16:19], s52 offen nt lds
 v_mfma_f32_16x16x32_bf16 v[208:211], v[32:35], v[48:51], v[208:211]
 ds_read_b64_tr_b16 v[40:41], v1 offset:224
 v_mfma_f32_16x16x32_bf16 a[144:147], v[28:31], v[52:55], a[144:147]
 ds_read_b64_tr_b16 v[42:43], v1 offset:736
 v_fma_f32 v60, v60, s29, -v6
 v_mfma_f32_16x16x32_bf16 a[148:151], v[32:35], v[52:55], a[148:151]
 s_add_u32 m0, s90, 544
 v_fma_f32 v61, v61, s29, -v6
 v_fma_f32 v62, v62, s29, -v6
 v_mfma_f32_16x16x32_bf16 a[208:211], v[28:31], v[56:59], a[208:211]
 buffer_load_dwordx4 v2, s[16:19], s52 offen offset:512 nt lds
 v_fma_f32 v63, v63, s29, -v6
 v_mfma_f32_16x16x32_bf16 a[212:215], v[32:35], v[56:59], a[212:215]
 s_waitcnt lgkmcnt(2)
 ds_read_b64_tr_b16 v[28:29], v1 offset:256
 v_fma_f32 v64, v64, s29, -v6
 v_mfma_f32_16x16x32_bf16 v[148:151], v[36:39], v[44:47], v[148:151]
 s_waitcnt lgkmcnt(1)
 ds_read_b64_tr_b16 v[30:31], v1 offset:768
 v_fma_f32 v65, v65, s29, -v6
 v_mfma_f32_16x16x32_bf16 v[152:155], v[40:43], v[44:47], v[152:155]
 s_add_u32 m0, s90, 1088
 v_fma_f32 v66, v66, s29, -v6
 v_fma_f32 v67, v67, s29, -v6
 v_mfma_f32_16x16x32_bf16 v[212:215], v[36:39], v[48:51], v[212:215]
 buffer_load_dwordx4 v2, s[16:19], s52 offen offset:1024 nt lds
 v_fma_f32 v68, v68, s29, -v7
 v_mfma_f32_16x16x32_bf16 v[216:219], v[40:43], v[48:51], v[216:219]
 ds_read_b64_tr_b16 v[32:33], v1 offset:288
 v_fma_f32 v69, v69, s29, -v7
 v_mfma_f32_16x16x32_bf16 a[152:155], v[36:39], v[52:55], a[152:155]
 ds_read_b64_tr_b16 v[34:35], v1 offset:800
 v_fma_f32 v70, v70, s29, -v7
 v_mfma_f32_16x16x32_bf16 a[156:159], v[40:43], v[52:55], a[156:159]
 s_add_u32 m0, s90, 1632
 v_fma_f32 v71, v71, s29, -v7
 v_fma_f32 v72, v72, s29, -v7
 v_mfma_f32_16x16x32_bf16 a[216:219], v[36:39], v[56:59], a[216:219]
 buffer_load_dwordx4 v2, s[16:19], s52 offen offset:1536 nt lds
 v_add_u32 v0, s54, v0
 v_mfma_f32_16x16x32_bf16 a[220:223], v[40:43], v[56:59], a[220:223]
 s_waitcnt lgkmcnt(2)
 ds_read_b64_tr_b16 v[36:37], v1 offset:320
 v_fma_f32 v73, v73, s29, -v7
 v_mfma_f32_16x16x32_bf16 v[156:159], v[28:31], v[44:47], v[156:159]
 s_waitcnt lgkmcnt(1)
 ds_read_b64_tr_b16 v[38:39], v1 offset:832
 v_fma_f32 v74, v74, s29, -v7
 v_mfma_f32_16x16x32_bf16 v[160:163], v[32:35], v[44:47], v[160:163]
 v_fma_f32 v75, v75, s29, -v7
 v_fma_f32 v76, v76, s29, -v8
 v_mfma_f32_16x16x32_bf16 v[220:223], v[28:31], v[48:51], v[220:223]
 v_fma_f32 v77, v77, s29, -v8
 v_fma_f32 v78, v78, s29, -v8
 v_mfma_f32_16x16x32_bf16 v[224:227], v[32:35], v[48:51], v[224:227]
 ds_read_b64_tr_b16 v[40:41], v1 offset:352
 v_fma_f32 v79, v79, s29, -v8
 v_mfma_f32_16x16x32_bf16 a[160:163], v[28:31], v[52:55], a[160:163]
 ds_read_b64_tr_b16 v[42:43], v1 offset:864
 v_fma_f32 v80, v80, s29, -v8
 v_mfma_f32_16x16x32_bf16 a[164:167], v[32:35], v[52:55], a[164:167]
 v_fma_f32 v81, v81, s29, -v8
 v_fma_f32 v82, v82, s29, -v8
 v_mfma_f32_16x16x32_bf16 a[224:227], v[28:31], v[56:59], a[224:227]
 v_fma_f32 v83, v83, s29, -v8
 v_fma_f32 v84, v84, s29, -v9
 v_mfma_f32_16x16x32_bf16 a[228:231], v[32:35], v[56:59], a[228:231]
 s_waitcnt lgkmcnt(2)
 ds_read_b64_tr_b16 v[28:29], v1 offset:384
 v_fma_f32 v85, v85, s29, -v9
 v_mfma_f32_16x16x32_bf16 v[164:167], v[36:39], v[44:47], v[164:167]
 s_waitcnt lgkmcnt(1)
 ds_read_b64_tr_b16 v[30:31], v1 offset:896
 v_fma_f32 v86, v86, s29, -v9
 v_mfma_f32_16x16x32_bf16 v[168:171], v[40:43], v[44:47], v[168:171]
 v_fma_f32 v87, v87, s29, -v9
 v_fma_f32 v88, v88, s29, -v9
 v_mfma_f32_16x16x32_bf16 v[228:231], v[36:39], v[48:51], v[228:231]
 v_fma_f32 v89, v89, s29, -v9
 v_fma_f32 v90, v90, s29, -v9
 v_mfma_f32_16x16x32_bf16 v[232:235], v[40:43], v[48:51], v[232:235]
 ds_read_b64_tr_b16 v[32:33], v1 offset:416
 v_fma_f32 v91, v91, s29, -v9
 v_mfma_f32_16x16x32_bf16 a[168:171], v[36:39], v[52:55], a[168:171]
 ds_read_b64_tr_b16 v[34:35], v1 offset:928
 v_mfma_f32_16x16x32_bf16 a[172:175], v[40:43], v[52:55], a[172:175]
 v_mfma_f32_16x16x32_bf16 a[232:235], v[36:39], v[56:59], a[232:235]
 v_mfma_f32_16x16x32_bf16 a[236:239], v[40:43], v[56:59], a[236:239]
 s_waitcnt lgkmcnt(2)
 ds_read_b64_tr_b16 v[36:37], v1 offset:448
 v_mfma_f32_16x16x32_bf16 v[172:175], v[28:31], v[44:47], v[172:175]
 s_waitcnt lgkmcnt(1)
 ds_read_b64_tr_b16 v[38:39], v1 offset:960
 v_mfma_f32_16x16x32_bf16 v[176:179], v[32:35], v[44:47], v[176:179]
 v_mfma_f32_16x16x32_bf16 v[236:239], v[28:31], v[48:51], v[236:239]
 v_mfma_f32_16x16x32_bf16 v[240:243], v[32:35], v[48:51], v[240:243]
 ds_read_b64_tr_b16 v[40:41], v1 offset:480
 v_mfma_f32_16x16x32_bf16 a[176:179], v[28:31], v[52:55], a[176:179]
 ds_read_b64_tr_b16 v[42:43], v1 offset:992
 v_mfma_f32_16x16x32_bf16 a[180:183], v[32:35], v[52:55], a[180:183]
 v_mfma_f32_16x16x32_bf16 a[240:243], v[28:31], v[56:59], a[240:243]
 v_add_u32 v1, s55, v1
 v_mfma_f32_16x16x32_bf16 a[244:247], v[32:35], v[56:59], a[244:247]
 s_waitcnt lgkmcnt(2)
 ds_read_b128 v[28:31], v0
 v_mfma_f32_16x16x32_bf16 v[180:183], v[36:39], v[44:47], v[180:183]
 s_waitcnt lgkmcnt(1)
 v_mfma_f32_16x16x32_bf16 v[184:187], v[40:43], v[44:47], v[184:187]
 v_mfma_f32_16x16x32_bf16 v[244:247], v[36:39], v[48:51], v[244:247]
 v_mfma_f32_16x16x32_bf16 v[248:251], v[40:43], v[48:51], v[248:251]
 ds_read_b128 v[32:35], v0 offset:64
 v_mfma_f32_16x16x32_bf16 a[184:187], v[36:39], v[52:55], a[184:187]
 v_exp_f32 v20, v60
 v_mfma_f32_16x16x32_bf16 a[188:191], v[40:43], v[52:55], a[188:191]
 v_exp_f32 v21, v61
 s_mov_b32 s38, s4
 s_mov_b32 s4, s5
 s_mov_b32 s5, s6
 s_mov_b32 s6, s38
 v_mfma_f32_16x16x32_bf16 a[248:251], v[36:39], v[56:59], a[248:251]
 v_add_f32 v14, v20, v21
 v_mfma_f32_16x16x32_bf16 a[252:255], v[40:43], v[56:59], a[252:255]
 s_waitcnt lgkmcnt(1)
 ds_read_b128 v[36:39], v0 offset:512
 v_cvt_pk_bf16_f32 v44, v20, v21
 v_mfma_f32_16x16x32_bf16 v[92:95], v[28:31], a[0:3], 0
 s_waitcnt lgkmcnt(1)
 v_exp_f32 v22, v62
 v_mfma_f32_16x16x32_bf16 v[92:95], v[32:35], a[4:7], v[92:95]
 v_exp_f32 v23, v63
 v_mfma_f32_16x16x32_bf16 v[100:103], v[28:31], a[32:35], 0
 v_add_f32 v14, v14, v22
 v_add_f32 v14, v14, v23
 v_mfma_f32_16x16x32_bf16 v[100:103], v[32:35], a[36:39], v[100:103]
 ds_read_b128 v[40:43], v0 offset:576
 v_cvt_pk_bf16_f32 v45, v22, v23
 v_mfma_f32_16x16x32_bf16 v[108:111], v[28:31], a[64:67], 0
 v_exp_f32 v20, v64
 v_mfma_f32_16x16x32_bf16 v[108:111], v[32:35], a[68:71], v[108:111]
 v_exp_f32 v21, v65
 v_mfma_f32_16x16x32_bf16 v[116:119], v[28:31], a[96:99], 0
 v_add_f32 v14, v14, v20
 v_add_f32 v14, v14, v21
 v_mfma_f32_16x16x32_bf16 v[116:119], v[32:35], a[100:103], v[116:119]
 s_waitcnt lgkmcnt(1)
 ds_read_b128 v[28:31], v0 offset:128
 v_cvt_pk_bf16_f32 v46, v20, v21
 v_mfma_f32_16x16x32_bf16 v[96:99], v[36:39], a[0:3], 0
 s_waitcnt lgkmcnt(1)
 v_exp_f32 v22, v66
 v_mfma_f32_16x16x32_bf16 v[96:99], v[40:43], a[4:7], v[96:99]
 v_exp_f32 v23, v67
 v_mfma_f32_16x16x32_bf16 v[104:107], v[36:39], a[32:35], 0
 v_add_f32 v14, v14, v22
 v_add_f32 v14, v14, v23
 v_mfma_f32_16x16x32_bf16 v[104:107], v[40:43], a[36:39], v[104:107]
 ds_read_b128 v[32:35], v0 offset:192
 v_cvt_pk_bf16_f32 v47, v22, v23
 v_mfma_f32_16x16x32_bf16 v[112:115], v[36:39], a[64:67], 0
 v_exp_f32 v20, v68
 v_mfma_f32_16x16x32_bf16 v[112:115], v[40:43], a[68:71], v[112:115]
 v_exp_f32 v21, v69
 v_mfma_f32_16x16x32_bf16 v[120:123], v[36:39], a[96:99], 0
 v_add_f32 v15, v20, v21
 v_mfma_f32_16x16x32_bf16 v[120:123], v[40:43], a[100:103], v[120:123]
 s_waitcnt lgkmcnt(1)
 ds_read_b128 v[36:39], v0 offset:640
 v_cvt_pk_bf16_f32 v48, v20, v21
 v_mfma_f32_16x16x32_bf16 v[92:95], v[28:31], a[8:11], v[92:95]
 s_waitcnt lgkmcnt(1)
 v_exp_f32 v22, v70
 v_mfma_f32_16x16x32_bf16 v[92:95], v[32:35], a[12:15], v[92:95]
 v_exp_f32 v23, v71
 v_mfma_f32_16x16x32_bf16 v[100:103], v[28:31], a[40:43], v[100:103]
 v_add_f32 v15, v15, v22
 v_add_f32 v15, v15, v23
 v_mfma_f32_16x16x32_bf16 v[100:103], v[32:35], a[44:47], v[100:103]
 ds_read_b128 v[40:43], v0 offset:704
 v_cvt_pk_bf16_f32 v49, v22, v23
 v_mfma_f32_16x16x32_bf16 v[108:111], v[28:31], a[72:75], v[108:111]
 v_exp_f32 v20, v72
 v_mfma_f32_16x16x32_bf16 v[108:111], v[32:35], a[76:79], v[108:111]
 v_exp_f32 v21, v73
 v_mfma_f32_16x16x32_bf16 v[116:119], v[28:31], a[104:107], v[116:119]
 v_add_f32 v15, v15, v20
 v_add_f32 v15, v15, v21
 v_mfma_f32_16x16x32_bf16 v[116:119], v[32:35], a[108:111], v[116:119]
 s_waitcnt lgkmcnt(1)
 ds_read_b128 v[28:31], v0 offset:256
 v_cvt_pk_bf16_f32 v50, v20, v21
 v_mfma_f32_16x16x32_bf16 v[96:99], v[36:39], a[8:11], v[96:99]
 s_waitcnt lgkmcnt(1)
 v_exp_f32 v22, v74
 v_mfma_f32_16x16x32_bf16 v[96:99], v[40:43], a[12:15], v[96:99]
 v_exp_f32 v23, v75
 v_mfma_f32_16x16x32_bf16 v[104:107], v[36:39], a[40:43], v[104:107]
 v_add_f32 v15, v15, v22
 v_add_f32 v15, v15, v23
 v_mfma_f32_16x16x32_bf16 v[104:107], v[40:43], a[44:47], v[104:107]
 ds_read_b128 v[32:35], v0 offset:320
 v_cvt_pk_bf16_f32 v51, v22, v23
 v_mfma_f32_16x16x32_bf16 v[112:115], v[36:39], a[72:75], v[112:115]
 v_exp_f32 v20, v76
 v_mfma_f32_16x16x32_bf16 v[112:115], v[40:43], a[76:79], v[112:115]
 v_exp_f32 v21, v77
 v_mfma_f32_16x16x32_bf16 v[120:123], v[36:39], a[104:107], v[120:123]
 v_add_f32 v16, v20, v21
 v_mfma_f32_16x16x32_bf16 v[120:123], v[40:43], a[108:111], v[120:123]
 s_waitcnt lgkmcnt(1)
 ds_read_b128 v[36:39], v0 offset:768
 v_cvt_pk_bf16_f32 v52, v20, v21
 v_mfma_f32_16x16x32_bf16 v[92:95], v[28:31], a[16:19], v[92:95]
 s_waitcnt lgkmcnt(1)
 v_exp_f32 v22, v78
 v_mfma_f32_16x16x32_bf16 v[92:95], v[32:35], a[20:23], v[92:95]
 v_exp_f32 v23, v79
 v_mfma_f32_16x16x32_bf16 v[100:103], v[28:31], a[48:51], v[100:103]
 v_add_f32 v16, v16, v22
 v_add_f32 v16, v16, v23
 v_mfma_f32_16x16x32_bf16 v[100:103], v[32:35], a[52:55], v[100:103]
 ds_read_b128 v[40:43], v0 offset:832
 v_cvt_pk_bf16_f32 v53, v22, v23
 v_mfma_f32_16x16x32_bf16 v[108:111], v[28:31], a[80:83], v[108:111]
 v_exp_f32 v20, v80
 v_mfma_f32_16x16x32_bf16 v[108:111], v[32:35], a[84:87], v[108:111]
 v_exp_f32 v21, v81
 v_mfma_f32_16x16x32_bf16 v[116:119], v[28:31], a[112:115], v[116:119]
 v_add_f32 v16, v16, v20
 v_add_f32 v16, v16, v21
 v_mfma_f32_16x16x32_bf16 v[116:119], v[32:35], a[116:119], v[116:119]
 s_waitcnt lgkmcnt(1)
 ds_read_b128 v[28:31], v0 offset:384
 v_cvt_pk_bf16_f32 v54, v20, v21
 v_mfma_f32_16x16x32_bf16 v[96:99], v[36:39], a[16:19], v[96:99]
 s_waitcnt lgkmcnt(1)
 v_exp_f32 v22, v82
 v_mfma_f32_16x16x32_bf16 v[96:99], v[40:43], a[20:23], v[96:99]
 v_exp_f32 v23, v83
 v_mfma_f32_16x16x32_bf16 v[104:107], v[36:39], a[48:51], v[104:107]
 v_add_f32 v16, v16, v22
 v_add_f32 v16, v16, v23
 v_mfma_f32_16x16x32_bf16 v[104:107], v[40:43], a[52:55], v[104:107]
 ds_read_b128 v[32:35], v0 offset:448
 v_cvt_pk_bf16_f32 v55, v22, v23
 v_mfma_f32_16x16x32_bf16 v[112:115], v[36:39], a[80:83], v[112:115]
 v_exp_f32 v20, v84
 v_mfma_f32_16x16x32_bf16 v[112:115], v[40:43], a[84:87], v[112:115]
 v_exp_f32 v21, v85
 v_mfma_f32_16x16x32_bf16 v[120:123], v[36:39], a[112:115], v[120:123]
 v_add_f32 v17, v20, v21
 v_mfma_f32_16x16x32_bf16 v[120:123], v[40:43], a[116:119], v[120:123]
 s_waitcnt lgkmcnt(1)
 ds_read_b128 v[36:39], v0 offset:896
 v_cvt_pk_bf16_f32 v56, v20, v21
 v_mfma_f32_16x16x32_bf16 v[92:95], v[28:31], a[24:27], v[92:95]
 s_waitcnt lgkmcnt(1)
 v_exp_f32 v22, v86
 v_mfma_f32_16x16x32_bf16 v[92:95], v[32:35], a[28:31], v[92:95]
 v_exp_f32 v23, v87
 v_mfma_f32_16x16x32_bf16 v[100:103], v[28:31], a[56:59], v[100:103]
 v_add_f32 v17, v17, v22
 v_add_f32 v17, v17, v23
 v_mfma_f32_16x16x32_bf16 v[100:103], v[32:35], a[60:63], v[100:103]
 ds_read_b128 v[40:43], v0 offset:960
 v_cvt_pk_bf16_f32 v57, v22, v23
 v_mfma_f32_16x16x32_bf16 v[108:111], v[28:31], a[88:91], v[108:111]
 v_exp_f32 v20, v88
 v_mfma_f32_16x16x32_bf16 v[108:111], v[32:35], a[92:95], v[108:111]
 v_exp_f32 v21, v89
 v_mfma_f32_16x16x32_bf16 v[116:119], v[28:31], a[120:123], v[116:119]
 v_add_f32 v17, v17, v20
 v_add_f32 v17, v17, v21
 v_mfma_f32_16x16x32_bf16 v[116:119], v[32:35], a[124:127], v[116:119]
 s_waitcnt lgkmcnt(1)
 ds_read_b64_tr_b16 v[28:29], v1
 v_cvt_pk_bf16_f32 v58, v20, v21
 v_mfma_f32_16x16x32_bf16 v[96:99], v[36:39], a[24:27], v[96:99]
 s_waitcnt lgkmcnt(1)
 ds_read_b64_tr_b16 v[30:31], v1 offset:512
 v_exp_f32 v22, v90
 v_mfma_f32_16x16x32_bf16 v[96:99], v[40:43], a[28:31], v[96:99]
 v_exp_f32 v23, v91
 v_mfma_f32_16x16x32_bf16 v[104:107], v[36:39], a[56:59], v[104:107]
 v_add_f32 v17, v17, v22
 v_add_f32 v17, v17, v23
 v_mfma_f32_16x16x32_bf16 v[104:107], v[40:43], a[60:63], v[104:107]
 ds_read_b64_tr_b16 v[32:33], v1 offset:32
 v_cvt_pk_bf16_f32 v59, v22, v23
 v_mfma_f32_16x16x32_bf16 v[112:115], v[36:39], a[88:91], v[112:115]
 ds_read_b64_tr_b16 v[34:35], v1 offset:544
 v_max3_f32 v252, v14, v15, v16
 v_max_f32 v252, v252, v17
 v_mfma_f32_16x16x32_bf16 v[112:115], v[40:43], a[92:95], v[112:115]
 v_cmp_lt_f32 vcc, s30, v252
 v_mfma_f32_16x16x32_bf16 v[120:123], v[36:39], a[120:123], v[120:123]
 v_mfma_f32_16x16x32_bf16 v[120:123], v[40:43], a[124:127], v[120:123]
 s_waitcnt lgkmcnt(2)
 ds_read_b64_tr_b16 v[36:37], v1 offset:64
 s_cbranch_vccnz L_rare_L0
L_back_L0:
 s_sub_u32 s54, s6, s5
 s_add_u32 s90, s31, s5
 v_mfma_f32_16x16x32_bf16 v[124:127], v[28:31], v[44:47], v[124:127]
 s_waitcnt vmcnt(8)
 s_barrier
 s_waitcnt lgkmcnt(1)
 ds_read_b64_tr_b16 v[38:39], v1 offset:576
 v_mfma_f32_16x16x32_bf16 v[128:131], v[32:35], v[44:47], v[128:131]
 s_add_u32 s53, s53, 16384
 s_add_u32 m0, s89, 67584
 v_add_f32 v10, v10, v14
 v_add_f32 v11, v11, v15
 v_mfma_f32_16x16x32_bf16 v[188:191], v[28:31], v[48:51], v[188:191]
 buffer_load_dwordx4 v2, s[20:23], s53 offen nt lds
 v_add_f32 v12, v12, v16
 v_mfma_f32_16x16x32_bf16 v[192:195], v[32:35], v[48:51], v[192:195]
 ds_read_b64_tr_b16 v[40:41], v1 offset:96
 v_add_f32 v13, v13, v17
 v_mfma_f32_16x16x32_bf16 a[128:131], v[28:31], v[52:55], a[128:131]
 ds_read_b64_tr_b16 v[42:43], v1 offset:608
 v_mfma_f32_16x16x32_bf16 a[132:135], v[32:35], v[52:55], a[132:135]
 s_add_u32 m0, s89, 68128
 v_mfma_f32_16x16x32_bf16 a[192:195], v[28:31], v[56:59], a[192:195]
 buffer_load_dwordx4 v2, s[20:23], s53 offen offset:512 nt lds
 v_mfma_f32_16x16x32_bf16 a[196:199], v[32:35], v[56:59], a[196:199]
 s_waitcnt lgkmcnt(2)
 ds_read_b64_tr_b16 v[28:29], v1 offset:128
 v_mfma_f32_16x16x32_bf16 v[132:135], v[36:39], v[44:47], v[132:135]
 s_waitcnt lgkmcnt(1)
 ds_read_b64_tr_b16 v[30:31], v1 offset:640
 v_mfma_f32_16x16x32_bf16 v[136:139], v[40:43], v[44:47], v[136:139]
 s_add_u32 m0, s89, 68672
 v_mfma_f32_16x16x32_bf16 v[196:199], v[36:39], v[48:51], v[196:199]
 buffer_load_dwordx4 v2, s[20:23], s53 offen offset:1024 nt lds
 v_mfma_f32_16x16x32_bf16 v[200:203], v[40:43], v[48:51], v[200:203]
 ds_read_b64_tr_b16 v[32:33], v1 offset:160
 v_mfma_f32_16x16x32_bf16 a[136:139], v[36:39], v[52:55], a[136:139]
 ds_read_b64_tr_b16 v[34:35], v1 offset:672
 v_mfma_f32_16x16x32_bf16 a[140:143], v[40:43], v[52:55], a[140:143]
 s_add_u32 m0, s89, 69216
 v_mfma_f32_16x16x32_bf16 a[200:203], v[36:39], v[56:59], a[200:203]
 buffer_load_dwordx4 v2, s[20:23], s53 offen offset:1536 nt lds
 v_mfma_f32_16x16x32_bf16 a[204:207], v[40:43], v[56:59], a[204:207]
 s_waitcnt lgkmcnt(2)
 ds_read_b64_tr_b16 v[36:37], v1 offset:192
 v_mfma_f32_16x16x32_bf16 v[140:143], v[28:31], v[44:47], v[140:143]
 s_waitcnt lgkmcnt(1)
 ds_read_b64_tr_b16 v[38:39], v1 offset:704
 v_mfma_f32_16x16x32_bf16 v[144:147], v[32:35], v[44:47], v[144:147]
 s_add_u32 s52, s52, 16384
 s_add_u32 m0, s90, 0
 v_mfma_f32_16x16x32_bf16 v[204:207], v[28:31], v[48:51], v[204:207]
 buffer_load_dwordx4 v2, s[16:19], s52 offen nt lds
 v_mfma_f32_16x16x32_bf16 v[208:211], v[32:35], v[48:51], v[208:211]
 ds_read_b64_tr_b16 v[40:41], v1 offset:224
 v_mfma_f32_16x16x32_bf16 a[144:147], v[28:31], v[52:55], a[144:147]
 ds_read_b64_tr_b16 v[42:43], v1 offset:736
 v_fma_f32 v92, v92, s29, -v6
 v_mfma_f32_16x16x32_bf16 a[148:151], v[32:35], v[52:55], a[148:151]
 s_add_u32 m0, s90, 544
 v_fma_f32 v93, v93, s29, -v6
 v_fma_f32 v94, v94, s29, -v6
 v_mfma_f32_16x16x32_bf16 a[208:211], v[28:31], v[56:59], a[208:211]
 buffer_load_dwordx4 v2, s[16:19], s52 offen offset:512 nt lds
 v_fma_f32 v95, v95, s29, -v6
 v_mfma_f32_16x16x32_bf16 a[212:215], v[32:35], v[56:59], a[212:215]
 s_waitcnt lgkmcnt(2)
 ds_read_b64_tr_b16 v[28:29], v1 offset:256
 v_fma_f32 v96, v96, s29, -v6
 v_mfma_f32_16x16x32_bf16 v[148:151], v[36:39], v[44:47], v[148:151]
 s_waitcnt lgkmcnt(1)
 ds_read_b64_tr_b16 v[30:31], v1 offset:768
 v_fma_f32 v97, v97, s29, -v6
 v_mfma_f32_16x16x32_bf16 v[152:155], v[40:43], v[44:47], v[152:155]
 s_add_u32 m0, s90, 1088
 v_fma_f32 v98, v98, s29, -v6
 v_fma_f32 v99, v99, s29, -v6
 v_mfma_f32_16x16x32_bf16 v[212:215], v[36:39], v[48:51], v[212:215]
 buffer_load_dwordx4 v2, s[16:19], s52 offen offset:1024 nt lds
 v_fma_f32 v100, v100, s29, -v7
 v_mfma_f32_16x16x32_bf16 v[216:219], v[40:43], v[48:51], v[216:219]
 ds_read_b64_tr_b16 v[32:33], v1 offset:288
 v_fma_f32 v101, v101, s29, -v7
 v_mfma_f32_16x16x32_bf16 a[152:155], v[36:39], v[52:55], a[152:155]
 ds_read_b64_tr_b16 v[34:35], v1 offset:800
 v_fma_f32 v102, v102, s29, -v7
 v_mfma_f32_16x16x32_bf16 a[156:159], v[40:43], v[52:55], a[156:159]
 s_add_u32 m0, s90, 1632
 v_fma_f32 v103, v103, s29, -v7
 v_fma_f32 v104, v104, s29, -v7
 v_mfma_f32_16x16x32_bf16 a[216:219], v[36:39], v[56:59], a[216:219]
 buffer_load_dwordx4 v2, s[16:19], s52 offen offset:1536 nt lds
 v_add_u32 v0, s54, v0
 v_mfma_f32_16x16x32_bf16 a[220:223], v[40:43], v[56:59], a[220:223]
 s_waitcnt lgkmcnt(2)
 ds_read_b64_tr_b16 v[36:37], v1 offset:320
 v_fma_f32 v105, v105, s29, -v7
 v_mfma_f32_16x16x32_bf16 v[156:159], v[28:31], v[44:47], v[156:159]
 s_waitcnt lgkmcnt(1)
 ds_read_b64_tr_b16 v[38:39], v1 offset:832
 v_fma_f32 v106, v106, s29, -v7
 v_mfma_f32_16x16x32_bf16 v[160:163], v[32:35], v[44:47], v[160:163]
 v_fma_f32 v107, v107, s29, -v7
 v_fma_f32 v108, v108, s29, -v8
 v_mfma_f32_16x16x32_bf16 v[220:223], v[28:31], v[48:51], v[220:223]
 v_fma_f32 v109, v109, s29, -v8
 v_fma_f32 v110, v110, s29, -v8
 v_mfma_f32_16x16x32_bf16 v[224:227], v[32:35], v[48:51], v[224:227]
 ds_read_b64_tr_b16 v[40:41], v1 offset:352
 v_fma_f32 v111, v111, s29, -v8
 v_mfma_f32_16x16x32_bf16 a[160:163], v[28:31], v[52:55], a[160:163]
 ds_read_b64_tr_b16 v[42:43], v1 offset:864
 v_fma_f32 v112, v112, s29, -v8
 v_mfma_f32_16x16x32_bf16 a[164:167], v[32:35], v[52:55], a[164:167]
 v_fma_f32 v113, v113, s29, -v8
 v_fma_f32 v114, v114, s29, -v8
 v_mfma_f32_16x16x32_bf16 a[224:227], v[28:31], v[56:59], a[224:227]
 v_fma_f32 v115, v115, s29, -v8
 v_fma_f32 v116, v116, s29, -v9
 v_mfma_f32_16x16x32_bf16 a[228:231], v[32:35], v[56:59], a[228:231]
 s_waitcnt lgkmcnt(2)
 ds_read_b64_tr_b16 v[28:29], v1 offset:384
 v_fma_f32 v117, v117, s29, -v9
 v_mfma_f32_16x16x32_bf16 v[164:167], v[36:39], v[44:47], v[164:167]
 s_waitcnt lgkmcnt(1)
 ds_read_b64_tr_b16 v[30:31], v1 offset:896
 v_fma_f32 v118, v118, s29, -v9
 v_mfma_f32_16x16x32_bf16 v[168:171], v[40:43], v[44:47], v[168:171]
 v_fma_f32 v119, v119, s29, -v9
 v_fma_f32 v120, v120, s29, -v9
 v_mfma_f32_16x16x32_bf16 v[228:231], v[36:39], v[48:51], v[228:231]
 v_fma_f32 v121, v121, s29, -v9
 v_fma_f32 v122, v122, s29, -v9
 v_mfma_f32_16x16x32_bf16 v[232:235], v[40:43], v[48:51], v[232:235]
 ds_read_b64_tr_b16 v[32:33], v1 offset:416
 v_fma_f32 v123, v123, s29, -v9
 v_mfma_f32_16x16x32_bf16 a[168:171], v[36:39], v[52:55], a[168:171]
 ds_read_b64_tr_b16 v[34:35], v1 offset:928
 v_mfma_f32_16x16x32_bf16 a[172:175], v[40:43], v[52:55], a[172:175]
 v_mfma_f32_16x16x32_bf16 a[232:235], v[36:39], v[56:59], a[232:235]
 v_mfma_f32_16x16x32_bf16 a[236:239], v[40:43], v[56:59], a[236:239]
 s_waitcnt lgkmcnt(2)
 ds_read_b64_tr_b16 v[36:37], v1 offset:448
 v_mfma_f32_16x16x32_bf16 v[172:175], v[28:31], v[44:47], v[172:175]
 s_waitcnt lgkmcnt(1)
 ds_read_b64_tr_b16 v[38:39], v1 offset:960
 v_mfma_f32_16x16x32_bf16 v[176:179], v[32:35], v[44:47], v[176:179]
 v_mfma_f32_16x16x32_bf16 v[236:239], v[28:31], v[48:51], v[236:239]
 v_mfma_f32_16x16x32_bf16 v[240:243], v[32:35], v[48:51], v[240:243]
 ds_read_b64_tr_b16 v[40:41], v1 offset:480
 v_mfma_f32_16x16x32_bf16 a[176:179], v[28:31], v[52:55], a[176:179]
 ds_read_b64_tr_b16 v[42:43], v1 offset:992
 v_mfma_f32_16x16x32_bf16 a[180:183], v[32:35], v[52:55], a[180:183]
 v_mfma_f32_16x16x32_bf16 a[240:243], v[28:31], v[56:59], a[240:243]
 v_add_u32 v1, 16896, v1
 v_mfma_f32_16x16x32_bf16 a[244:247], v[32:35], v[56:59], a[244:247]
 s_waitcnt lgkmcnt(2)
 ds_read_b128 v[28:31], v0
 v_mfma_f32_16x16x32_bf16 v[180:183], v[36:39], v[44:47], v[180:183]
 s_waitcnt lgkmcnt(1)
 v_mfma_f32_16x16x32_bf16 v[184:187], v[40:43], v[44:47], v[184:187]
 v_mfma_f32_16x16x32_bf16 v[244:247], v[36:39], v[48:51], v[244:247]
 v_mfma_f32_16x16x32_bf16 v[248:251], v[40:43], v[48:51], v[248:251]
 ds_read_b128 v[32:35], v0 offset:64
 v_mfma_f32_16x16x32_bf16 a[184:187], v[36:39], v[52:55], a[184:187]
 v_exp_f32 v20, v92
 v_mfma_f32_16x16x32_bf16 a[188:191], v[40:43], v[52:55], a[188:191]
 v_exp_f32 v21, v93
 s_mov_b32 s38, s4
 s_mov_b32 s4, s5
 s_mov_b32 s5, s6
 s_mov_b32 s6, s38
 s_xor_b32 s88, s88, 33792
 s_xor_b32 s55, s55, 4294932480
 v_mfma_f32_16x16x32_bf16 a[248:251], v[36:39], v[56:59], a[248:251]
 v_add_f32 v14, v20, v21
 v_mfma_f32_16x16x32_bf16 a[252:255], v[40:43], v[56:59], a[252:255]
 s_waitcnt lgkmcnt(1)
 ds_read_b128 v[36:39], v0 offset:512
 v_cvt_pk_bf16_f32 v44, v20, v21
 s_sub_u32 s91, s91, 1
 s_cmp_lg_u32 s91, 0
 s_cbranch_scc1 L_loop
 v_mfma_f32_16x16x32_bf16 v[60:63], v[28:31], a[0:3], 0
 s_waitcnt lgkmcnt(1)
 v_exp_f32 v22, v94
 v_mfma_f32_16x16x32_bf16 v[60:63], v[32:35], a[4:7], v[60:63]
 v_exp_f32 v23, v95
 v_mfma_f32_16x16x32_bf16 v[68:71], v[28:31], a[32:35], 0
 v_add_f32 v14, v14, v22
 v_add_f32 v14, v14, v23
 v_mfma_f32_16x16x32_bf16 v[68:71], v[32:35], a[36:39], v[68:71]
 ds_read_b128 v[40:43], v0 offset:576
 v_cvt_pk_bf16_f32 v45, v22, v23
 v_mfma_f32_16x16x32_bf16 v[76:79], v[28:31], a[64:67], 0
 v_exp_f32 v20, v96
 v_mfma_f32_16x16x32_bf16 v[76:79], v[32:35], a[68:71], v[76:79]
 v_exp_f32 v21, v97
 v_mfma_f32_16x16x32_bf16 v[84:87], v[28:31], a[96:99], 0
 v_add_f32 v14, v14, v20
 v_add_f32 v14, v14, v21
 v_mfma_f32_16x16x32_bf16 v[84:87], v[32:35], a[100:103], v[84:87]
 s_waitcnt lgkmcnt(1)
 ds_read_b128 v[28:31], v0 offset:128
 v_cvt_pk_bf16_f32 v46, v20, v21
 v_mfma_f32_16x16x32_bf16 v[64:67], v[36:39], a[0:3], 0
 s_waitcnt lgkmcnt(1)
 v_exp_f32 v22, v98
 v_mfma_f32_16x16x32_bf16 v[64:67], v[40:43], a[4:7], v[64:67]
 v_exp_f32 v23, v99
 v_mfma_f32_16x16x32_bf16 v[72:75], v[36:39], a[32:35], 0
 v_add_f32 v14, v14, v22
 v_add_f32 v14, v14, v23
 v_mfma_f32_16x16x32_bf16 v[72:75], v[40:43], a[36:39], v[72:75]
 ds_read_b128 v[32:35], v0 offset:192
 v_cvt_pk_bf16_f32 v47, v22, v23
 v_mfma_f32_16x16x32_bf16 v[80:83], v[36:39], a[64:67], 0
 v_exp_f32 v20, v100
 v_mfma_f32_16x16x32_bf16 v[80:83], v[40:43], a[68:71], v[80:83]
 v_exp_f32 v21, v101
 v_mfma_f32_16x16x32_bf16 v[88:91], v[36:39], a[96:99], 0
 v_add_f32 v15, v20, v21
 v_mfma_f32_16x16x32_bf16 v[88:91], v[40:43], a[100:103], v[88:91]
 s_waitcnt lgkmcnt(1)
 ds_read_b128 v[36:39], v0 offset:640
 v_cvt_pk_bf16_f32 v48, v20, v21
 v_mfma_f32_16x16x32_bf16 v[60:63], v[28:31], a[8:11], v[60:63]
 s_waitcnt lgkmcnt(1)
 v_exp_f32 v22, v102
 v_mfma_f32_16x16x32_bf16 v[60:63], v[32:35], a[12:15], v[60:63]
 v_exp_f32 v23, v103
 v_mfma_f32_16x16x32_bf16 v[68:71], v[28:31], a[40:43], v[68:71]
 v_add_f32 v15, v15, v22
 v_add_f32 v15, v15, v23
 v_mfma_f32_16x16x32_bf16 v[68:71], v[32:35], a[44:47], v[68:71]
 ds_read_b128 v[40:43], v0 offset:704
 v_cvt_pk_bf16_f32 v49, v22, v23
 v_mfma_f32_16x16x32_bf16 v[76:79], v[28:31], a[72:75], v[76:79]
 v_exp_f32 v20, v104
 v_mfma_f32_16x16x32_bf16 v[76:79], v[32:35], a[76:79], v[76:79]
 v_exp_f32 v21, v105
 v_mfma_f32_16x16x32_bf16 v[84:87], v[28:31], a[104:107], v[84:87]
 v_add_f32 v15, v15, v20
 v_add_f32 v15, v15, v21
 v_mfma_f32_16x16x32_bf16 v[84:87], v[32:35], a[108:111], v[84:87]
 s_waitcnt lgkmcnt(1)
 ds_read_b128 v[28:31], v0 offset:256
 v_cvt_pk_bf16_f32 v50, v20, v21
 v_mfma_f32_16x16x32_bf16 v[64:67], v[36:39], a[8:11], v[64:67]
 s_waitcnt lgkmcnt(1)
 v_exp_f32 v22, v106
 v_mfma_f32_16x16x32_bf16 v[64:67], v[40:43], a[12:15], v[64:67]
 v_exp_f32 v23, v107
 v_mfma_f32_16x16x32_bf16 v[72:75], v[36:39], a[40:43], v[72:75]
 v_add_f32 v15, v15, v22
 v_add_f32 v15, v15, v23
 v_mfma_f32_16x16x32_bf16 v[72:75], v[40:43], a[44:47], v[72:75]
 ds_read_b128 v[32:35], v0 offset:320
 v_cvt_pk_bf16_f32 v51, v22, v23
 v_mfma_f32_16x16x32_bf16 v[80:83], v[36:39], a[72:75], v[80:83]
 v_exp_f32 v20, v108
 v_mfma_f32_16x16x32_bf16 v[80:83], v[40:43], a[76:79], v[80:83]
 v_exp_f32 v21, v109
 v_mfma_f32_16x16x32_bf16 v[88:91], v[36:39], a[104:107], v[88:91]
 v_add_f32 v16, v20, v21
 v_mfma_f32_16x16x32_bf16 v[88:91], v[40:43], a[108:111], v[88:91]
 s_waitcnt lgkmcnt(1)
 ds_read_b128 v[36:39], v0 offset:768
 v_cvt_pk_bf16_f32 v52, v20, v21
 v_mfma_f32_16x16x32_bf16 v[60:63], v[28:31], a[16:19], v[60:63]
 s_waitcnt lgkmcnt(1)
 v_exp_f32 v22, v110
 v_mfma_f32_16x16x32_bf16 v[60:63], v[32:35], a[20:23], v[60:63]
 v_exp_f32 v23, v111
 v_mfma_f32_16x16x32_bf16 v[68:71], v[28:31], a[48:51], v[68:71]
 v_add_f32 v16, v16, v22
 v_add_f32 v16, v16, v23
 v_mfma_f32_16x16x32_bf16 v[68:71], v[32:35], a[52:55], v[68:71]
 ds_read_b128 v[40:43], v0 offset:832
 v_cvt_pk_bf16_f32 v53, v22, v23
 v_mfma_f32_16x16x32_bf16 v[76:79], v[28:31], a[80:83], v[76:79]
 v_exp_f32 v20, v112
 v_mfma_f32_16x16x32_bf16 v[76:79], v[32:35], a[84:87], v[76:79]
 v_exp_f32 v21, v113
 v_mfma_f32_16x16x32_bf16 v[84:87], v[28:31], a[112:115], v[84:87]
 v_add_f32 v16, v16, v20
 v_add_f32 v16, v16, v21
 v_mfma_f32_16x16x32_bf16 v[84:87], v[32:35], a[116:119], v[84:87]
 s_waitcnt lgkmcnt(1)
 ds_read_b128 v[28:31], v0 offset:384
 v_cvt_pk_bf16_f32 v54, v20, v21
 v_mfma_f32_16x16x32_bf16 v[64:67], v[36:39], a[16:19], v[64:67]
 s_waitcnt lgkmcnt(1)
 v_exp_f32 v22, v114
 v_mfma_f32_16x16x32_bf16 v[64:67], v[40:43], a[20:23], v[64:67]
 v_exp_f32 v23, v115
 v_mfma_f32_16x16x32_bf16 v[72:75], v[36:39], a[48:51], v[72:75]
 v_add_f32 v16, v16, v22
 v_add_f32 v16, v16, v23
 v_mfma_f32_16x16x32_bf16 v[72:75], v[40:43], a[52:55], v[72:75]
 ds_read_b128 v[32:35], v0 offset:448
 v_cvt_pk_bf16_f32 v55, v22, v23
 v_mfma_f32_16x16x32_bf16 v[80:83], v[36:39], a[80:83], v[80:83]
 v_exp_f32 v20, v116
 v_mfma_f32_16x16x32_bf16 v[80:83], v[40:43], a[84:87], v[80:83]
 v_exp_f32 v21, v117
 v_mfma_f32_16x16x32_bf16 v[88:91], v[36:39], a[112:115], v[88:91]
 v_add_f32 v17, v20, v21
 v_mfma_f32_16x16x32_bf16 v[88:91], v[40:43], a[116:119], v[88:91]
 s_waitcnt lgkmcnt(1)
 ds_read_b128 v[36:39], v0 offset:896
 v_cvt_pk_bf16_f32 v56, v20, v21
 v_mfma_f32_16x16x32_bf16 v[60:63], v[28:31], a[24:27], v[60:63]
 s_waitcnt lgkmcnt(1)
 v_exp_f32 v22, v118
 v_mfma_f32_16x16x32_bf16 v[60:63], v[32:35], a[28:31], v[60:63]
 v_exp_f32 v23, v119
 v_mfma_f32_16x16x32_bf16 v[68:71], v[28:31], a[56:59], v[68:71]
 v_add_f32 v17, v17, v22
 v_add_f32 v17, v17, v23
 v_mfma_f32_16x16x32_bf16 v[68:71], v[32:35], a[60:63], v[68:71]
 ds_read_b128 v[40:43], v0 offset:960
 v_cvt_pk_bf16_f32 v57, v22, v23
 v_mfma_f32_16x16x32_bf16 v[76:79], v[28:31], a[88:91], v[76:79]
 v_exp_f32 v20, v120
 v_mfma_f32_16x16x32_bf16 v[76:79], v[32:35], a[92:95], v[76:79]
 v_exp_f32 v21, v121
 v_mfma_f32_16x16x32_bf16 v[84:87], v[28:31], a[120:123], v[84:87]
 v_add_f32 v17, v17, v20
 v_add_f32 v17, v17, v21
 v_mfma_f32_16x16x32_bf16 v[84:87], v[32:35], a[124:127], v[84:87]
 s_waitcnt lgkmcnt(1)
 ds_read_b64_tr_b16 v[28:29], v1
 v_cvt_pk_bf16_f32 v58, v20, v21
 v_mfma_f32_16x16x32_bf16 v[64:67], v[36:39], a[24:27], v[64:67]
 s_waitcnt lgkmcnt(1)
 ds_read_b64_tr_b16 v[30:31], v1 offset:512
 v_exp_f32 v22, v122
 v_mfma_f32_16x16x32_bf16 v[64:67], v[40:43], a[28:31], v[64:67]
 v_exp_f32 v23, v123
 v_mfma_f32_16x16x32_bf16 v[72:75], v[36:39], a[56:59], v[72:75]
 v_add_f32 v17, v17, v22
 v_add_f32 v17, v17, v23
 v_mfma_f32_16x16x32_bf16 v[72:75], v[40:43], a[60:63], v[72:75]
 ds_read_b64_tr_b16 v[32:33], v1 offset:32
 v_cvt_pk_bf16_f32 v59, v22, v23
 v_mfma_f32_16x16x32_bf16 v[80:83], v[36:39], a[88:91], v[80:83]
 ds_read_b64_tr_b16 v[34:35], v1 offset:544
 v_max3_f32 v252, v14, v15, v16
 v_max_f32 v252, v252, v17
 v_mfma_f32_16x16x32_bf16 v[80:83], v[40:43], a[92:95], v[80:83]
 v_cmp_lt_f32 vcc, s30, v252
 v_mfma_f32_16x16x32_bf16 v[88:91], v[36:39], a[120:123], v[88:91]
 v_mfma_f32_16x16x32_bf16 v[88:91], v[40:43], a[124:127], v[88:91]
 s_waitcnt lgkmcnt(2)
 ds_read_b64_tr_b16 v[36:37], v1 offset:64
 s_cbranch_vccnz L_rare_T11
L_back_T11:
 v_mfma_f32_16x16x32_bf16 v[124:127], v[28:31], v[44:47], v[124:127]
 s_waitcnt vmcnt(8)
 s_barrier
 s_waitcnt lgkmcnt(1)
 ds_read_b64_tr_b16 v[38:39], v1 offset:576
 v_mfma_f32_16x16x32_bf16 v[128:131], v[32:35], v[44:47], v[128:131]
 s_add_u32 s53, s53, 16384
 s_add_u32 m0, s31, 84480
 v_add_f32 v10, v10, v14
 v_add_f32 v11, v11, v15
 v_mfma_f32_16x16x32_bf16 v[188:191], v[28:31], v[48:51], v[188:191]
 buffer_load_dwordx4 v2, s[20:23], s53 offen nt lds
 v_add_f32 v12, v12, v16
 v_mfma_f32_16x16x32_bf16 v[192:195], v[32:35], v[48:51], v[192:195]
 ds_read_b64_tr_b16 v[40:41], v1 offset:96
 v_add_f32 v13, v13, v17
 v_mfma_f32_16x16x32_bf16 a[128:131], v[28:31], v[52:55], a[128:131]
 ds_read_b64_tr_b16 v[42:43], v1 offset:608
 v_mfma_f32_16x16x32_bf16 a[132:135], v[32:35], v[52:55], a[132:135]
 s_add_u32 m0, s31, 85024
 v_mfma_f32_16x16x32_bf16 a[192:195], v[28:31], v[56:59], a[192:195]
 buffer_load_dwordx4 v2, s[20:23], s53 offen offset:512 nt lds
 v_mfma_f32_16x16x32_bf16 a[196:199], v[32:35], v[56:59], a[196:199]
 s_waitcnt lgkmcnt(2)
 ds_read_b64_tr_b16 v[28:29], v1 offset:128
 v_mfma_f32_16x16x32_bf16 v[132:135], v[36:39], v[44:47], v[132:135]
 s_waitcnt lgkmcnt(1)
 ds_read_b64_tr_b16 v[30:31], v1 offset:640
 v_mfma_f32_16x16x32_bf16 v[136:139], v[40:43], v[44:47], v[136:139]
 s_add_u32 m0, s31, 85568
 v_mfma_f32_16x16x32_bf16 v[196:199], v[36:39], v[48:51], v[196:199]
 buffer_load_dwordx4 v2, s[20:23], s53 offen offset:1024 nt lds
 v_mfma_f32_16x16x32_bf16 v[200:203], v[40:43], v[48:51], v[200:203]
 ds_read_b64_tr_b16 v[32:33], v1 offset:160
 v_mfma_f32_16x16x32_bf16 a[136:139], v[36:39], v[52:55], a[136:139]
 ds_read_b64_tr_b16 v[34:35], v1 offset:672
 v_mfma_f32_16x16x32_bf16 a[140:143], v[40:43], v[52:55], a[140:143]
 s_add_u32 m0, s31, 86112
 v_mfma_f32_16x16x32_bf16 a[200:203], v[36:39], v[56:59], a[200:203]
 buffer_load_dwordx4 v2, s[20:23], s53 offen offset:1536 nt lds
 v_mfma_f32_16x16x32_bf16 a[204:207], v[40:43], v[56:59], a[204:207]
 s_waitcnt lgkmcnt(2)
 ds_read_b64_tr_b16 v[36:37], v1 offset:192
 v_mfma_f32_16x16x32_bf16 v[140:143], v[28:31], v[44:47], v[140:143]
 s_waitcnt lgkmcnt(1)
 ds_read_b64_tr_b16 v[38:39], v1 offset:704
 v_mfma_f32_16x16x32_bf16 v[144:147], v[32:35], v[44:47], v[144:147]
 s_add_u32 s52, s52, 16384
 s_add_u32 m0, s31, 0
 v_mfma_f32_16x16x32_bf16 v[204:207], v[28:31], v[48:51], v[204:207]
 buffer_load_dwordx4 v2, s[16:19], s52 offen nt lds
 v_mfma_f32_16x16x32_bf16 v[208:211], v[32:35], v[48:51], v[208:211]
 ds_read_b64_tr_b16 v[40:41], v1 offset:224
 v_mfma_f32_16x16x32_bf16 a[144:147], v[28:31], v[52:55], a[144:147]
 ds_read_b64_tr_b16 v[42:43], v1 offset:736
 v_fma_f32 v60, v60, s29, -v6
 v_mfma_f32_16x16x32_bf16 a[148:151], v[32:35], v[52:55], a[148:151]
 s_add_u32 m0, s31, 544
 v_fma_f32 v61, v61, s29, -v6
 v_fma_f32 v62, v62, s29, -v6
 v_mfma_f32_16x16x32_bf16 a[208:211], v[28:31], v[56:59], a[208:211]
 buffer_load_dwordx4 v2, s[16:19], s52 offen offset:512 nt lds
 v_fma_f32 v63, v63, s29, -v6
 v_mfma_f32_16x16x32_bf16 a[212:215], v[32:35], v[56:59], a[212:215]
 s_waitcnt lgkmcnt(2)
 ds_read_b64_tr_b16 v[28:29], v1 offset:256
 v_fma_f32 v64, v64, s29, -v6
 v_mfma_f32_16x16x32_bf16 v[148:151], v[36:39], v[44:47], v[148:151]
 s_waitcnt lgkmcnt(1)
 ds_read_b64_tr_b16 v[30:31], v1 offset:768
 v_fma_f32 v65, v65, s29, -v6
 v_mfma_f32_16x16x32_bf16 v[152:155], v[40:43], v[44:47], v[152:155]
 s_add_u32 m0, s31, 1088
 v_fma_f32 v66, v66, s29, -v6
 v_fma_f32 v67, v67, s29, -v6
 v_mfma_f32_16x16x32_bf16 v[212:215], v[36:39], v[48:51], v[212:215]
 buffer_load_dwordx4 v2, s[16:19], s52 offen offset:1024 nt lds
 v_fma_f32 v68, v68, s29, -v7
 v_mfma_f32_16x16x32_bf16 v[216:219], v[40:43], v[48:51], v[216:219]
 ds_read_b64_tr_b16 v[32:33], v1 offset:288
 v_fma_f32 v69, v69, s29, -v7
 v_mfma_f32_16x16x32_bf16 a[152:155], v[36:39], v[52:55], a[152:155]
 ds_read_b64_tr_b16 v[34:35], v1 offset:800
 v_fma_f32 v70, v70, s29, -v7
 v_mfma_f32_16x16x32_bf16 a[156:159], v[40:43], v[52:55], a[156:159]
 s_add_u32 m0, s31, 1632
 v_fma_f32 v71, v71, s29, -v7
 v_fma_f32 v72, v72, s29, -v7
 v_mfma_f32_16x16x32_bf16 a[216:219], v[36:39], v[56:59], a[216:219]
 buffer_load_dwordx4 v2, s[16:19], s52 offen offset:1536 nt lds
 v_add_u32 v0, 16896, v0
 v_mfma_f32_16x16x32_bf16 a[220:223], v[40:43], v[56:59], a[220:223]
 s_waitcnt lgkmcnt(2)
 ds_read_b64_tr_b16 v[36:37], v1 offset:320
 v_fma_f32 v73, v73, s29, -v7
 v_mfma_f32_16x16x32_bf16 v[156:159], v[28:31], v[44:47], v[156:159]
 s_waitcnt lgkmcnt(1)
 ds_read_b64_tr_b16 v[38:39], v1 offset:832
 v_fma_f32 v74, v74, s29, -v7
 v_mfma_f32_16x16x32_bf16 v[160:163], v[32:35], v[44:47], v[160:163]
 v_fma_f32 v75, v75, s29, -v7
 v_fma_f32 v76, v76, s29, -v8
 v_mfma_f32_16x16x32_bf16 v[220:223], v[28:31], v[48:51], v[220:223]
 v_fma_f32 v77, v77, s29, -v8
 v_fma_f32 v78, v78, s29, -v8
 v_mfma_f32_16x16x32_bf16 v[224:227], v[32:35], v[48:51], v[224:227]
 ds_read_b64_tr_b16 v[40:41], v1 offset:352
 v_fma_f32 v79, v79, s29, -v8
 v_mfma_f32_16x16x32_bf16 a[160:163], v[28:31], v[52:55], a[160:163]
 ds_read_b64_tr_b16 v[42:43], v1 offset:864
 v_fma_f32 v80, v80, s29, -v8
 v_mfma_f32_16x16x32_bf16 a[164:167], v[32:35], v[52:55], a[164:167]
 v_fma_f32 v81, v81, s29, -v8
 v_fma_f32 v82, v82, s29, -v8
 v_mfma_f32_16x16x32_bf16 a[224:227], v[28:31], v[56:59], a[224:227]
 v_fma_f32 v83, v83, s29, -v8
 v_fma_f32 v84, v84, s29, -v9
 v_mfma_f32_16x16x32_bf16 a[228:231], v[32:35], v[56:59], a[228:231]
 s_waitcnt lgkmcnt(2)
 ds_read_b64_tr_b16 v[28:29], v1 offset:384
 v_fma_f32 v85, v85, s29, -v9
 v_mfma_f32_16x16x32_bf16 v[164:167], v[36:39], v[44:47], v[164:167]
 s_waitcnt lgkmcnt(1)
 ds_read_b64_tr_b16 v[30:31], v1 offset:896
 v_fma_f32 v86, v86, s29, -v9
 v_mfma_f32_16x16x32_bf16 v[168:171], v[40:43], v[44:47], v[168:171]
 v_fma_f32 v87, v87, s29, -v9
 v_fma_f32 v88, v88, s29, -v9
 v_mfma_f32_16x16x32_bf16 v[228:231], v[36:39], v[48:51], v[228:231]
 v_fma_f32 v89, v89, s29, -v9
 v_fma_f32 v90, v90, s29, -v9
 v_mfma_f32_16x16x32_bf16 v[232:235], v[40:43], v[48:51], v[232:235]
 ds_read_b64_tr_b16 v[32:33], v1 offset:416
 v_fma_f32 v91, v91, s29, -v9
 v_mfma_f32_16x16x32_bf16 a[168:171], v[36:39], v[52:55], a[168:171]
 ds_read_b64_tr_b16 v[34:35], v1 offset:928
 v_mfma_f32_16x16x32_bf16 a[172:175], v[40:43], v[52:55], a[172:175]
 v_mfma_f32_16x16x32_bf16 a[232:235], v[36:39], v[56:59], a[232:235]
 v_mfma_f32_16x16x32_bf16 a[236:239], v[40:43], v[56:59], a[236:239]
 s_waitcnt lgkmcnt(2)
 ds_read_b64_tr_b16 v[36:37], v1 offset:448
 v_mfma_f32_16x16x32_bf16 v[172:175], v[28:31], v[44:47], v[172:175]
 s_waitcnt lgkmcnt(1)
 ds_read_b64_tr_b16 v[38:39], v1 offset:960
 v_mfma_f32_16x16x32_bf16 v[176:179], v[32:35], v[44:47], v[176:179]
 v_mfma_f32_16x16x32_bf16 v[236:239], v[28:31], v[48:51], v[236:239]
 v_mfma_f32_16x16x32_bf16 v[240:243], v[32:35], v[48:51], v[240:243]
 ds_read_b64_tr_b16 v[40:41], v1 offset:480
 v_mfma_f32_16x16x32_bf16 a[176:179], v[28:31], v[52:55], a[176:179]
 ds_read_b64_tr_b16 v[42:43], v1 offset:992
 v_mfma_f32_16x16x32_bf16 a[180:183], v[32:35], v[52:55], a[180:183]
 v_mfma_f32_16x16x32_bf16 a[240:243], v[28:31], v[56:59], a[240:243]
 v_add_u32 v1, 4294916608, v1
 v_mfma_f32_16x16x32_bf16 a[244:247], v[32:35], v[56:59], a[244:247]
 s_waitcnt lgkmcnt(2)
 ds_read_b128 v[28:31], v0
 v_mfma_f32_16x16x32_bf16 v[180:183], v[36:39], v[44:47], v[180:183]
 s_waitcnt lgkmcnt(1)
 v_mfma_f32_16x16x32_bf16 v[184:187], v[40:43], v[44:47], v[184:187]
 v_mfma_f32_16x16x32_bf16 v[244:247], v[36:39], v[48:51], v[244:247]
 v_mfma_f32_16x16x32_bf16 v[248:251], v[40:43], v[48:51], v[248:251]
 ds_read_b128 v[32:35], v0 offset:64
 v_mfma_f32_16x16x32_bf16 a[184:187], v[36:39], v[52:55], a[184:187]
 v_exp_f32 v20, v60
 v_mfma_f32_16x16x32_bf16 a[188:191], v[40:43], v[52:55], a[188:191]
 v_exp_f32 v21, v61
 v_mfma_f32_16x16x32_bf16 a[248:251], v[36:39], v[56:59], a[248:251]
 v_add_f32 v14, v20, v21
 v_mfma_f32_16x16x32_bf16 a[252:255], v[40:43], v[56:59], a[252:255]
 s_waitcnt lgkmcnt(1)
 ds_read_b128 v[36:39], v0 offset:512
 v_cvt_pk_bf16_f32 v44, v20, v21
 v_mfma_f32_16x16x32_bf16 v[92:95], v[28:31], a[0:3], 0
 s_waitcnt lgkmcnt(1)
 v_exp_f32 v22, v62
 v_mfma_f32_16x16x32_bf16 v[92:95], v[32:35], a[4:7], v[92:95]
 v_exp_f32 v23, v63
 v_mfma_f32_16x16x32_bf16 v[100:103], v[28:31], a[32:35], 0
 v_add_f32 v14, v14, v22
 v_add_f32 v14, v14, v23
 v_mfma_f32_16x16x32_bf16 v[100:103], v[32:35], a[36:39], v[100:103]
 ds_read_b128 v[40:43], v0 offset:576
 v_cvt_pk_bf16_f32 v45, v22, v23
 v_mfma_f32_16x16x32_bf16 v[108:111], v[28:31], a[64:67], 0
 v_exp_f32 v20, v64
 v_mfma_f32_16x16x32_bf16 v[108:111], v[32:35], a[68:71], v[108:111]
 v_exp_f32 v21, v65
 v_mfma_f32_16x16x32_bf16 v[116:119], v[28:31], a[96:99], 0
 v_add_f32 v14, v14, v20
 v_add_f32 v14, v14, v21
 v_mfma_f32_16x16x32_bf16 v[116:119], v[32:35], a[100:103], v[116:119]
 s_waitcnt lgkmcnt(1)
 ds_read_b128 v[28:31], v0 offset:128
 v_cvt_pk_bf16_f32 v46, v20, v21
 v_mfma_f32_16x16x32_bf16 v[96:99], v[36:39], a[0:3], 0
 s_waitcnt lgkmcnt(1)
 v_exp_f32 v22, v66
 v_mfma_f32_16x16x32_bf16 v[96:99], v[40:43], a[4:7], v[96:99]
 v_exp_f32 v23, v67
 v_mfma_f32_16x16x32_bf16 v[104:107], v[36:39], a[32:35], 0
 v_add_f32 v14, v14, v22
 v_add_f32 v14, v14, v23
 v_mfma_f32_16x16x32_bf16 v[104:107], v[40:43], a[36:39], v[104:107]
 ds_read_b128 v[32:35], v0 offset:192
 v_cvt_pk_bf16_f32 v47, v22, v23
 v_mfma_f32_16x16x32_bf16 v[112:115], v[36:39], a[64:67], 0
 v_exp_f32 v20, v68
 v_mfma_f32_16x16x32_bf16 v[112:115], v[40:43], a[68:71], v[112:115]
 v_exp_f32 v21, v69
 v_mfma_f32_16x16x32_bf16 v[120:123], v[36:39], a[96:99], 0
 v_add_f32 v15, v20, v21
 v_mfma_f32_16x16x32_bf16 v[120:123], v[40:43], a[100:103], v[120:123]
 s_waitcnt lgkmcnt(1)
 ds_read_b128 v[36:39], v0 offset:640
 v_cvt_pk_bf16_f32 v48, v20, v21
 v_mfma_f32_16x16x32_bf16 v[92:95], v[28:31], a[8:11], v[92:95]
 s_waitcnt lgkmcnt(1)
 v_exp_f32 v22, v70
 v_mfma_f32_16x16x32_bf16 v[92:95], v[32:35], a[12:15], v[92:95]
 v_exp_f32 v23, v71
 v_mfma_f32_16x16x32_bf16 v[100:103], v[28:31], a[40:43], v[100:103]
 v_add_f32 v15, v15, v22
 v_add_f32 v15, v15, v23
 v_mfma_f32_16x16x32_bf16 v[100:103], v[32:35], a[44:47], v[100:103]
 ds_read_b128 v[40:43], v0 offset:704
 v_cvt_pk_bf16_f32 v49, v22, v23
 v_mfma_f32_16x16x32_bf16 v[108:111], v[28:31], a[72:75], v[108:111]
 v_exp_f32 v20, v72
 v_mfma_f32_16x16x32_bf16 v[108:111], v[32:35], a[76:79], v[108:111]
 v_exp_f32 v21, v73
 v_mfma_f32_16x16x32_bf16 v[116:119], v[28:31], a[104:107], v[116:119]
 v_add_f32 v15, v15, v20
 v_add_f32 v15, v15, v21
 v_mfma_f32_16x16x32_bf16 v[116:119], v[32:35], a[108:111], v[116:119]
 s_waitcnt lgkmcnt(1)
 ds_read_b128 v[28:31], v0 offset:256
 v_cvt_pk_bf16_f32 v50, v20, v21
 v_mfma_f32_16x16x32_bf16 v[96:99], v[36:39], a[8:11], v[96:99]
 s_waitcnt lgkmcnt(1)
 v_exp_f32 v22, v74
 v_mfma_f32_16x16x32_bf16 v[96:99], v[40:43], a[12:15], v[96:99]
 v_exp_f32 v23, v75
 v_mfma_f32_16x16x32_bf16 v[104:107], v[36:39], a[40:43], v[104:107]
 v_add_f32 v15, v15, v22
 v_add_f32 v15, v15, v23
 v_mfma_f32_16x16x32_bf16 v[104:107], v[40:43], a[44:47], v[104:107]
 ds_read_b128 v[32:35], v0 offset:320
 v_cvt_pk_bf16_f32 v51, v22, v23
 v_mfma_f32_16x16x32_bf16 v[112:115], v[36:39], a[72:75], v[112:115]
 v_exp_f32 v20, v76
 v_mfma_f32_16x16x32_bf16 v[112:115], v[40:43], a[76:79], v[112:115]
 v_exp_f32 v21, v77
 v_mfma_f32_16x16x32_bf16 v[120:123], v[36:39], a[104:107], v[120:123]
 v_add_f32 v16, v20, v21
 v_mfma_f32_16x16x32_bf16 v[120:123], v[40:43], a[108:111], v[120:123]
 s_waitcnt lgkmcnt(1)
 ds_read_b128 v[36:39], v0 offset:768
 v_cvt_pk_bf16_f32 v52, v20, v21
 v_mfma_f32_16x16x32_bf16 v[92:95], v[28:31], a[16:19], v[92:95]
 s_waitcnt lgkmcnt(1)
 v_exp_f32 v22, v78
 v_mfma_f32_16x16x32_bf16 v[92:95], v[32:35], a[20:23], v[92:95]
 v_exp_f32 v23, v79
 v_mfma_f32_16x16x32_bf16 v[100:103], v[28:31], a[48:51], v[100:103]
 v_add_f32 v16, v16, v22
 v_add_f32 v16, v16, v23
 v_mfma_f32_16x16x32_bf16 v[100:103], v[32:35], a[52:55], v[100:103]
 ds_read_b128 v[40:43], v0 offset:832
 v_cvt_pk_bf16_f32 v53, v22, v23
 v_mfma_f32_16x16x32_bf16 v[108:111], v[28:31], a[80:83], v[108:111]
 v_exp_f32 v20, v80
 v_mfma_f32_16x16x32_bf16 v[108:111], v[32:35], a[84:87], v[108:111]
 v_exp_f32 v21, v81
 v_mfma_f32_16x16x32_bf16 v[116:119], v[28:31], a[112:115], v[116:119]
 v_add_f32 v16, v16, v20
 v_add_f32 v16, v16, v21
 v_mfma_f32_16x16x32_bf16 v[116:119], v[32:35], a[116:119], v[116:119]
 s_waitcnt lgkmcnt(1)
 ds_read_b128 v[28:31], v0 offset:384
 v_cvt_pk_bf16_f32 v54, v20, v21
 v_mfma_f32_16x16x32_bf16 v[96:99], v[36:39], a[16:19], v[96:99]
 s_waitcnt lgkmcnt(1)
 v_exp_f32 v22, v82
 v_mfma_f32_16x16x32_bf16 v[96:99], v[40:43], a[20:23], v[96:99]
 v_exp_f32 v23, v83
 v_mfma_f32_16x16x32_bf16 v[104:107], v[36:39], a[48:51], v[104:107]
 v_add_f32 v16, v16, v22
 v_add_f32 v16, v16, v23
 v_mfma_f32_16x16x32_bf16 v[104:107], v[40:43], a[52:55], v[104:107]
 ds_read_b128 v[32:35], v0 offset:448
 v_cvt_pk_bf16_f32 v55, v22, v23
 v_mfma_f32_16x16x32_bf16 v[112:115], v[36:39], a[80:83], v[112:115]
 v_exp_f32 v20, v84
 v_mfma_f32_16x16x32_bf16 v[112:115], v[40:43], a[84:87], v[112:115]
 v_exp_f32 v21, v85
 v_mfma_f32_16x16x32_bf16 v[120:123], v[36:39], a[112:115], v[120:123]
 v_add_f32 v17, v20, v21
 v_mfma_f32_16x16x32_bf16 v[120:123], v[40:43], a[116:119], v[120:123]
 s_waitcnt lgkmcnt(1)
 ds_read_b128 v[36:39], v0 offset:896
 v_cvt_pk_bf16_f32 v56, v20, v21
 v_mfma_f32_16x16x32_bf16 v[92:95], v[28:31], a[24:27], v[92:95]
 s_waitcnt lgkmcnt(1)
 v_exp_f32 v22, v86
 v_mfma_f32_16x16x32_bf16 v[92:95], v[32:35], a[28:31], v[92:95]
 v_exp_f32 v23, v87
 v_mfma_f32_16x16x32_bf16 v[100:103], v[28:31], a[56:59], v[100:103]
 v_add_f32 v17, v17, v22
 v_add_f32 v17, v17, v23
 v_mfma_f32_16x16x32_bf16 v[100:103], v[32:35], a[60:63], v[100:103]
 ds_read_b128 v[40:43], v0 offset:960
 v_cvt_pk_bf16_f32 v57, v22, v23
 v_mfma_f32_16x16x32_bf16 v[108:111], v[28:31], a[88:91], v[108:111]
 v_exp_f32 v20, v88
 v_mfma_f32_16x16x32_bf16 v[108:111], v[32:35], a[92:95], v[108:111]
 v_exp_f32 v21, v89
 v_mfma_f32_16x16x32_bf16 v[116:119], v[28:31], a[120:123], v[116:119]
 v_add_f32 v17, v17, v20
 v_add_f32 v17, v17, v21
 v_mfma_f32_16x16x32_bf16 v[116:119], v[32:35], a[124:127], v[116:119]
 s_waitcnt lgkmcnt(1)
 ds_read_b64_tr_b16 v[28:29], v1
 v_cvt_pk_bf16_f32 v58, v20, v21
 v_mfma_f32_16x16x32_bf16 v[96:99], v[36:39], a[24:27], v[96:99]
 s_waitcnt lgkmcnt(1)
 ds_read_b64_tr_b16 v[30:31], v1 offset:512
 v_exp_f32 v22, v90
 v_mfma_f32_16x16x32_bf16 v[96:99], v[40:43], a[28:31], v[96:99]
 v_exp_f32 v23, v91
 v_mfma_f32_16x16x32_bf16 v[104:107], v[36:39], a[56:59], v[104:107]
 v_add_f32 v17, v17, v22
 v_add_f32 v17, v17, v23
 v_mfma_f32_16x16x32_bf16 v[104:107], v[40:43], a[60:63], v[104:107]
 ds_read_b64_tr_b16 v[32:33], v1 offset:32
 v_cvt_pk_bf16_f32 v59, v22, v23
 v_mfma_f32_16x16x32_bf16 v[112:115], v[36:39], a[88:91], v[112:115]
 ds_read_b64_tr_b16 v[34:35], v1 offset:544
 v_max3_f32 v252, v14, v15, v16
 v_max_f32 v252, v252, v17
 v_mfma_f32_16x16x32_bf16 v[112:115], v[40:43], a[92:95], v[112:115]
 v_cmp_lt_f32 vcc, s30, v252
 v_mfma_f32_16x16x32_bf16 v[120:123], v[36:39], a[120:123], v[120:123]
 v_mfma_f32_16x16x32_bf16 v[120:123], v[40:43], a[124:127], v[120:123]
 s_waitcnt lgkmcnt(2)
 ds_read_b64_tr_b16 v[36:37], v1 offset:64
 s_cbranch_vccnz L_rare_T12
L_back_T12:
 v_mfma_f32_16x16x32_bf16 v[124:127], v[28:31], v[44:47], v[124:127]
 s_waitcnt vmcnt(8)
 s_barrier
 s_waitcnt lgkmcnt(1)
 ds_read_b64_tr_b16 v[38:39], v1 offset:576
 v_mfma_f32_16x16x32_bf16 v[128:131], v[32:35], v[44:47], v[128:131]
 s_add_u32 s53, s53, 16384
 s_add_u32 m0, s31, 101376
 v_add_f32 v10, v10, v14
 v_add_f32 v11, v11, v15
 v_mfma_f32_16x16x32_bf16 v[188:191], v[28:31], v[48:51], v[188:191]
 buffer_load_dwordx4 v2, s[20:23], s53 offen nt lds
 v_add_f32 v12, v12, v16
 v_mfma_f32_16x16x32_bf16 v[192:195], v[32:35], v[48:51], v[192:195]
 ds_read_b64_tr_b16 v[40:41], v1 offset:96
 v_add_f32 v13, v13, v17
 v_mfma_f32_16x16x32_bf16 a[128:131], v[28:31], v[52:55], a[128:131]
 ds_read_b64_tr_b16 v[42:43], v1 offset:608
 v_mfma_f32_16x16x32_bf16 a[132:135], v[32:35], v[52:55], a[132:135]
 s_add_u32 m0, s31, 101920
 v_mfma_f32_16x16x32_bf16 a[192:195], v[28:31], v[56:59], a[192:195]
 buffer_load_dwordx4 v2, s[20:23], s53 offen offset:512 nt lds
 v_mfma_f32_16x16x32_bf16 a[196:199], v[32:35], v[56:59], a[196:199]
 s_waitcnt lgkmcnt(2)
 ds_read_b64_tr_b16 v[28:29], v1 offset:128
 v_mfma_f32_16x16x32_bf16 v[132:135], v[36:39], v[44:47], v[132:135]
 s_waitcnt lgkmcnt(1)
 ds_read_b64_tr_b16 v[30:31], v1 offset:640
 v_mfma_f32_16x16x32_bf16 v[136:139], v[40:43], v[44:47], v[136:139]
 s_add_u32 m0, s31, 102464
 v_mfma_f32_16x16x32_bf16 v[196:199], v[36:39], v[48:51], v[196:199]
 buffer_load_dwordx4 v2, s[20:23], s53 offen offset:1024 nt lds
 v_mfma_f32_16x16x32_bf16 v[200:203], v[40:43], v[48:51], v[200:203]
 ds_read_b64_tr_b16 v[32:33], v1 offset:160
 v_mfma_f32_16x16x32_bf16 a[136:139], v[36:39], v[52:55], a[136:139]
 ds_read_b64_tr_b16 v[34:35], v1 offset:672
 v_mfma_f32_16x16x32_bf16 a[140:143], v[40:43], v[52:55], a[140:143]
 s_add_u32 m0, s31, 103008
 v_mfma_f32_16x16x32_bf16 a[200:203], v[36:39], v[56:59], a[200:203]
 buffer_load_dwordx4 v2, s[20:23], s53 offen offset:1536 nt lds
 v_mfma_f32_16x16x32_bf16 a[204:207], v[40:43], v[56:59], a[204:207]
 s_waitcnt lgkmcnt(2)
 ds_read_b64_tr_b16 v[36:37], v1 offset:192
 v_mfma_f32_16x16x32_bf16 v[140:143], v[28:31], v[44:47], v[140:143]
 s_waitcnt lgkmcnt(1)
 ds_read_b64_tr_b16 v[38:39], v1 offset:704
 v_mfma_f32_16x16x32_bf16 v[144:147], v[32:35], v[44:47], v[144:147]
 s_add_u32 s42, s36, 128
 s_add_u32 m0, s32, 16896
 v_mfma_f32_16x16x32_bf16 v[204:207], v[28:31], v[48:51], v[204:207]
 buffer_load_dwordx4 v4, s[12:15], s42 offen nt lds
 v_mfma_f32_16x16x32_bf16 v[208:211], v[32:35], v[48:51], v[208:211]
 ds_read_b64_tr_b16 v[40:41], v1 offset:224
 v_mfma_f32_16x16x32_bf16 a[144:147], v[28:31], v[52:55], a[144:147]
 ds_read_b64_tr_b16 v[42:43], v1 offset:736
 v_fma_f32 v92, v92, s29, -v6
 v_mfma_f32_16x16x32_bf16 a[148:151], v[32:35], v[52:55], a[148:151]
 s_add_u32 s42, s36, 4224
 s_add_u32 m0, s32, 17920
 v_fma_f32 v93, v93, s29, -v6
 v_fma_f32 v94, v94, s29, -v6
 v_mfma_f32_16x16x32_bf16 a[208:211], v[28:31], v[56:59], a[208:211]
 buffer_load_dwordx4 v5, s[12:15], s42 offen nt lds
 v_fma_f32 v95, v95, s29, -v6
 v_mfma_f32_16x16x32_bf16 a[212:215], v[32:35], v[56:59], a[212:215]
 s_waitcnt lgkmcnt(2)
 ds_read_b64_tr_b16 v[28:29], v1 offset:256
 v_fma_f32 v96, v96, s29, -v6
 v_mfma_f32_16x16x32_bf16 v[148:151], v[36:39], v[44:47], v[148:151]
 s_waitcnt lgkmcnt(1)
 ds_read_b64_tr_b16 v[30:31], v1 offset:768
 v_fma_f32 v97, v97, s29, -v6
 v_mfma_f32_16x16x32_bf16 v[152:155], v[40:43], v[44:47], v[152:155]
 s_add_u32 s42, s36, 8320
 s_add_u32 m0, s32, 18944
 v_fma_f32 v98, v98, s29, -v6
 v_fma_f32 v99, v99, s29, -v6
 v_mfma_f32_16x16x32_bf16 v[212:215], v[36:39], v[48:51], v[212:215]
 buffer_load_dwordx4 v4, s[12:15], s42 offen nt lds
 v_fma_f32 v100, v100, s29, -v7
 v_mfma_f32_16x16x32_bf16 v[216:219], v[40:43], v[48:51], v[216:219]
 ds_read_b64_tr_b16 v[32:33], v1 offset:288
 v_fma_f32 v101, v101, s29, -v7
 v_mfma_f32_16x16x32_bf16 a[152:155], v[36:39], v[52:55], a[152:155]
 ds_read_b64_tr_b16 v[34:35], v1 offset:800
 v_fma_f32 v102, v102, s29, -v7
 v_mfma_f32_16x16x32_bf16 a[156:159], v[40:43], v[52:55], a[156:159]
 s_add_u32 s42, s36, 12416
 s_add_u32 m0, s32, 19968
 v_fma_f32 v103, v103, s29, -v7
 v_fma_f32 v104, v104, s29, -v7
 v_mfma_f32_16x16x32_bf16 a[216:219], v[36:39], v[56:59], a[216:219]
 buffer_load_dwordx4 v5, s[12:15], s42 offen nt lds
 v_add_u32 v0, 16896, v0
 v_mfma_f32_16x16x32_bf16 a[220:223], v[40:43], v[56:59], a[220:223]
 s_waitcnt lgkmcnt(2)
 ds_read_b64_tr_b16 v[36:37], v1 offset:320
 v_fma_f32 v105, v105, s29, -v7
 v_mfma_f32_16x16x32_bf16 v[156:159], v[28:31], v[44:47], v[156:159]
 s_waitcnt lgkmcnt(1)
 ds_read_b64_tr_b16 v[38:39], v1 offset:832
 v_fma_f32 v106, v106, s29, -v7
 v_mfma_f32_16x16x32_bf16 v[160:163], v[32:35], v[44:47], v[160:163]
 v_fma_f32 v107, v107, s29, -v7
 v_fma_f32 v108, v108, s29, -v8
 v_mfma_f32_16x16x32_bf16 v[220:223], v[28:31], v[48:51], v[220:223]
 v_fma_f32 v109, v109, s29, -v8
 v_fma_f32 v110, v110, s29, -v8
 v_mfma_f32_16x16x32_bf16 v[224:227], v[32:35], v[48:51], v[224:227]
 ds_read_b64_tr_b16 v[40:41], v1 offset:352
 v_fma_f32 v111, v111, s29, -v8
 v_mfma_f32_16x16x32_bf16 a[160:163], v[28:31], v[52:55], a[160:163]
 ds_read_b64_tr_b16 v[42:43], v1 offset:864
 v_fma_f32 v112, v112, s29, -v8
 v_mfma_f32_16x16x32_bf16 a[164:167], v[32:35], v[52:55], a[164:167]
 v_fma_f32 v113, v113, s29, -v8
 v_fma_f32 v114, v114, s29, -v8
 v_mfma_f32_16x16x32_bf16 a[224:227], v[28:31], v[56:59], a[224:227]
 v_fma_f32 v115, v115, s29, -v8
 v_fma_f32 v116, v116, s29, -v9
 v_mfma_f32_16x16x32_bf16 a[228:231], v[32:35], v[56:59], a[228:231]
 s_waitcnt lgkmcnt(2)
 ds_read_b64_tr_b16 v[28:29], v1 offset:384
 v_fma_f32 v117, v117, s29, -v9
 v_mfma_f32_16x16x32_bf16 v[164:167], v[36:39], v[44:47], v[164:167]
 s_waitcnt lgkmcnt(1)
 ds_read_b64_tr_b16 v[30:31], v1 offset:896
 v_fma_f32 v118, v118, s29, -v9
 v_mfma_f32_16x16x32_bf16 v[168:171], v[40:43], v[44:47], v[168:171]
 v_fma_f32 v119, v119, s29, -v9
 v_fma_f32 v120, v120, s29, -v9
 v_mfma_f32_16x16x32_bf16 v[228:231], v[36:39], v[48:51], v[228:231]
 v_fma_f32 v121, v121, s29, -v9
 v_fma_f32 v122, v122, s29, -v9
 v_mfma_f32_16x16x32_bf16 v[232:235], v[40:43], v[48:51], v[232:235]
 ds_read_b64_tr_b16 v[32:33], v1 offset:416
 v_fma_f32 v123, v123, s29, -v9
 v_mfma_f32_16x16x32_bf16 a[168:171], v[36:39], v[52:55], a[168:171]
 ds_read_b64_tr_b16 v[34:35], v1 offset:928
 v_mfma_f32_16x16x32_bf16 a[172:175], v[40:43], v[52:55], a[172:175]
 v_mfma_f32_16x16x32_bf16 a[232:235], v[36:39], v[56:59], a[232:235]
 v_mfma_f32_16x16x32_bf16 a[236:239], v[40:43], v[56:59], a[236:239]
 s_waitcnt lgkmcnt(2)
 ds_read_b64_tr_b16 v[36:37], v1 offset:448
 v_mfma_f32_16x16x32_bf16 v[172:175], v[28:31], v[44:47], v[172:175]
 s_waitcnt lgkmcnt(1)
 ds_read_b64_tr_b16 v[38:39], v1 offset:960
 v_mfma_f32_16x16x32_bf16 v[176:179], v[32:35], v[44:47], v[176:179]
 v_mfma_f32_16x16x32_bf16 v[236:239], v[28:31], v[48:51], v[236:239]
 v_mfma_f32_16x16x32_bf16 v[240:243], v[32:35], v[48:51], v[240:243]
 ds_read_b64_tr_b16 v[40:41], v1 offset:480
 v_mfma_f32_16x16x32_bf16 a[176:179], v[28:31], v[52:55], a[176:179]
 ds_read_b64_tr_b16 v[42:43], v1 offset:992
 v_mfma_f32_16x16x32_bf16 a[180:183], v[32:35], v[52:55], a[180:183]
 v_mfma_f32_16x16x32_bf16 a[240:243], v[28:31], v[56:59], a[240:243]
 v_add_u32 v1, 16896, v1
 v_mfma_f32_16x16x32_bf16 a[244:247], v[32:35], v[56:59], a[244:247]
 s_waitcnt lgkmcnt(2)
 ds_read_b128 v[28:31], v0
 v_mfma_f32_16x16x32_bf16 v[180:183], v[36:39], v[44:47], v[180:183]
 s_waitcnt lgkmcnt(1)
 v_mfma_f32_16x16x32_bf16 v[184:187], v[40:43], v[44:47], v[184:187]
 v_mfma_f32_16x16x32_bf16 v[244:247], v[36:39], v[48:51], v[244:247]
 v_mfma_f32_16x16x32_bf16 v[248:251], v[40:43], v[48:51], v[248:251]
 ds_read_b128 v[32:35], v0 offset:64
 v_mfma_f32_16x16x32_bf16 a[184:187], v[36:39], v[52:55], a[184:187]
 v_exp_f32 v20, v92
 v_mfma_f32_16x16x32_bf16 a[188:191], v[40:43], v[52:55], a[188:191]
 v_exp_f32 v21, v93
 v_mfma_f32_16x16x32_bf16 a[248:251], v[36:39], v[56:59], a[248:251]
 v_add_f32 v14, v20, v21
 v_mfma_f32_16x16x32_bf16 a[252:255], v[40:43], v[56:59], a[252:255]
 s_waitcnt lgkmcnt(1)
 ds_read_b128 v[36:39], v0 offset:512
 v_cvt_pk_bf16_f32 v44, v20, v21
 v_mfma_f32_16x16x32_bf16 v[60:63], v[28:31], a[0:3], 0
 s_waitcnt lgkmcnt(1)
 v_exp_f32 v22, v94
 v_mfma_f32_16x16x32_bf16 v[60:63], v[32:35], a[4:7], v[60:63]
 v_exp_f32 v23, v95
 v_mfma_f32_16x16x32_bf16 v[68:71], v[28:31], a[32:35], 0
 v_add_f32 v14, v14, v22
 v_add_f32 v14, v14, v23
 v_mfma_f32_16x16x32_bf16 v[68:71], v[32:35], a[36:39], v[68:71]
 ds_read_b128 v[40:43], v0 offset:576
 v_cvt_pk_bf16_f32 v45, v22, v23
 v_mfma_f32_16x16x32_bf16 v[76:79], v[28:31], a[64:67], 0
 v_exp_f32 v20, v96
 v_mfma_f32_16x16x32_bf16 v[76:79], v[32:35], a[68:71], v[76:79]
 v_exp_f32 v21, v97
 v_mfma_f32_16x16x32_bf16 v[84:87], v[28:31], a[96:99], 0
 v_add_f32 v14, v14, v20
 v_add_f32 v14, v14, v21
 v_mfma_f32_16x16x32_bf16 v[84:87], v[32:35], a[100:103], v[84:87]
 s_waitcnt lgkmcnt(1)
 ds_read_b128 v[28:31], v0 offset:128
 v_cvt_pk_bf16_f32 v46, v20, v21
 v_mfma_f32_16x16x32_bf16 v[64:67], v[36:39], a[0:3], 0
 s_waitcnt lgkmcnt(1)
 v_exp_f32 v22, v98
 v_mfma_f32_16x16x32_bf16 v[64:67], v[40:43], a[4:7], v[64:67]
 v_exp_f32 v23, v99
 v_mfma_f32_16x16x32_bf16 v[72:75], v[36:39], a[32:35], 0
 v_add_f32 v14, v14, v22
 v_add_f32 v14, v14, v23
 v_mfma_f32_16x16x32_bf16 v[72:75], v[40:43], a[36:39], v[72:75]
 ds_read_b128 v[32:35], v0 offset:192
 v_cvt_pk_bf16_f32 v47, v22, v23
 v_mfma_f32_16x16x32_bf16 v[80:83], v[36:39], a[64:67], 0
 v_exp_f32 v20, v100
 v_mfma_f32_16x16x32_bf16 v[80:83], v[40:43], a[68:71], v[80:83]
 v_exp_f32 v21, v101
 v_mfma_f32_16x16x32_bf16 v[88:91], v[36:39], a[96:99], 0
 v_add_f32 v15, v20, v21
 v_mfma_f32_16x16x32_bf16 v[88:91], v[40:43], a[100:103], v[88:91]
 s_waitcnt lgkmcnt(1)
 ds_read_b128 v[36:39], v0 offset:640
 v_cvt_pk_bf16_f32 v48, v20, v21
 v_mfma_f32_16x16x32_bf16 v[60:63], v[28:31], a[8:11], v[60:63]
 s_waitcnt lgkmcnt(1)
 v_exp_f32 v22, v102
 v_mfma_f32_16x16x32_bf16 v[60:63], v[32:35], a[12:15], v[60:63]
 v_exp_f32 v23, v103
 v_mfma_f32_16x16x32_bf16 v[68:71], v[28:31], a[40:43], v[68:71]
 v_add_f32 v15, v15, v22
 v_add_f32 v15, v15, v23
 v_mfma_f32_16x16x32_bf16 v[68:71], v[32:35], a[44:47], v[68:71]
 ds_read_b128 v[40:43], v0 offset:704
 v_cvt_pk_bf16_f32 v49, v22, v23
 v_mfma_f32_16x16x32_bf16 v[76:79], v[28:31], a[72:75], v[76:79]
 v_exp_f32 v20, v104
 v_mfma_f32_16x16x32_bf16 v[76:79], v[32:35], a[76:79], v[76:79]
 v_exp_f32 v21, v105
 v_mfma_f32_16x16x32_bf16 v[84:87], v[28:31], a[104:107], v[84:87]
 v_add_f32 v15, v15, v20
 v_add_f32 v15, v15, v21
 v_mfma_f32_16x16x32_bf16 v[84:87], v[32:35], a[108:111], v[84:87]
 s_waitcnt lgkmcnt(1)
 ds_read_b128 v[28:31], v0 offset:256
 v_cvt_pk_bf16_f32 v50, v20, v21
 v_mfma_f32_16x16x32_bf16 v[64:67], v[36:39], a[8:11], v[64:67]
 s_waitcnt lgkmcnt(1)
 v_exp_f32 v22, v106
 v_mfma_f32_16x16x32_bf16 v[64:67], v[40:43], a[12:15], v[64:67]
 v_exp_f32 v23, v107
 v_mfma_f32_16x16x32_bf16 v[72:75], v[36:39], a[40:43], v[72:75]
 v_add_f32 v15, v15, v22
 v_add_f32 v15, v15, v23
 v_mfma_f32_16x16x32_bf16 v[72:75], v[40:43], a[44:47], v[72:75]
 ds_read_b128 v[32:35], v0 offset:320
 v_cvt_pk_bf16_f32 v51, v22, v23
 v_mfma_f32_16x16x32_bf16 v[80:83], v[36:39], a[72:75], v[80:83]
 v_exp_f32 v20, v108
 v_mfma_f32_16x16x32_bf16 v[80:83], v[40:43], a[76:79], v[80:83]
 v_exp_f32 v21, v109
 v_mfma_f32_16x16x32_bf16 v[88:91], v[36:39], a[104:107], v[88:91]
 v_add_f32 v16, v20, v21
 v_mfma_f32_16x16x32_bf16 v[88:91], v[40:43], a[108:111], v[88:91]
 s_waitcnt lgkmcnt(1)
 ds_read_b128 v[36:39], v0 offset:768
 v_cvt_pk_bf16_f32 v52, v20, v21
 v_mfma_f32_16x16x32_bf16 v[60:63], v[28:31], a[16:19], v[60:63]
 s_waitcnt lgkmcnt(1)
 v_exp_f32 v22, v110
 v_mfma_f32_16x16x32_bf16 v[60:63], v[32:35], a[20:23], v[60:63]
 v_exp_f32 v23, v111
 v_mfma_f32_16x16x32_bf16 v[68:71], v[28:31], a[48:51], v[68:71]
 v_add_f32 v16, v16, v22
 v_add_f32 v16, v16, v23
 v_mfma_f32_16x16x32_bf16 v[68:71], v[32:35], a[52:55], v[68:71]
 ds_read_b128 v[40:43], v0 offset:832
 v_cvt_pk_bf16_f32 v53, v22, v23
 v_mfma_f32_16x16x32_bf16 v[76:79], v[28:31], a[80:83], v[76:79]
 v_exp_f32 v20, v112
 v_mfma_f32_16x16x32_bf16 v[76:79], v[32:35], a[84:87], v[76:79]
 v_exp_f32 v21, v113
 v_mfma_f32_16x16x32_bf16 v[84:87], v[28:31], a[112:115], v[84:87]
 v_add_f32 v16, v16, v20
 v_add_f32 v16, v16, v21
 v_mfma_f32_16x16x32_bf16 v[84:87], v[32:35], a[116:119], v[84:87]
 s_waitcnt lgkmcnt(1)
 ds_read_b128 v[28:31], v0 offset:384
 v_cvt_pk_bf16_f32 v54, v20, v21
 v_mfma_f32_16x16x32_bf16 v[64:67], v[36:39], a[16:19], v[64:67]
 s_waitcnt lgkmcnt(1)
 v_exp_f32 v22, v114
 v_mfma_f32_16x16x32_bf16 v[64:67], v[40:43], a[20:23], v[64:67]
 v_exp_f32 v23, v115
 v_mfma_f32_16x16x32_bf16 v[72:75], v[36:39], a[48:51], v[72:75]
 v_add_f32 v16, v16, v22
 v_add_f32 v16, v16, v23
 v_mfma_f32_16x16x32_bf16 v[72:75], v[40:43], a[52:55], v[72:75]
 ds_read_b128 v[32:35], v0 offset:448
 v_cvt_pk_bf16_f32 v55, v22, v23
 v_mfma_f32_16x16x32_bf16 v[80:83], v[36:39], a[80:83], v[80:83]
 v_exp_f32 v20, v116
 v_mfma_f32_16x16x32_bf16 v[80:83], v[40:43], a[84:87], v[80:83]
 v_exp_f32 v21, v117
 v_mfma_f32_16x16x32_bf16 v[88:91], v[36:39], a[112:115], v[88:91]
 v_add_f32 v17, v20, v21
 v_mfma_f32_16x16x32_bf16 v[88:91], v[40:43], a[116:119], v[88:91]
 s_waitcnt lgkmcnt(1)
 ds_read_b128 v[36:39], v0 offset:896
 v_cvt_pk_bf16_f32 v56, v20, v21
 v_mfma_f32_16x16x32_bf16 v[60:63], v[28:31], a[24:27], v[60:63]
 s_waitcnt lgkmcnt(1)
 v_exp_f32 v22, v118
 v_mfma_f32_16x16x32_bf16 v[60:63], v[32:35], a[28:31], v[60:63]
 v_exp_f32 v23, v119
 v_mfma_f32_16x16x32_bf16 v[68:71], v[28:31], a[56:59], v[68:71]
 v_add_f32 v17, v17, v22
 v_add_f32 v17, v17, v23
 v_mfma_f32_16x16x32_bf16 v[68:71], v[32:35], a[60:63], v[68:71]
 ds_read_b128 v[40:43], v0 offset:960
 v_cvt_pk_bf16_f32 v57, v22, v23
 v_mfma_f32_16x16x32_bf16 v[76:79], v[28:31], a[88:91], v[76:79]
 v_exp_f32 v20, v120
 v_mfma_f32_16x16x32_bf16 v[76:79], v[32:35], a[92:95], v[76:79]
 v_exp_f32 v21, v121
 v_mfma_f32_16x16x32_bf16 v[84:87], v[28:31], a[120:123], v[84:87]
 v_add_f32 v17, v17, v20
 v_add_f32 v17, v17, v21
 v_mfma_f32_16x16x32_bf16 v[84:87], v[32:35], a[124:127], v[84:87]
 s_waitcnt lgkmcnt(1)
 ds_read_b64_tr_b16 v[28:29], v1
 v_cvt_pk_bf16_f32 v58, v20, v21
 v_mfma_f32_16x16x32_bf16 v[64:67], v[36:39], a[24:27], v[64:67]
 s_waitcnt lgkmcnt(1)
 ds_read_b64_tr_b16 v[30:31], v1 offset:512
 v_exp_f32 v22, v122
 v_mfma_f32_16x16x32_bf16 v[64:67], v[40:43], a[28:31], v[64:67]
 v_exp_f32 v23, v123
 v_mfma_f32_16x16x32_bf16 v[72:75], v[36:39], a[56:59], v[72:75]
 v_add_f32 v17, v17, v22
 v_add_f32 v17, v17, v23
 v_mfma_f32_16x16x32_bf16 v[72:75], v[40:43], a[60:63], v[72:75]
 ds_read_b64_tr_b16 v[32:33], v1 offset:32
 v_cvt_pk_bf16_f32 v59, v22, v23
 v_mfma_f32_16x16x32_bf16 v[80:83], v[36:39], a[88:91], v[80:83]
 ds_read_b64_tr_b16 v[34:35], v1 offset:544
 v_max3_f32 v252, v14, v15, v16
 v_max_f32 v252, v252, v17
 v_mfma_f32_16x16x32_bf16 v[80:83], v[40:43], a[92:95], v[80:83]
 v_cmp_lt_f32 vcc, s30, v252
 v_mfma_f32_16x16x32_bf16 v[88:91], v[36:39], a[120:123], v[88:91]
 v_mfma_f32_16x16x32_bf16 v[88:91], v[40:43], a[124:127], v[88:91]
 s_waitcnt lgkmcnt(2)
 ds_read_b64_tr_b16 v[36:37], v1 offset:64
 s_cbranch_vccnz L_rare_T13
L_back_T13:
 v_mfma_f32_16x16x32_bf16 v[124:127], v[28:31], v[44:47], v[124:127]
 s_waitcnt vmcnt(8)
 s_barrier
 s_waitcnt lgkmcnt(1)
 ds_read_b64_tr_b16 v[38:39], v1 offset:576
 v_mfma_f32_16x16x32_bf16 v[128:131], v[32:35], v[44:47], v[128:131]
 s_add_u32 s42, s36, 16512
 s_add_u32 m0, s32, 33792
 v_add_f32 v10, v10, v14
 v_add_f32 v11, v11, v15
 v_mfma_f32_16x16x32_bf16 v[188:191], v[28:31], v[48:51], v[188:191]
 buffer_load_dwordx4 v4, s[12:15], s42 offen nt lds
 v_add_f32 v12, v12, v16
 v_mfma_f32_16x16x32_bf16 v[192:195], v[32:35], v[48:51], v[192:195]
 ds_read_b64_tr_b16 v[40:41], v1 offset:96
 v_add_f32 v13, v13, v17
 v_mfma_f32_16x16x32_bf16 a[128:131], v[28:31], v[52:55], a[128:131]
 ds_read_b64_tr_b16 v[42:43], v1 offset:608
 v_mfma_f32_16x16x32_bf16 a[132:135], v[32:35], v[52:55], a[132:135]
 s_add_u32 s42, s36, 20608
 s_add_u32 m0, s32, 34816
 v_mfma_f32_16x16x32_bf16 a[192:195], v[28:31], v[56:59], a[192:195]
 buffer_load_dwordx4 v5, s[12:15], s42 offen nt lds
 v_mfma_f32_16x16x32_bf16 a[196:199], v[32:35], v[56:59], a[196:199]
 s_waitcnt lgkmcnt(2)
 ds_read_b64_tr_b16 v[28:29], v1 offset:128
 v_mfma_f32_16x16x32_bf16 v[132:135], v[36:39], v[44:47], v[132:135]
 s_waitcnt lgkmcnt(1)
 ds_read_b64_tr_b16 v[30:31], v1 offset:640
 v_mfma_f32_16x16x32_bf16 v[136:139], v[40:43], v[44:47], v[136:139]
 s_add_u32 s42, s36, 24704
 s_add_u32 m0, s32, 35840
 v_mfma_f32_16x16x32_bf16 v[196:199], v[36:39], v[48:51], v[196:199]
 buffer_load_dwordx4 v4, s[12:15], s42 offen nt lds
 v_mfma_f32_16x16x32_bf16 v[200:203], v[40:43], v[48:51], v[200:203]
 ds_read_b64_tr_b16 v[32:33], v1 offset:160
 v_mfma_f32_16x16x32_bf16 a[136:139], v[36:39], v[52:55], a[136:139]
 ds_read_b64_tr_b16 v[34:35], v1 offset:672
 v_mfma_f32_16x16x32_bf16 a[140:143], v[40:43], v[52:55], a[140:143]
 s_add_u32 s42, s36, 28800
 s_add_u32 m0, s32, 36864
 v_mfma_f32_16x16x32_bf16 a[200:203], v[36:39], v[56:59], a[200:203]
 buffer_load_dwordx4 v5, s[12:15], s42 offen nt lds
 v_mfma_f32_16x16x32_bf16 a[204:207], v[40:43], v[56:59], a[204:207]
 s_waitcnt lgkmcnt(2)
 ds_read_b64_tr_b16 v[36:37], v1 offset:192
 v_mfma_f32_16x16x32_bf16 v[140:143], v[28:31], v[44:47], v[140:143]
 s_waitcnt lgkmcnt(1)
 ds_read_b64_tr_b16 v[38:39], v1 offset:704
 v_mfma_f32_16x16x32_bf16 v[144:147], v[32:35], v[44:47], v[144:147]
 s_add_u32 s42, s36, 256
 s_add_u32 m0, s32, 50688
 v_mfma_f32_16x16x32_bf16 v[204:207], v[28:31], v[48:51], v[204:207]
 buffer_load_dwordx4 v4, s[12:15], s42 offen nt lds
 v_mfma_f32_16x16x32_bf16 v[208:211], v[32:35], v[48:51], v[208:211]
 ds_read_b64_tr_b16 v[40:41], v1 offset:224
 v_mfma_f32_16x16x32_bf16 a[144:147], v[28:31], v[52:55], a[144:147]
 ds_read_b64_tr_b16 v[42:43], v1 offset:736
 v_fma_f32 v60, v60, s29, -v6
 v_mfma_f32_16x16x32_bf16 a[148:151], v[32:35], v[52:55], a[148:151]
 s_add_u32 s42, s36, 4352
 s_add_u32 m0, s32, 51712
 v_fma_f32 v61, v61, s29, -v6
 v_fma_f32 v62, v62, s29, -v6
 v_mfma_f32_16x16x32_bf16 a[208:211], v[28:31], v[56:59], a[208:211]
 buffer_load_dwordx4 v5, s[12:15], s42 offen nt lds
 v_fma_f32 v63, v63, s29, -v6
 v_mfma_f32_16x16x32_bf16 a[212:215], v[32:35], v[56:59], a[212:215]
 s_waitcnt lgkmcnt(2)
 ds_read_b64_tr_b16 v[28:29], v1 offset:256
 v_fma_f32 v64, v64, s29, -v6
 v_mfma_f32_16x16x32_bf16 v[148:151], v[36:39], v[44:47], v[148:151]
 s_waitcnt lgkmcnt(1)
 ds_read_b64_tr_b16 v[30:31], v1 offset:768
 v_fma_f32 v65, v65, s29, -v6
 v_mfma_f32_16x16x32_bf16 v[152:155], v[40:43], v[44:47], v[152:155]
 s_add_u32 s42, s36, 8448
 s_add_u32 m0, s32, 52736
 v_fma_f32 v66, v66, s29, -v6
 v_fma_f32 v67, v67, s29, -v6
 v_mfma_f32_16x16x32_bf16 v[212:215], v[36:39], v[48:51], v[212:215]
 buffer_load_dwordx4 v4, s[12:15], s42 offen nt lds
 v_fma_f32 v68, v68, s29, -v7
 v_mfma_f32_16x16x32_bf16 v[216:219], v[40:43], v[48:51], v[216:219]
 ds_read_b64_tr_b16 v[32:33], v1 offset:288
 v_fma_f32 v69, v69, s29, -v7
 v_mfma_f32_16x16x32_bf16 a[152:155], v[36:39], v[52:55], a[152:155]
 ds_read_b64_tr_b16 v[34:35], v1 offset:800
 v_fma_f32 v70, v70, s29, -v7
 v_mfma_f32_16x16x32_bf16 a[156:159], v[40:43], v[52:55], a[156:159]
 s_add_u32 s42, s36, 12544
 s_add_u32 m0, s32, 53760
 v_fma_f32 v71, v71, s29, -v7
 v_fma_f32 v72, v72, s29, -v7
 v_mfma_f32_16x16x32_bf16 a[216:219], v[36:39], v[56:59], a[216:219]
 buffer_load_dwordx4 v5, s[12:15], s42 offen nt lds
 v_add_u32 v0, 4294933504, v0
 v_mfma_f32_16x16x32_bf16 a[220:223], v[40:43], v[56:59], a[220:223]
 s_waitcnt lgkmcnt(2)
 ds_read_b64_tr_b16 v[36:37], v1 offset:320
 v_fma_f32 v73, v73, s29, -v7
 v_mfma_f32_16x16x32_bf16 v[156:159], v[28:31], v[44:47], v[156:159]
 s_waitcnt lgkmcnt(1)
 ds_read_b64_tr_b16 v[38:39], v1 offset:832
 v_fma_f32 v74, v74, s29, -v7
 v_mfma_f32_16x16x32_bf16 v[160:163], v[32:35], v[44:47], v[160:163]
 v_fma_f32 v75, v75, s29, -v7
 v_fma_f32 v76, v76, s29, -v8
 v_mfma_f32_16x16x32_bf16 v[220:223], v[28:31], v[48:51], v[220:223]
 v_fma_f32 v77, v77, s29, -v8
 v_fma_f32 v78, v78, s29, -v8
 v_mfma_f32_16x16x32_bf16 v[224:227], v[32:35], v[48:51], v[224:227]
 ds_read_b64_tr_b16 v[40:41], v1 offset:352
 v_fma_f32 v79, v79, s29, -v8
 v_mfma_f32_16x16x32_bf16 a[160:163], v[28:31], v[52:55], a[160:163]
 ds_read_b64_tr_b16 v[42:43], v1 offset:864
 v_fma_f32 v80, v80, s29, -v8
 v_mfma_f32_16x16x32_bf16 a[164:167], v[32:35], v[52:55], a[164:167]
 v_fma_f32 v81, v81, s29, -v8
 v_fma_f32 v82, v82, s29, -v8
 v_mfma_f32_16x16x32_bf16 a[224:227], v[28:31], v[56:59], a[224:227]
 v_fma_f32 v83, v83, s29, -v8
 v_fma_f32 v84, v84, s29, -v9
 v_mfma_f32_16x16x32_bf16 a[228:231], v[32:35], v[56:59], a[228:231]
 s_waitcnt lgkmcnt(2)
 ds_read_b64_tr_b16 v[28:29], v1 offset:384
 v_fma_f32 v85, v85, s29, -v9
 v_mfma_f32_16x16x32_bf16 v[164:167], v[36:39], v[44:47], v[164:167]
 s_waitcnt lgkmcnt(1)
 ds_read_b64_tr_b16 v[30:31], v1 offset:896
 v_fma_f32 v86, v86, s29, -v9
 v_mfma_f32_16x16x32_bf16 v[168:171], v[40:43], v[44:47], v[168:171]
 v_fma_f32 v87, v87, s29, -v9
 v_fma_f32 v88, v88, s29, -v9
 v_mfma_f32_16x16x32_bf16 v[228:231], v[36:39], v[48:51], v[228:231]
 v_fma_f32 v89, v89, s29, -v9
 v_fma_f32 v90, v90, s29, -v9
 v_mfma_f32_16x16x32_bf16 v[232:235], v[40:43], v[48:51], v[232:235]
 ds_read_b64_tr_b16 v[32:33], v1 offset:416
 v_fma_f32 v91, v91, s29, -v9
 v_mfma_f32_16x16x32_bf16 a[168:171], v[36:39], v[52:55], a[168:171]
 ds_read_b64_tr_b16 v[34:35], v1 offset:928
 v_mfma_f32_16x16x32_bf16 a[172:175], v[40:43], v[52:55], a[172:175]
 v_mfma_f32_16x16x32_bf16 a[232:235], v[36:39], v[56:59], a[232:235]
 v_mfma_f32_16x16x32_bf16 a[236:239], v[40:43], v[56:59], a[236:239]
 s_waitcnt lgkmcnt(2)
 ds_read_b64_tr_b16 v[36:37], v1 offset:448
 v_mfma_f32_16x16x32_bf16 v[172:175], v[28:31], v[44:47], v[172:175]
 s_waitcnt lgkmcnt(1)
 ds_read_b64_tr_b16 v[38:39], v1 offset:960
 v_mfma_f32_16x16x32_bf16 v[176:179], v[32:35], v[44:47], v[176:179]
 v_mfma_f32_16x16x32_bf16 v[236:239], v[28:31], v[48:51], v[236:239]
 v_mfma_f32_16x16x32_bf16 v[240:243], v[32:35], v[48:51], v[240:243]
 ds_read_b64_tr_b16 v[40:41], v1 offset:480
 v_mfma_f32_16x16x32_bf16 a[176:179], v[28:31], v[52:55], a[176:179]
 ds_read_b64_tr_b16 v[42:43], v1 offset:992
 v_mfma_f32_16x16x32_bf16 a[180:183], v[32:35], v[52:55], a[180:183]
 v_mfma_f32_16x16x32_bf16 a[240:243], v[28:31], v[56:59], a[240:243]
 v_add_u32 v1, 16896, v1
 v_mfma_f32_16x16x32_bf16 a[244:247], v[32:35], v[56:59], a[244:247]
 s_waitcnt lgkmcnt(2)
 ds_read_b128 v[28:31], v0
 v_mfma_f32_16x16x32_bf16 v[180:183], v[36:39], v[44:47], v[180:183]
 s_waitcnt lgkmcnt(1)
 v_mfma_f32_16x16x32_bf16 v[184:187], v[40:43], v[44:47], v[184:187]
 v_mfma_f32_16x16x32_bf16 v[244:247], v[36:39], v[48:51], v[244:247]
 v_mfma_f32_16x16x32_bf16 v[248:251], v[40:43], v[48:51], v[248:251]
 ds_read_b128 v[32:35], v0 offset:64
 v_mfma_f32_16x16x32_bf16 a[184:187], v[36:39], v[52:55], a[184:187]
 v_exp_f32 v20, v60
 v_mfma_f32_16x16x32_bf16 a[188:191], v[40:43], v[52:55], a[188:191]
 v_exp_f32 v21, v61
 v_mfma_f32_16x16x32_bf16 a[248:251], v[36:39], v[56:59], a[248:251]
 v_add_f32 v14, v20, v21
 v_mfma_f32_16x16x32_bf16 a[252:255], v[40:43], v[56:59], a[252:255]
 s_waitcnt lgkmcnt(1)
 ds_read_b128 v[36:39], v0 offset:512
 v_cvt_pk_bf16_f32 v44, v20, v21
 v_mfma_f32_16x16x32_bf16 v[92:95], v[28:31], a[0:3], 0
 s_waitcnt lgkmcnt(1)
 v_exp_f32 v22, v62
 v_mfma_f32_16x16x32_bf16 v[92:95], v[32:35], a[4:7], v[92:95]
 v_exp_f32 v23, v63
 v_mfma_f32_16x16x32_bf16 v[100:103], v[28:31], a[32:35], 0
 v_add_f32 v14, v14, v22
 v_add_f32 v14, v14, v23
 v_mfma_f32_16x16x32_bf16 v[100:103], v[32:35], a[36:39], v[100:103]
 ds_read_b128 v[40:43], v0 offset:576
 v_cvt_pk_bf16_f32 v45, v22, v23
 v_mfma_f32_16x16x32_bf16 v[108:111], v[28:31], a[64:67], 0
 v_exp_f32 v20, v64
 v_mfma_f32_16x16x32_bf16 v[108:111], v[32:35], a[68:71], v[108:111]
 v_exp_f32 v21, v65
 v_mfma_f32_16x16x32_bf16 v[116:119], v[28:31], a[96:99], 0
 v_add_f32 v14, v14, v20
 v_add_f32 v14, v14, v21
 v_mfma_f32_16x16x32_bf16 v[116:119], v[32:35], a[100:103], v[116:119]
 s_waitcnt lgkmcnt(1)
 ds_read_b128 v[28:31], v0 offset:128
 v_cvt_pk_bf16_f32 v46, v20, v21
 v_mfma_f32_16x16x32_bf16 v[96:99], v[36:39], a[0:3], 0
 s_waitcnt lgkmcnt(1)
 v_exp_f32 v22, v66
 v_mfma_f32_16x16x32_bf16 v[96:99], v[40:43], a[4:7], v[96:99]
 v_exp_f32 v23, v67
 v_mfma_f32_16x16x32_bf16 v[104:107], v[36:39], a[32:35], 0
 v_add_f32 v14, v14, v22
 v_add_f32 v14, v14, v23
 v_mfma_f32_16x16x32_bf16 v[104:107], v[40:43], a[36:39], v[104:107]
 ds_read_b128 v[32:35], v0 offset:192
 v_cvt_pk_bf16_f32 v47, v22, v23
 v_mfma_f32_16x16x32_bf16 v[112:115], v[36:39], a[64:67], 0
 v_exp_f32 v20, v68
 v_mfma_f32_16x16x32_bf16 v[112:115], v[40:43], a[68:71], v[112:115]
 v_exp_f32 v21, v69
 v_mfma_f32_16x16x32_bf16 v[120:123], v[36:39], a[96:99], 0
 v_add_f32 v15, v20, v21
 v_mfma_f32_16x16x32_bf16 v[120:123], v[40:43], a[100:103], v[120:123]
 s_waitcnt lgkmcnt(1)
 ds_read_b128 v[36:39], v0 offset:640
 v_cvt_pk_bf16_f32 v48, v20, v21
 v_mfma_f32_16x16x32_bf16 v[92:95], v[28:31], a[8:11], v[92:95]
 s_waitcnt lgkmcnt(1)
 v_exp_f32 v22, v70
 v_mfma_f32_16x16x32_bf16 v[92:95], v[32:35], a[12:15], v[92:95]
 v_exp_f32 v23, v71
 v_mfma_f32_16x16x32_bf16 v[100:103], v[28:31], a[40:43], v[100:103]
 v_add_f32 v15, v15, v22
 v_add_f32 v15, v15, v23
 v_mfma_f32_16x16x32_bf16 v[100:103], v[32:35], a[44:47], v[100:103]
 ds_read_b128 v[40:43], v0 offset:704
 v_cvt_pk_bf16_f32 v49, v22, v23
 v_mfma_f32_16x16x32_bf16 v[108:111], v[28:31], a[72:75], v[108:111]
 v_exp_f32 v20, v72
 v_mfma_f32_16x16x32_bf16 v[108:111], v[32:35], a[76:79], v[108:111]
 v_exp_f32 v21, v73
 v_mfma_f32_16x16x32_bf16 v[116:119], v[28:31], a[104:107], v[116:119]
 v_add_f32 v15, v15, v20
 v_add_f32 v15, v15, v21
 v_mfma_f32_16x16x32_bf16 v[116:119], v[32:35], a[108:111], v[116:119]
 s_waitcnt lgkmcnt(1)
 ds_read_b128 v[28:31], v0 offset:256
 v_cvt_pk_bf16_f32 v50, v20, v21
 v_mfma_f32_16x16x32_bf16 v[96:99], v[36:39], a[8:11], v[96:99]
 s_waitcnt lgkmcnt(1)
 v_exp_f32 v22, v74
 v_mfma_f32_16x16x32_bf16 v[96:99], v[40:43], a[12:15], v[96:99]
 v_exp_f32 v23, v75
 v_mfma_f32_16x16x32_bf16 v[104:107], v[36:39], a[40:43], v[104:107]
 v_add_f32 v15, v15, v22
 v_add_f32 v15, v15, v23
 v_mfma_f32_16x16x32_bf16 v[104:107], v[40:43], a[44:47], v[104:107]
 ds_read_b128 v[32:35], v0 offset:320
 v_cvt_pk_bf16_f32 v51, v22, v23
 v_mfma_f32_16x16x32_bf16 v[112:115], v[36:39], a[72:75], v[112:115]
 v_exp_f32 v20, v76
 v_mfma_f32_16x16x32_bf16 v[112:115], v[40:43], a[76:79], v[112:115]
 v_exp_f32 v21, v77
 v_mfma_f32_16x16x32_bf16 v[120:123], v[36:39], a[104:107], v[120:123]
 v_add_f32 v16, v20, v21
 v_mfma_f32_16x16x32_bf16 v[120:123], v[40:43], a[108:111], v[120:123]
 s_waitcnt lgkmcnt(1)
 ds_read_b128 v[36:39], v0 offset:768
 v_cvt_pk_bf16_f32 v52, v20, v21
 v_mfma_f32_16x16x32_bf16 v[92:95], v[28:31], a[16:19], v[92:95]
 s_waitcnt lgkmcnt(1)
 v_exp_f32 v22, v78
 v_mfma_f32_16x16x32_bf16 v[92:95], v[32:35], a[20:23], v[92:95]
 v_exp_f32 v23, v79
 v_mfma_f32_16x16x32_bf16 v[100:103], v[28:31], a[48:51], v[100:103]
 v_add_f32 v16, v16, v22
 v_add_f32 v16, v16, v23
 v_mfma_f32_16x16x32_bf16 v[100:103], v[32:35], a[52:55], v[100:103]
 ds_read_b128 v[40:43], v0 offset:832
 v_cvt_pk_bf16_f32 v53, v22, v23
 v_mfma_f32_16x16x32_bf16 v[108:111], v[28:31], a[80:83], v[108:111]
 v_exp_f32 v20, v80
 v_mfma_f32_16x16x32_bf16 v[108:111], v[32:35], a[84:87], v[108:111]
 v_exp_f32 v21, v81
 v_mfma_f32_16x16x32_bf16 v[116:119], v[28:31], a[112:115], v[116:119]
 v_add_f32 v16, v16, v20
 v_add_f32 v16, v16, v21
 v_mfma_f32_16x16x32_bf16 v[116:119], v[32:35], a[116:119], v[116:119]
 s_waitcnt lgkmcnt(1)
 ds_read_b128 v[28:31], v0 offset:384
 v_cvt_pk_bf16_f32 v54, v20, v21
 v_mfma_f32_16x16x32_bf16 v[96:99], v[36:39], a[16:19], v[96:99]
 s_waitcnt lgkmcnt(1)
 v_exp_f32 v22, v82
 v_mfma_f32_16x16x32_bf16 v[96:99], v[40:43], a[20:23], v[96:99]
 v_exp_f32 v23, v83
 v_mfma_f32_16x16x32_bf16 v[104:107], v[36:39], a[48:51], v[104:107]
 v_add_f32 v16, v16, v22
 v_add_f32 v16, v16, v23
 v_mfma_f32_16x16x32_bf16 v[104:107], v[40:43], a[52:55], v[104:107]
 ds_read_b128 v[32:35], v0 offset:448
 v_cvt_pk_bf16_f32 v55, v22, v23
 v_mfma_f32_16x16x32_bf16 v[112:115], v[36:39], a[80:83], v[112:115]
 v_exp_f32 v20, v84
 v_mfma_f32_16x16x32_bf16 v[112:115], v[40:43], a[84:87], v[112:115]
 v_exp_f32 v21, v85
 v_mfma_f32_16x16x32_bf16 v[120:123], v[36:39], a[112:115], v[120:123]
 v_add_f32 v17, v20, v21
 v_mfma_f32_16x16x32_bf16 v[120:123], v[40:43], a[116:119], v[120:123]
 s_waitcnt lgkmcnt(1)
 ds_read_b128 v[36:39], v0 offset:896
 v_cvt_pk_bf16_f32 v56, v20, v21
 v_mfma_f32_16x16x32_bf16 v[92:95], v[28:31], a[24:27], v[92:95]
 s_waitcnt lgkmcnt(1)
 v_exp_f32 v22, v86
 v_mfma_f32_16x16x32_bf16 v[92:95], v[32:35], a[28:31], v[92:95]
 v_exp_f32 v23, v87
 v_mfma_f32_16x16x32_bf16 v[100:103], v[28:31], a[56:59], v[100:103]
 v_add_f32 v17, v17, v22
 v_add_f32 v17, v17, v23
 v_mfma_f32_16x16x32_bf16 v[100:103], v[32:35], a[60:63], v[100:103]
 ds_read_b128 v[40:43], v0 offset:960
 v_cvt_pk_bf16_f32 v57, v22, v23
 v_mfma_f32_16x16x32_bf16 v[108:111], v[28:31], a[88:91], v[108:111]
 v_exp_f32 v20, v88
 v_mfma_f32_16x16x32_bf16 v[108:111], v[32:35], a[92:95], v[108:111]
 v_exp_f32 v21, v89
 v_mfma_f32_16x16x32_bf16 v[116:119], v[28:31], a[120:123], v[116:119]
 v_add_f32 v17, v17, v20
 v_add_f32 v17, v17, v21
 v_mfma_f32_16x16x32_bf16 v[116:119], v[32:35], a[124:127], v[116:119]
 s_waitcnt lgkmcnt(1)
 ds_read_b64_tr_b16 v[28:29], v1
 v_cvt_pk_bf16_f32 v58, v20, v21
 v_mfma_f32_16x16x32_bf16 v[96:99], v[36:39], a[24:27], v[96:99]
 s_waitcnt lgkmcnt(1)
 ds_read_b64_tr_b16 v[30:31], v1 offset:512
 v_exp_f32 v22, v90
 v_mfma_f32_16x16x32_bf16 v[96:99], v[40:43], a[28:31], v[96:99]
 v_exp_f32 v23, v91
 v_mfma_f32_16x16x32_bf16 v[104:107], v[36:39], a[56:59], v[104:107]
 v_add_f32 v17, v17, v22
 v_add_f32 v17, v17, v23
 v_mfma_f32_16x16x32_bf16 v[104:107], v[40:43], a[60:63], v[104:107]
 ds_read_b64_tr_b16 v[32:33], v1 offset:32
 v_cvt_pk_bf16_f32 v59, v22, v23
 v_mfma_f32_16x16x32_bf16 v[112:115], v[36:39], a[88:91], v[112:115]
 ds_read_b64_tr_b16 v[34:35], v1 offset:544
 v_max3_f32 v252, v14, v15, v16
 v_max_f32 v252, v252, v17
 v_mfma_f32_16x16x32_bf16 v[112:115], v[40:43], a[92:95], v[112:115]
 v_cmp_lt_f32 vcc, s30, v252
 v_mfma_f32_16x16x32_bf16 v[120:123], v[36:39], a[120:123], v[120:123]
 v_mfma_f32_16x16x32_bf16 v[120:123], v[40:43], a[124:127], v[120:123]
 s_waitcnt lgkmcnt(2)
 ds_read_b64_tr_b16 v[36:37], v1 offset:64
 s_cbranch_vccnz L_rare_T14
L_back_T14:
 v_mfma_f32_16x16x32_bf16 v[124:127], v[28:31], v[44:47], v[124:127]
 s_waitcnt vmcnt(12)
 s_barrier
 s_waitcnt lgkmcnt(1)
 ds_read_b64_tr_b16 v[38:39], v1 offset:576
 v_mfma_f32_16x16x32_bf16 v[128:131], v[32:35], v[44:47], v[128:131]
 s_add_u32 s38, s35, 0
 s_add_u32 m0, s31, 0
 v_add_f32 v10, v10, v14
 v_add_f32 v11, v11, v15
 v_mfma_f32_16x16x32_bf16 v[188:191], v[28:31], v[48:51], v[188:191]
 buffer_load_dwordx4 v2, s[80:83], s38 offen nt lds
 v_add_f32 v12, v12, v16
 v_mfma_f32_16x16x32_bf16 v[192:195], v[32:35], v[48:51], v[192:195]
 ds_read_b64_tr_b16 v[40:41], v1 offset:96
 v_add_f32 v13, v13, v17
 v_mfma_f32_16x16x32_bf16 a[128:131], v[28:31], v[52:55], a[128:131]
 ds_read_b64_tr_b16 v[42:43], v1 offset:608
 v_mfma_f32_16x16x32_bf16 a[132:135], v[32:35], v[52:55], a[132:135]
 s_add_u32 m0, s31, 544
 v_mfma_f32_16x16x32_bf16 a[192:195], v[28:31], v[56:59], a[192:195]
 buffer_load_dwordx4 v2, s[80:83], s38 offen offset:512 nt lds
 v_mfma_f32_16x16x32_bf16 a[196:199], v[32:35], v[56:59], a[196:199]
 s_waitcnt lgkmcnt(2)
 ds_read_b64_tr_b16 v[28:29], v1 offset:128
 v_mfma_f32_16x16x32_bf16 v[132:135], v[36:39], v[44:47], v[132:135]
 s_waitcnt lgkmcnt(1)
 ds_read_b64_tr_b16 v[30:31], v1 offset:640
 v_fma_f32 v92, v92, s29, -v6
 v_fma_f32 v93, v93, s29, -v6
 v_fma_f32 v94, v94, s29, -v6
 v_mfma_f32_16x16x32_bf16 v[136:139], v[40:43], v[44:47], v[136:139]
 s_add_u32 m0, s31, 1088
 v_fma_f32 v95, v95, s29, -v6
 v_fma_f32 v96, v96, s29, -v6
 v_fma_f32 v97, v97, s29, -v6
 v_mfma_f32_16x16x32_bf16 v[196:199], v[36:39], v[48:51], v[196:199]
 buffer_load_dwordx4 v2, s[80:83], s38 offen offset:1024 nt lds
 v_fma_f32 v98, v98, s29, -v6
 v_fma_f32 v99, v99, s29, -v6
 v_mfma_f32_16x16x32_bf16 v[200:203], v[40:43], v[48:51], v[200:203]
 ds_read_b64_tr_b16 v[32:33], v1 offset:160
 v_fma_f32 v100, v100, s29, -v7
 v_fma_f32 v101, v101, s29, -v7
 v_fma_f32 v102, v102, s29, -v7
 v_mfma_f32_16x16x32_bf16 a[136:139], v[36:39], v[52:55], a[136:139]
 ds_read_b64_tr_b16 v[34:35], v1 offset:672
 v_fma_f32 v103, v103, s29, -v7
 v_fma_f32 v104, v104, s29, -v7
 v_mfma_f32_16x16x32_bf16 a[140:143], v[40:43], v[52:55], a[140:143]
 s_add_u32 m0, s31, 1632
 v_fma_f32 v105, v105, s29, -v7
 v_fma_f32 v106, v106, s29, -v7
 v_fma_f32 v107, v107, s29, -v7
 v_mfma_f32_16x16x32_bf16 a[200:203], v[36:39], v[56:59], a[200:203]
 buffer_load_dwordx4 v2, s[80:83], s38 offen offset:1536 nt lds
 v_fma_f32 v108, v108, s29, -v8
 v_fma_f32 v109, v109, s29, -v8
 v_mfma_f32_16x16x32_bf16 a[204:207], v[40:43], v[56:59], a[204:207]
 s_waitcnt lgkmcnt(2)
 ds_read_b64_tr_b16 v[36:37], v1 offset:192
 v_fma_f32 v110, v110, s29, -v8
 v_fma_f32 v111, v111, s29, -v8
 v_fma_f32 v112, v112, s29, -v8
 v_mfma_f32_16x16x32_bf16 v[140:143], v[28:31], v[44:47], v[140:143]
 s_waitcnt lgkmcnt(1)
 ds_read_b64_tr_b16 v[38:39], v1 offset:704
 v_fma_f32 v113, v113, s29, -v8
 v_fma_f32 v114, v114, s29, -v8
 v_mfma_f32_16x16x32_bf16 v[144:147], v[32:35], v[44:47], v[144:147]
 s_add_u32 s42, s36, 16640
 s_add_u32 m0, s32, 67584
 v_fma_f32 v115, v115, s29, -v8
 v_fma_f32 v116, v116, s29, -v9
 v_fma_f32 v117, v117, s29, -v9
 v_mfma_f32_16x16x32_bf16 v[204:207], v[28:31], v[48:51], v[204:207]
 buffer_load_dwordx4 v4, s[12:15], s42 offen nt lds
 v_fma_f32 v118, v118, s29, -v9
 v_fma_f32 v119, v119, s29, -v9
 v_mfma_f32_16x16x32_bf16 v[208:211], v[32:35], v[48:51], v[208:211]
 ds_read_b64_tr_b16 v[40:41], v1 offset:224
 v_fma_f32 v120, v120, s29, -v9
 v_fma_f32 v121, v121, s29, -v9
 v_fma_f32 v122, v122, s29, -v9
 v_mfma_f32_16x16x32_bf16 a[144:147], v[28:31], v[52:55], a[144:147]
 ds_read_b64_tr_b16 v[42:43], v1 offset:736
 v_fma_f32 v123, v123, s29, -v9
 v_exp_f32 v20, v92
 v_mfma_f32_16x16x32_bf16 a[148:151], v[32:35], v[52:55], a[148:151]
 s_add_u32 s42, s36, 20736
 s_add_u32 m0, s32, 68608
 v_exp_f32 v21, v93
 v_mfma_f32_16x16x32_bf16 a[208:211], v[28:31], v[56:59], a[208:211]
 buffer_load_dwordx4 v5, s[12:15], s42 offen nt lds
 v_exp_f32 v22, v94
 v_exp_f32 v23, v95
 v_mfma_f32_16x16x32_bf16 a[212:215], v[32:35], v[56:59], a[212:215]
 s_waitcnt lgkmcnt(2)
 ds_read_b64_tr_b16 v[28:29], v1 offset:256
 v_add_f32 v14, v20, v21
 v_mfma_f32_16x16x32_bf16 v[148:151], v[36:39], v[44:47], v[148:151]
 s_waitcnt lgkmcnt(1)
 ds_read_b64_tr_b16 v[30:31], v1 offset:768
 v_cvt_pk_bf16_f32 v60, v20, v21
 v_exp_f32 v20, v96
 v_mfma_f32_16x16x32_bf16 v[152:155], v[40:43], v[44:47], v[152:155]
 s_add_u32 s42, s36, 24832
 s_add_u32 m0, s32, 69632
 v_exp_f32 v21, v97
 v_mfma_f32_16x16x32_bf16 v[212:215], v[36:39], v[48:51], v[212:215]
 buffer_load_dwordx4 v4, s[12:15], s42 offen nt lds
 v_add_f32 v14, v14, v22
 v_add_f32 v14, v14, v23
 v_cvt_pk_bf16_f32 v61, v22, v23
 v_mfma_f32_16x16x32_bf16 v[216:219], v[40:43], v[48:51], v[216:219]
 ds_read_b64_tr_b16 v[32:33], v1 offset:288
 v_exp_f32 v22, v98
 v_mfma_f32_16x16x32_bf16 a[152:155], v[36:39], v[52:55], a[152:155]
 ds_read_b64_tr_b16 v[34:35], v1 offset:800
 v_exp_f32 v23, v99
 v_add_f32 v14, v14, v20
 v_mfma_f32_16x16x32_bf16 a[156:159], v[40:43], v[52:55], a[156:159]
 s_add_u32 s42, s36, 28928
 s_add_u32 m0, s32, 70656
 v_add_f32 v14, v14, v21
 v_cvt_pk_bf16_f32 v62, v20, v21
 v_mfma_f32_16x16x32_bf16 a[216:219], v[36:39], v[56:59], a[216:219]
 buffer_load_dwordx4 v5, s[12:15], s42 offen nt lds
 v_exp_f32 v20, v100
 v_exp_f32 v21, v101
 v_mfma_f32_16x16x32_bf16 a[220:223], v[40:43], v[56:59], a[220:223]
 s_waitcnt lgkmcnt(2)
 ds_read_b64_tr_b16 v[36:37], v1 offset:320
 v_add_f32 v14, v14, v22
 v_add_f32 v14, v14, v23
 v_mfma_f32_16x16x32_bf16 v[156:159], v[28:31], v[44:47], v[156:159]
 s_waitcnt lgkmcnt(1)
 ds_read_b64_tr_b16 v[38:39], v1 offset:832
 v_cvt_pk_bf16_f32 v63, v22, v23
 v_exp_f32 v22, v102
 v_mfma_f32_16x16x32_bf16 v[160:163], v[32:35], v[44:47], v[160:163]
 v_exp_f32 v23, v103
 v_mfma_f32_16x16x32_bf16 v[220:223], v[28:31], v[48:51], v[220:223]
 v_add_f32 v15, v20, v21
 v_cvt_pk_bf16_f32 v64, v20, v21
 v_mfma_f32_16x16x32_bf16 v[224:227], v[32:35], v[48:51], v[224:227]
 ds_read_b64_tr_b16 v[40:41], v1 offset:352
 v_exp_f32 v20, v104
 v_exp_f32 v21, v105
 v_mfma_f32_16x16x32_bf16 a[160:163], v[28:31], v[52:55], a[160:163]
 ds_read_b64_tr_b16 v[42:43], v1 offset:864
 s_waitcnt vmcnt(8)
 v_add_u32 v26, 118272, v18
 v_add_u32 v27, 118272, v19
 ds_read_b128 a[0:3], v26
 ds_read_b128 a[4:7], v27
 ds_read_b128 a[32:35], v26 offset:2048
 ds_read_b128 a[36:39], v27 offset:2048
 v_add_u32 v26, 134656, v18
 v_add_u32 v27, 134656, v19
 ds_read_b128 a[64:67], v26
 ds_read_b128 a[68:71], v27
 ds_read_b128 a[96:99], v26 offset:2048
 ds_read_b128 a[100:103], v27 offset:2048
 v_add_f32 v15, v15, v22
 v_mfma_f32_16x16x32_bf16 a[164:167], v[32:35], v[52:55], a[164:167]
 v_add_f32 v15, v15, v23
 v_cvt_pk_bf16_f32 v65, v22, v23
 v_exp_f32 v22, v106
 v_mfma_f32_16x16x32_bf16 a[224:227], v[28:31], v[56:59], a[224:227]
 v_exp_f32 v23, v107
 v_mfma_f32_16x16x32_bf16 a[228:231], v[32:35], v[56:59], a[228:231]
 s_waitcnt lgkmcnt(10)
 ds_read_b64_tr_b16 v[28:29], v1 offset:384
 v_add_f32 v15, v15, v20
 v_add_f32 v15, v15, v21
 v_mfma_f32_16x16x32_bf16 v[164:167], v[36:39], v[44:47], v[164:167]
 s_waitcnt lgkmcnt(9)
 ds_read_b64_tr_b16 v[30:31], v1 offset:896
 v_cvt_pk_bf16_f32 v66, v20, v21
 v_exp_f32 v20, v108
 v_mfma_f32_16x16x32_bf16 v[168:171], v[40:43], v[44:47], v[168:171]
 v_exp_f32 v21, v109
 v_mfma_f32_16x16x32_bf16 v[228:231], v[36:39], v[48:51], v[228:231]
 v_add_u32 v26, 16896, v18
 v_add_u32 v27, 16896, v19
 ds_read_b128 a[8:11], v26
 ds_read_b128 a[12:15], v27
 ds_read_b128 a[40:43], v26 offset:2048
 ds_read_b128 a[44:47], v27 offset:2048
 v_add_u32 v26, 33792, v18
 v_add_u32 v27, 33792, v19
 ds_read_b128 a[72:75], v26
 ds_read_b128 a[76:79], v27
 ds_read_b128 a[104:107], v26 offset:2048
 ds_read_b128 a[108:111], v27 offset:2048
 v_add_f32 v15, v15, v22
 v_add_f32 v15, v15, v23
 v_cvt_pk_bf16_f32 v67, v22, v23
 v_mfma_f32_16x16x32_bf16 v[232:235], v[40:43], v[48:51], v[232:235]
 ds_read_b64_tr_b16 v[32:33], v1 offset:416
 v_exp_f32 v22, v110
 v_mfma_f32_16x16x32_bf16 a[168:171], v[36:39], v[52:55], a[168:171]
 ds_read_b64_tr_b16 v[34:35], v1 offset:928
 v_exp_f32 v23, v111
 v_add_f32 v16, v20, v21
 v_mfma_f32_16x16x32_bf16 a[172:175], v[40:43], v[52:55], a[172:175]
 v_cvt_pk_bf16_f32 v68, v20, v21
 v_exp_f32 v20, v112
 v_mfma_f32_16x16x32_bf16 a[232:235], v[36:39], v[56:59], a[232:235]
 v_exp_f32 v21, v113
 v_mfma_f32_16x16x32_bf16 a[236:239], v[40:43], v[56:59], a[236:239]
 s_waitcnt lgkmcnt(10)
 ds_read_b64_tr_b16 v[36:37], v1 offset:448
 v_add_f32 v16, v16, v22
 v_add_f32 v16, v16, v23
 v_mfma_f32_16x16x32_bf16 v[172:175], v[28:31], v[44:47], v[172:175]
 s_waitcnt lgkmcnt(1)
 ds_read_b64_tr_b16 v[38:39], v1 offset:960
 v_cvt_pk_bf16_f32 v69, v22, v23
 v_exp_f32 v22, v114
 v_mfma_f32_16x16x32_bf16 v[176:179], v[32:35], v[44:47], v[176:179]
 v_exp_f32 v23, v115
 v_mfma_f32_16x16x32_bf16 v[236:239], v[28:31], v[48:51], v[236:239]
 v_add_f32 v16, v16, v20
 v_add_f32 v16, v16, v21
 v_cvt_pk_bf16_f32 v70, v20, v21
 v_mfma_f32_16x16x32_bf16 v[240:243], v[32:35], v[48:51], v[240:243]
 ds_read_b64_tr_b16 v[40:41], v1 offset:480
 v_exp_f32 v20, v116
 v_mfma_f32_16x16x32_bf16 a[176:179], v[28:31], v[52:55], a[176:179]
 ds_read_b64_tr_b16 v[42:43], v1 offset:992
 v_exp_f32 v21, v117
 v_add_f32 v16, v16, v22
 v_mfma_f32_16x16x32_bf16 a[180:183], v[32:35], v[52:55], a[180:183]
 v_add_f32 v16, v16, v23
 v_cvt_pk_bf16_f32 v71, v22, v23
 v_exp_f32 v22, v118
 v_mfma_f32_16x16x32_bf16 a[240:243], v[28:31], v[56:59], a[240:243]
 v_add_u32 v1, 16896, v1
 v_add_u32 v26, 50688, v18
 v_add_u32 v27, 50688, v19
 ds_read_b128 a[16:19], v26
 ds_read_b128 a[20:23], v27
 ds_read_b128 a[48:51], v26 offset:2048
 ds_read_b128 a[52:55], v27 offset:2048
 v_exp_f32 v23, v119
 v_mfma_f32_16x16x32_bf16 a[244:247], v[32:35], v[56:59], a[244:247]
 s_waitcnt lgkmcnt(6)
 ds_read_b64_tr_b16 v[28:29], v1
 v_add_f32 v17, v20, v21
 v_cvt_pk_bf16_f32 v72, v20, v21
 v_mfma_f32_16x16x32_bf16 v[180:183], v[36:39], v[44:47], v[180:183]
 s_waitcnt lgkmcnt(5)
 ds_read_b64_tr_b16 v[30:31], v1 offset:512
 v_exp_f32 v20, v120
 v_mfma_f32_16x16x32_bf16 v[184:187], v[40:43], v[44:47], v[184:187]
 v_exp_f32 v21, v121
 v_add_f32 v17, v17, v22
 v_mfma_f32_16x16x32_bf16 v[244:247], v[36:39], v[48:51], v[244:247]
 v_add_f32 v17, v17, v23
 v_cvt_pk_bf16_f32 v73, v22, v23
 v_mfma_f32_16x16x32_bf16 v[248:251], v[40:43], v[48:51], v[248:251]
 ds_read_b64_tr_b16 v[32:33], v1 offset:32
 v_exp_f32 v22, v122
 v_exp_f32 v23, v123
 v_mfma_f32_16x16x32_bf16 a[184:187], v[36:39], v[52:55], a[184:187]
 ds_read_b64_tr_b16 v[34:35], v1 offset:544
 v_add_f32 v17, v17, v20
 v_mfma_f32_16x16x32_bf16 a[188:191], v[40:43], v[52:55], a[188:191]
 v_add_f32 v17, v17, v21
 v_cvt_pk_bf16_f32 v74, v20, v21
 v_add_f32 v17, v17, v22
 v_mfma_f32_16x16x32_bf16 a[248:251], v[36:39], v[56:59], a[248:251]
 v_add_f32 v17, v17, v23
 v_cvt_pk_bf16_f32 v75, v22, v23
 v_mfma_f32_16x16x32_bf16 a[252:255], v[40:43], v[56:59], a[252:255]
 s_waitcnt lgkmcnt(2)
 ds_read_b64_tr_b16 v[36:37], v1 offset:64
 v_max3_f32 v252, v14, v15, v16
 v_max_f32 v252, v252, v17
 v_cmp_lt_f32 vcc, s30, v252
 s_cbranch_vccnz L_rare_T15
L_back_T15:
 s_cmp_lg_u32 s92, 0
 s_cbranch_scc1 L_last
 v_mfma_f32_16x16x32_bf16 v[124:127], v[28:31], v[60:63], v[124:127]
 s_waitcnt lgkmcnt(0)
 s_waitcnt vmcnt(4)
 s_barrier
 ds_read_b64_tr_b16 v[38:39], v1 offset:576
 v_add_f32 v10, v10, v14
 v_mfma_f32_16x16x32_bf16 v[128:131], v[32:35], v[60:63], v[128:131]
 s_add_u32 s38, s35, 16384
 s_add_u32 m0, s31, 16896
 v_add_f32 v11, v11, v15
 v_add_f32 v12, v12, v16
 v_mfma_f32_16x16x32_bf16 v[188:191], v[28:31], v[64:67], v[188:191]
 buffer_load_dwordx4 v2, s[80:83], s38 offen nt lds
 v_add_f32 v13, v13, v17
 v_mfma_f32_16x16x32_bf16 v[192:195], v[32:35], v[64:67], v[192:195]
 ds_read_b64_tr_b16 v[40:41], v1 offset:96
 v_mfma_f32_16x16x32_bf16 a[128:131], v[28:31], v[68:71], a[128:131]
 ds_read_b64_tr_b16 v[42:43], v1 offset:608
 s_add_u32 m0, s31, 17440
 v_mfma_f32_16x16x32_bf16 a[132:135], v[32:35], v[68:71], a[132:135]
 buffer_load_dwordx4 v2, s[80:83], s38 offen offset:512 nt lds
 v_and_b32 v252, 15, v3
 v_lshrrev_b32 v253, 5, v3
 v_and_b32 v254, 7, v3
 v_xor_b32 v253, v253, v254
 v_mfma_f32_16x16x32_bf16 a[192:195], v[28:31], v[72:75], a[192:195]
 v_lshlrev_b32 v253, 4, v253
 v_lshlrev_b32 v252, 7, v252
 v_add_u32 v252, v252, v253
 v_bfe_u32 v253, v3, 4, 1
 v_mfma_f32_16x16x32_bf16 a[196:199], v[32:35], v[72:75], a[196:199]
 s_waitcnt lgkmcnt(2)
 ds_read_b64_tr_b16 v[28:29], v1 offset:128
 s_add_u32 m0, s31, 17984
 v_lshlrev_b32 v253, 3, v253
 v_add_u32 v252, v252, v253
 v_add_u32 v252, s33, v252
 v_add_u32 v20, 151040, v252
 v_mfma_f32_16x16x32_bf16 v[132:135], v[36:39], v[60:63], v[132:135]
 s_waitcnt lgkmcnt(1)
 buffer_load_dwordx4 v2, s[80:83], s38 offen offset:1024 nt lds
 ds_read_b64_tr_b16 v[30:31], v1 offset:640
 v_lshrrev_b32 v252, 3, v3
 v_xor_b32 v253, v254, v252
 v_lshlrev_b32 v253, 4, v253
 v_lshlrev_b32 v255, 7, v252
 v_mfma_f32_16x16x32_bf16 v[136:139], v[40:43], v[60:63], v[136:139]
 v_add_u32 v253, v253, v255
 v_add_u32 v253, s33, v253
 v_add_u32 v24, 151040, v253
 v_lshlrev_b32 v252, 9, v252
 v_mfma_f32_16x16x32_bf16 v[196:199], v[36:39], v[64:67], v[196:199]
 s_add_u32 m0, s31, 18528
 v_lshlrev_b32 v254, 4, v254
 v_add_u32 v25, v252, v254
 v_mov_b32 v252, v10
 v_mov_b32 v253, v11
 v_mfma_f32_16x16x32_bf16 v[200:203], v[40:43], v[64:67], v[200:203]
 buffer_load_dwordx4 v2, s[80:83], s38 offen offset:1536 nt lds
 ds_read_b64_tr_b16 v[32:33], v1 offset:160
 v_mov_b32 v254, v12
 v_mov_b32 v255, v13
 v_permlane16_swap_b32 v10, v252
 v_mfma_f32_16x16x32_bf16 a[136:139], v[36:39], v[68:71], a[136:139]
 ds_read_b64_tr_b16 v[34:35], v1 offset:672
 v_permlane16_swap_b32 v11, v253
 v_permlane16_swap_b32 v12, v254
 v_permlane16_swap_b32 v13, v255
 v_add_f32 v10, v10, v252
 v_mfma_f32_16x16x32_bf16 a[140:143], v[40:43], v[68:71], a[140:143]
 s_add_u32 s39, s35, 0
 s_add_u32 m0, s31, 50688
 v_add_f32 v11, v11, v253
 v_add_f32 v12, v12, v254
 v_add_f32 v13, v13, v255
 v_mov_b32 v252, v10
 v_mfma_f32_16x16x32_bf16 a[200:203], v[36:39], v[72:75], a[200:203]
 buffer_load_dwordx4 v2, s[84:87], s39 offen nt lds
 v_mov_b32 v253, v11
 v_mov_b32 v254, v12
 v_mov_b32 v255, v13
 v_permlane32_swap_b32 v10, v252
 v_mfma_f32_16x16x32_bf16 a[204:207], v[40:43], v[72:75], a[204:207]
 s_waitcnt lgkmcnt(2)
 ds_read_b64_tr_b16 v[36:37], v1 offset:192
 v_permlane32_swap_b32 v11, v253
 v_permlane32_swap_b32 v12, v254
 v_permlane32_swap_b32 v13, v255
 v_add_f32 v10, v10, v252
 v_mfma_f32_16x16x32_bf16 v[140:143], v[28:31], v[60:63], v[140:143]
 s_waitcnt lgkmcnt(1)
 ds_read_b64_tr_b16 v[38:39], v1 offset:704
 s_add_u32 m0, s31, 51232
 v_add_f32 v11, v11, v253
 v_add_f32 v12, v12, v254
 v_add_f32 v13, v13, v255
 v_rcp_f32 v252, v10
 v_mfma_f32_16x16x32_bf16 v[144:147], v[32:35], v[60:63], v[144:147]
 buffer_load_dwordx4 v2, s[84:87], s39 offen offset:512 nt lds
 v_rcp_f32 v253, v11
 v_rcp_f32 v254, v12
 v_mfma_f32_16x16x32_bf16 v[204:207], v[28:31], v[64:67], v[204:207]
 v_rcp_f32 v255, v13
 v_mfma_f32_16x16x32_bf16 v[208:211], v[32:35], v[64:67], v[208:211]
 ds_read_b64_tr_b16 v[40:41], v1 offset:224
 s_add_u32 m0, s31, 51776
 v_mfma_f32_16x16x32_bf16 a[144:147], v[28:31], v[68:71], a[144:147]
 buffer_load_dwordx4 v2, s[84:87], s39 offen offset:1024 nt lds
 ds_read_b64_tr_b16 v[42:43], v1 offset:736
 v_mul_f32 v124, v124, v252
 v_mul_f32 v125, v125, v252
 v_mul_f32 v126, v126, v252
 v_mfma_f32_16x16x32_bf16 a[148:151], v[32:35], v[68:71], a[148:151]
 v_mul_f32 v127, v127, v252
 v_mul_f32 v128, v128, v252
 v_mfma_f32_16x16x32_bf16 a[208:211], v[28:31], v[72:75], a[208:211]
 s_add_u32 m0, s31, 52320
 v_mul_f32 v129, v129, v252
 v_mul_f32 v130, v130, v252
 v_mul_f32 v131, v131, v252
 v_mfma_f32_16x16x32_bf16 a[212:215], v[32:35], v[72:75], a[212:215]
 s_waitcnt lgkmcnt(2)
 buffer_load_dwordx4 v2, s[84:87], s39 offen offset:1536 nt lds
 ds_read_b64_tr_b16 v[28:29], v1 offset:256
 v_mul_f32 v132, v132, v252
 v_mul_f32 v133, v133, v252
 v_mfma_f32_16x16x32_bf16 v[148:151], v[36:39], v[60:63], v[148:151]
 s_waitcnt lgkmcnt(1)
 ds_read_b64_tr_b16 v[30:31], v1 offset:768
 v_mul_f32 v134, v134, v252
 v_mul_f32 v135, v135, v252
 v_mul_f32 v136, v136, v252
 v_mfma_f32_16x16x32_bf16 v[152:155], v[40:43], v[60:63], v[152:155]
 s_add_u32 s42, s36, 384
 s_add_u32 m0, s32, 33792
 v_mul_f32 v137, v137, v252
 v_mul_f32 v138, v138, v252
 v_mfma_f32_16x16x32_bf16 v[212:215], v[36:39], v[64:67], v[212:215]
 buffer_load_dwordx4 v4, s[12:15], s42 offen nt lds
 v_mul_f32 v139, v139, v252
 v_cvt_pk_bf16_f32 v124, v124, v125
 v_cvt_pk_bf16_f32 v125, v126, v127
 v_mfma_f32_16x16x32_bf16 v[216:219], v[40:43], v[64:67], v[216:219]
 ds_read_b64_tr_b16 v[32:33], v1 offset:288
 v_cvt_pk_bf16_f32 v126, v128, v129
 v_cvt_pk_bf16_f32 v127, v130, v131
 v_mfma_f32_16x16x32_bf16 a[152:155], v[36:39], v[68:71], a[152:155]
 ds_read_b64_tr_b16 v[34:35], v1 offset:800
 s_add_u32 s42, s36, 4480
 s_add_u32 m0, s32, 34816
 v_cvt_pk_bf16_f32 v128, v132, v133
 v_cvt_pk_bf16_f32 v129, v134, v135
 v_cvt_pk_bf16_f32 v130, v136, v137
 v_mfma_f32_16x16x32_bf16 a[156:159], v[40:43], v[68:71], a[156:159]
 buffer_load_dwordx4 v5, s[12:15], s42 offen nt lds
 v_cvt_pk_bf16_f32 v131, v138, v139
 v_add_u32 v132, s44, v20
 v_mfma_f32_16x16x32_bf16 a[216:219], v[36:39], v[72:75], a[216:219]
 ds_write_b64 v132, v[124:125]
 v_add_u32 v133, s44, v20
 v_xor_b32 v133, 32, v133
 v_mfma_f32_16x16x32_bf16 a[220:223], v[40:43], v[72:75], a[220:223]
 s_waitcnt lgkmcnt(3)
 ds_read_b64_tr_b16 v[36:37], v1 offset:320
 s_add_u32 s42, s36, 8576
 s_add_u32 m0, s32, 35840
 ds_write_b64 v133, v[126:127]
 v_add_u32 v134, s44, v20
 v_mfma_f32_16x16x32_bf16 v[156:159], v[28:31], v[60:63], v[156:159]
 s_waitcnt lgkmcnt(3)
 buffer_load_dwordx4 v4, s[12:15], s42 offen nt lds
 ds_read_b64_tr_b16 v[38:39], v1 offset:832
 v_xor_b32 v134, 64, v134
 ds_write_b64 v134, v[128:129]
 v_add_u32 v135, s44, v20
 v_mfma_f32_16x16x32_bf16 v[160:163], v[32:35], v[60:63], v[160:163]
 v_xor_b32 v135, 96, v135
 ds_write_b64 v135, v[130:131]
 v_mfma_f32_16x16x32_bf16 v[220:223], v[28:31], v[64:67], v[220:223]
 s_add_u32 s42, s36, 12672
 s_add_u32 m0, s32, 36864
 v_mul_f32 v188, v188, v253
 v_mul_f32 v189, v189, v253
 v_mul_f32 v190, v190, v253
 v_mfma_f32_16x16x32_bf16 v[224:227], v[32:35], v[64:67], v[224:227]
 buffer_load_dwordx4 v5, s[12:15], s42 offen nt lds
 ds_read_b64_tr_b16 v[40:41], v1 offset:352
 v_mul_f32 v191, v191, v253
 v_mul_f32 v192, v192, v253
 v_mfma_f32_16x16x32_bf16 a[160:163], v[28:31], v[68:71], a[160:163]
 ds_read_b64_tr_b16 v[42:43], v1 offset:864
 v_mul_f32 v193, v193, v253
 v_mul_f32 v194, v194, v253
 v_mfma_f32_16x16x32_bf16 a[164:167], v[32:35], v[68:71], a[164:167]
 s_add_u32 s42, s36, 16768
 s_add_u32 m0, s32, 84480
 v_mul_f32 v195, v195, v253
 v_mul_f32 v196, v196, v253
 v_mul_f32 v197, v197, v253
 v_mfma_f32_16x16x32_bf16 a[224:227], v[28:31], v[72:75], a[224:227]
 buffer_load_dwordx4 v4, s[12:15], s42 offen nt lds
 v_mul_f32 v198, v198, v253
 v_mul_f32 v199, v199, v253
 v_mfma_f32_16x16x32_bf16 a[228:231], v[32:35], v[72:75], a[228:231]
 s_waitcnt lgkmcnt(4)
 ds_read_b64_tr_b16 v[28:29], v1 offset:384
 v_mul_f32 v200, v200, v253
 v_mul_f32 v201, v201, v253
 v_mfma_f32_16x16x32_bf16 v[164:167], v[36:39], v[60:63], v[164:167]
 s_waitcnt lgkmcnt(1)
 ds_read_b64_tr_b16 v[30:31], v1 offset:896
 s_add_u32 s42, s36, 20864
 s_add_u32 m0, s32, 85504
 s_waitcnt vmcnt(13)
 v_add_u32 v26, 67584, v18
 v_add_u32 v27, 67584, v19
 ds_read_b128 a[80:83], v26
 ds_read_b128 a[84:87], v27
 ds_read_b128 a[112:115], v26 offset:2048
 ds_read_b128 a[116:119], v27 offset:2048
 v_mul_f32 v202, v202, v253
 v_mul_f32 v203, v203, v253
 v_cvt_pk_bf16_f32 v188, v188, v189
 v_mfma_f32_16x16x32_bf16 v[168:171], v[40:43], v[60:63], v[168:171]
 buffer_load_dwordx4 v5, s[12:15], s42 offen nt lds
 v_cvt_pk_bf16_f32 v189, v190, v191
 v_cvt_pk_bf16_f32 v190, v192, v193
 v_mfma_f32_16x16x32_bf16 v[228:231], v[36:39], v[64:67], v[228:231]
 v_cvt_pk_bf16_f32 v191, v194, v195
 v_cvt_pk_bf16_f32 v192, v196, v197
 v_mfma_f32_16x16x32_bf16 v[232:235], v[40:43], v[64:67], v[232:235]
 ds_read_b64_tr_b16 v[32:33], v1 offset:416
 s_add_u32 s42, s36, 24960
 s_add_u32 m0, s32, 86528
 v_cvt_pk_bf16_f32 v193, v198, v199
 v_cvt_pk_bf16_f32 v194, v200, v201
 v_cvt_pk_bf16_f32 v195, v202, v203
 v_mfma_f32_16x16x32_bf16 a[168:171], v[36:39], v[68:71], a[168:171]
 buffer_load_dwordx4 v4, s[12:15], s42 offen nt lds
 ds_read_b64_tr_b16 v[34:35], v1 offset:928
 v_add_u32 v196, s44, v20
 ds_write_b64 v196, v[188:189] offset:16384
 v_mfma_f32_16x16x32_bf16 a[172:175], v[40:43], v[68:71], a[172:175]
 v_add_u32 v197, s44, v20
 v_xor_b32 v197, 32, v197
 v_mfma_f32_16x16x32_bf16 a[232:235], v[36:39], v[72:75], a[232:235]
 s_add_u32 s42, s36, 29056
 s_add_u32 m0, s32, 87552
 ds_write_b64 v197, v[190:191] offset:16384
 v_add_u32 v198, s44, v20
 v_xor_b32 v198, 64, v198
 v_mfma_f32_16x16x32_bf16 a[236:239], v[40:43], v[72:75], a[236:239]
 s_waitcnt lgkmcnt(8)
 buffer_load_dwordx4 v5, s[12:15], s42 offen nt lds
 ds_read_b64_tr_b16 v[36:37], v1 offset:448
 ds_write_b64 v198, v[192:193] offset:16384
 v_add_u32 v199, s44, v20
 v_mfma_f32_16x16x32_bf16 v[172:175], v[28:31], v[60:63], v[172:175]
 s_waitcnt lgkmcnt(4)
 ds_read_b64_tr_b16 v[38:39], v1 offset:960
 v_xor_b32 v199, 96, v199
 ds_write_b64 v199, v[194:195] offset:16384
 v_mfma_f32_16x16x32_bf16 v[176:179], v[32:35], v[60:63], v[176:179]
 v_accvgpr_read_b32 v124, a128
 v_accvgpr_read_b32 v125, a129
 v_accvgpr_read_b32 v126, a130
 v_accvgpr_read_b32 v127, a131
 v_mfma_f32_16x16x32_bf16 v[236:239], v[28:31], v[64:67], v[236:239]
 v_accvgpr_read_b32 v128, a132
 v_accvgpr_read_b32 v129, a133
 v_accvgpr_read_b32 v130, a134
 v_mfma_f32_16x16x32_bf16 v[240:243], v[32:35], v[64:67], v[240:243]
 ds_read_b64_tr_b16 v[40:41], v1 offset:480
 v_accvgpr_read_b32 v131, a135
 v_accvgpr_read_b32 v132, a136
 v_accvgpr_read_b32 v133, a137
 v_mfma_f32_16x16x32_bf16 a[176:179], v[28:31], v[68:71], a[176:179]
 ds_read_b64_tr_b16 v[42:43], v1 offset:992
 v_accvgpr_read_b32 v134, a138
 v_accvgpr_read_b32 v135, a139
 v_accvgpr_read_b32 v136, a140
 v_accvgpr_read_b32 v137, a141
 v_mfma_f32_16x16x32_bf16 a[180:183], v[32:35], v[68:71], a[180:183]
 v_accvgpr_read_b32 v138, a142
 v_accvgpr_read_b32 v139, a143
 v_mul_f32 v124, v124, v254
 v_mfma_f32_16x16x32_bf16 a[240:243], v[28:31], v[72:75], a[240:243]
 v_add_u32 v1, 4294916608, v1
 v_mul_f32 v125, v125, v254
 v_mul_f32 v126, v126, v254
 v_mul_f32 v127, v127, v254
 v_mfma_f32_16x16x32_bf16 a[244:247], v[32:35], v[72:75], a[244:247]
 s_waitcnt lgkmcnt(3)
 ds_read_b128 v[28:31], v0
 v_mul_f32 v128, v128, v254
 v_mul_f32 v129, v129, v254
 v_mul_f32 v130, v130, v254
 v_mfma_f32_16x16x32_bf16 v[180:183], v[36:39], v[60:63], v[180:183]
 s_waitcnt lgkmcnt(1)
 v_mul_f32 v131, v131, v254
 v_mul_f32 v132, v132, v254
 v_mul_f32 v133, v133, v254
 v_mul_f32 v134, v134, v254
 v_mfma_f32_16x16x32_bf16 v[184:187], v[40:43], v[60:63], v[184:187]
 v_mul_f32 v135, v135, v254
 v_mul_f32 v136, v136, v254
 v_mul_f32 v137, v137, v254
 v_mfma_f32_16x16x32_bf16 v[244:247], v[36:39], v[64:67], v[244:247]
 v_mul_f32 v138, v138, v254
 v_mul_f32 v139, v139, v254
 v_cvt_pk_bf16_f32 v124, v124, v125
 v_mfma_f32_16x16x32_bf16 v[248:251], v[40:43], v[64:67], v[248:251]
 ds_read_b128 v[32:35], v0 offset:64
 v_cvt_pk_bf16_f32 v125, v126, v127
 v_cvt_pk_bf16_f32 v126, v128, v129
 v_cvt_pk_bf16_f32 v127, v130, v131
 v_mfma_f32_16x16x32_bf16 a[184:187], v[36:39], v[68:71], a[184:187]
 v_cvt_pk_bf16_f32 v128, v132, v133
 v_cvt_pk_bf16_f32 v129, v134, v135
 v_cvt_pk_bf16_f32 v130, v136, v137
 v_cvt_pk_bf16_f32 v131, v138, v139
 v_mfma_f32_16x16x32_bf16 a[188:191], v[40:43], v[68:71], a[188:191]
 ds_write_b64 v20, v[124:125]
 v_xor_b32 v133, 32, v20
 ds_write_b64 v133, v[126:127]
 v_mfma_f32_16x16x32_bf16 a[248:251], v[36:39], v[72:75], a[248:251]
 v_xor_b32 v134, 64, v20
 ds_write_b64 v134, v[128:129]
 v_xor_b32 v135, 96, v20
 v_mfma_f32_16x16x32_bf16 a[252:255], v[40:43], v[72:75], a[252:255]
 s_waitcnt lgkmcnt(4)
 ds_read_b128 v[36:39], v0 offset:512
 ds_write_b64 v135, v[130:131]
 ds_read_b128 v[132:135], v24
 ds_read_b128 v[136:139], v24 offset:1024
 s_mov_b32 s50, s36
 v_mfma_f32_16x16x32_bf16 v[60:63], v[28:31], a[0:3], 0
 s_waitcnt lgkmcnt(0)
 s_barrier
 v_mfma_f32_16x16x32_bf16 v[60:63], v[32:35], a[4:7], v[60:63]
 s_add_u32 s39, s35, 16384
 s_add_u32 m0, s31, 67584
 v_accvgpr_read_b32 v188, a192
 v_accvgpr_read_b32 v189, a193
 v_accvgpr_read_b32 v190, a194
 v_accvgpr_read_b32 v191, a195
 v_accvgpr_read_b32 v192, a196
 v_mfma_f32_16x16x32_bf16 v[68:71], v[28:31], a[32:35], 0
 buffer_load_dwordx4 v2, s[84:87], s39 offen nt lds
 v_accvgpr_read_b32 v193, a197
 v_accvgpr_read_b32 v194, a198
 v_accvgpr_read_b32 v195, a199
 v_accvgpr_read_b32 v196, a200
 v_mfma_f32_16x16x32_bf16 v[68:71], v[32:35], a[36:39], v[68:71]
 ds_read_b128 v[40:43], v0 offset:576
 v_accvgpr_read_b32 v197, a201
 v_accvgpr_read_b32 v198, a202
 v_accvgpr_read_b32 v199, a203
 v_accvgpr_read_b32 v200, a204
 v_accvgpr_read_b32 v201, a205
 v_mfma_f32_16x16x32_bf16 v[76:79], v[28:31], a[64:67], 0
 v_accvgpr_read_b32 v202, a206
 v_accvgpr_read_b32 v203, a207
 v_mul_f32 v188, v188, v255
 v_mul_f32 v189, v189, v255
 v_mfma_f32_16x16x32_bf16 v[76:79], v[32:35], a[68:71], v[76:79]
 v_mul_f32 v190, v190, v255
 v_mul_f32 v191, v191, v255
 v_mul_f32 v192, v192, v255
 v_mul_f32 v193, v193, v255
 v_mul_f32 v194, v194, v255
 v_mfma_f32_16x16x32_bf16 v[84:87], v[28:31], a[96:99], 0
 s_add_u32 m0, s31, 68128
 v_mul_f32 v195, v195, v255
 v_mul_f32 v196, v196, v255
 v_mul_f32 v197, v197, v255
 v_mul_f32 v198, v198, v255
 v_mfma_f32_16x16x32_bf16 v[84:87], v[32:35], a[100:103], v[84:87]
 buffer_load_dwordx4 v2, s[84:87], s39 offen offset:512 nt lds
 ds_read_b128 v[28:31], v0 offset:128
 v_mul_f32 v199, v199, v255
 v_mul_f32 v200, v200, v255
 v_mul_f32 v201, v201, v255
 v_mul_f32 v202, v202, v255
 v_mfma_f32_16x16x32_bf16 v[64:67], v[36:39], a[0:3], 0
 s_waitcnt lgkmcnt(1)
 v_mul_f32 v203, v203, v255
 v_cvt_pk_bf16_f32 v188, v188, v189
 v_cvt_pk_bf16_f32 v189, v190, v191
 v_cvt_pk_bf16_f32 v190, v192, v193
 v_cvt_pk_bf16_f32 v191, v194, v195
 v_mfma_f32_16x16x32_bf16 v[64:67], v[40:43], a[4:7], v[64:67]
 v_cvt_pk_bf16_f32 v192, v196, v197
 v_cvt_pk_bf16_f32 v193, v198, v199
 v_cvt_pk_bf16_f32 v194, v200, v201
 v_cvt_pk_bf16_f32 v195, v202, v203
 v_mfma_f32_16x16x32_bf16 v[72:75], v[36:39], a[32:35], 0
 ds_write_b64 v20, v[188:189]
 v_xor_b32 v197, 32, v20
 ds_write_b64 v197, v[190:191]
 v_xor_b32 v198, 64, v20
 ds_write_b64 v198, v[192:193]
 v_mfma_f32_16x16x32_bf16 v[72:75], v[40:43], a[36:39], v[72:75]
 ds_read_b128 v[32:35], v0 offset:192
 s_add_u32 m0, s31, 68672
 v_xor_b32 v199, 96, v20
 ds_write_b64 v199, v[194:195]
 ds_read_b128 v[196:199], v24
 ds_read_b128 v[200:203], v24 offset:1024
 v_mfma_f32_16x16x32_bf16 v[80:83], v[36:39], a[64:67], 0
 buffer_load_dwordx4 v2, s[84:87], s39 offen offset:1024 nt lds
 s_add_u32 s43, s37, 16384
 buffer_store_dwordx4 v[132:135], v25, s[24:27], s43 offen sc0 sc1
 s_add_u32 s43, s37, 20480
 buffer_store_dwordx4 v[136:139], v25, s[24:27], s43 offen sc0 sc1
 v_mfma_f32_16x16x32_bf16 v[80:83], v[40:43], a[68:71], v[80:83]
 v_mul_f32 v140, v140, v252
 v_mul_f32 v141, v141, v252
 v_mul_f32 v142, v142, v252
 v_mul_f32 v143, v143, v252
 v_mfma_f32_16x16x32_bf16 v[88:91], v[36:39], a[96:99], 0
 v_mul_f32 v144, v144, v252
 v_mul_f32 v145, v145, v252
 v_mul_f32 v146, v146, v252
 v_mfma_f32_16x16x32_bf16 v[88:91], v[40:43], a[100:103], v[88:91]
 s_waitcnt lgkmcnt(7)
 ds_read_b128 v[36:39], v0 offset:640
 v_mul_f32 v147, v147, v252
 v_mul_f32 v148, v148, v252
 v_mul_f32 v149, v149, v252
 v_mfma_f32_16x16x32_bf16 v[60:63], v[28:31], a[8:11], v[60:63]
 s_waitcnt lgkmcnt(4)
 s_add_u32 m0, s31, 69216
 v_mul_f32 v150, v150, v252
 v_mul_f32 v151, v151, v252
 v_mul_f32 v152, v152, v252
 v_mfma_f32_16x16x32_bf16 v[60:63], v[32:35], a[12:15], v[60:63]
 buffer_load_dwordx4 v2, s[84:87], s39 offen offset:1536 nt lds
 v_mul_f32 v153, v153, v252
 v_mul_f32 v154, v154, v252
 v_mul_f32 v155, v155, v252
 v_mfma_f32_16x16x32_bf16 v[68:71], v[28:31], a[40:43], v[68:71]
 v_cvt_pk_bf16_f32 v140, v140, v141
 v_cvt_pk_bf16_f32 v141, v142, v143
 v_cvt_pk_bf16_f32 v142, v144, v145
 v_mfma_f32_16x16x32_bf16 v[68:71], v[32:35], a[44:47], v[68:71]
 ds_read_b128 v[40:43], v0 offset:704
 v_cvt_pk_bf16_f32 v143, v146, v147
 v_cvt_pk_bf16_f32 v144, v148, v149
 v_cvt_pk_bf16_f32 v145, v150, v151
 v_mfma_f32_16x16x32_bf16 v[76:79], v[28:31], a[72:75], v[76:79]
 v_cvt_pk_bf16_f32 v146, v152, v153
 v_cvt_pk_bf16_f32 v147, v154, v155
 ds_write_b64 v20, v[140:141]
 v_mfma_f32_16x16x32_bf16 v[76:79], v[32:35], a[76:79], v[76:79]
 v_xor_b32 v149, 32, v20
 ds_write_b64 v149, v[142:143]
 v_xor_b32 v150, 64, v20
 v_mfma_f32_16x16x32_bf16 v[84:87], v[28:31], a[104:107], v[84:87]
 ds_write_b64 v150, v[144:145]
 v_xor_b32 v151, 96, v20
 ds_write_b64 v151, v[146:147]
 v_mfma_f32_16x16x32_bf16 v[84:87], v[32:35], a[108:111], v[84:87]
 s_waitcnt lgkmcnt(5)
 ds_read_b128 v[28:31], v0 offset:256
 ds_read_b128 v[148:151], v24
 ds_read_b128 v[152:155], v24 offset:1024
 s_add_u32 s43, s37, 24576
 v_mfma_f32_16x16x32_bf16 v[64:67], v[36:39], a[8:11], v[64:67]
 s_waitcnt lgkmcnt(7)
 buffer_store_dwordx4 v[196:199], v25, s[24:27], s43 offen sc0 sc1
 s_add_u32 s43, s37, 28672
 buffer_store_dwordx4 v[200:203], v25, s[24:27], s43 offen sc0 sc1
 v_mfma_f32_16x16x32_bf16 v[64:67], v[40:43], a[12:15], v[64:67]
 v_mul_f32 v204, v204, v253
 v_mul_f32 v205, v205, v253
 v_mul_f32 v206, v206, v253
 v_mul_f32 v207, v207, v253
 v_mfma_f32_16x16x32_bf16 v[72:75], v[36:39], a[40:43], v[72:75]
 v_mul_f32 v208, v208, v253
 v_mul_f32 v209, v209, v253
 v_mul_f32 v210, v210, v253
 v_mfma_f32_16x16x32_bf16 v[72:75], v[40:43], a[44:47], v[72:75]
 ds_read_b128 v[32:35], v0 offset:320
 v_mul_f32 v211, v211, v253
 v_mul_f32 v212, v212, v253
 v_mul_f32 v213, v213, v253
 v_mfma_f32_16x16x32_bf16 v[80:83], v[36:39], a[72:75], v[80:83]
 v_mul_f32 v214, v214, v253
 v_mul_f32 v215, v215, v253
 v_mul_f32 v216, v216, v253
 v_mfma_f32_16x16x32_bf16 v[80:83], v[40:43], a[76:79], v[80:83]
 v_mul_f32 v217, v217, v253
 v_mul_f32 v218, v218, v253
 v_mul_f32 v219, v219, v253
 v_mfma_f32_16x16x32_bf16 v[88:91], v[36:39], a[104:107], v[88:91]
 v_cvt_pk_bf16_f32 v204, v204, v205
 v_cvt_pk_bf16_f32 v205, v206, v207
 v_cvt_pk_bf16_f32 v206, v208, v209
 v_mfma_f32_16x16x32_bf16 v[88:91], v[40:43], a[108:111], v[88:91]
 s_waitcnt lgkmcnt(3)
 ds_read_b128 v[36:39], v0 offset:768
 v_cvt_pk_bf16_f32 v207, v210, v211
 v_cvt_pk_bf16_f32 v208, v212, v213
 v_cvt_pk_bf16_f32 v209, v214, v215
 v_mfma_f32_16x16x32_bf16 v[60:63], v[28:31], a[16:19], v[60:63]
 s_waitcnt lgkmcnt(1)
 v_cvt_pk_bf16_f32 v210, v216, v217
 v_cvt_pk_bf16_f32 v211, v218, v219
 ds_write_b64 v20, v[204:205]
 v_mfma_f32_16x16x32_bf16 v[60:63], v[32:35], a[20:23], v[60:63]
 v_xor_b32 v213, 32, v20
 ds_write_b64 v213, v[206:207]
 v_xor_b32 v214, 64, v20
 v_mfma_f32_16x16x32_bf16 v[68:71], v[28:31], a[48:51], v[68:71]
 ds_write_b64 v214, v[208:209]
 v_xor_b32 v215, 96, v20
 ds_write_b64 v215, v[210:211]
 v_mfma_f32_16x16x32_bf16 v[68:71], v[32:35], a[52:55], v[68:71]
 ds_read_b128 v[40:43], v0 offset:832
 ds_read_b128 v[212:215], v24
 ds_read_b128 v[216:219], v24 offset:1024
 s_add_u32 s43, s37, 0
 v_mfma_f32_16x16x32_bf16 v[76:79], v[28:31], a[80:83], v[76:79]
 buffer_store_dwordx4 v[148:151], v25, s[24:27], s43 offen offset:128 sc0 sc1
 s_add_u32 s43, s37, 4096
 buffer_store_dwordx4 v[152:155], v25, s[24:27], s43 offen offset:128 sc0 sc1
 v_mfma_f32_16x16x32_bf16 v[76:79], v[32:35], a[84:87], v[76:79]
 v_accvgpr_read_b32 v140, a144
 v_accvgpr_read_b32 v141, a145
 v_accvgpr_read_b32 v142, a146
 v_accvgpr_read_b32 v143, a147
 v_accvgpr_read_b32 v144, a148
 v_mfma_f32_16x16x32_bf16 v[84:87], v[28:31], a[112:115], v[84:87]
 v_accvgpr_read_b32 v145, a149
 v_accvgpr_read_b32 v146, a150
 v_accvgpr_read_b32 v147, a151
 v_accvgpr_read_b32 v148, a152
 v_mfma_f32_16x16x32_bf16 v[84:87], v[32:35], a[116:119], v[84:87]
 s_waitcnt lgkmcnt(7)
 ds_read_b128 v[28:31], v0 offset:384
 v_accvgpr_read_b32 v149, a153
 v_accvgpr_read_b32 v150, a154
 v_accvgpr_read_b32 v151, a155
 v_accvgpr_read_b32 v152, a156
 v_accvgpr_read_b32 v153, a157
 v_mfma_f32_16x16x32_bf16 v[64:67], v[36:39], a[16:19], v[64:67]
 s_waitcnt lgkmcnt(3)
 v_accvgpr_read_b32 v154, a158
 v_accvgpr_read_b32 v155, a159
 v_mul_f32 v140, v140, v254
 v_mul_f32 v141, v141, v254
 v_mfma_f32_16x16x32_bf16 v[64:67], v[40:43], a[20:23], v[64:67]
 v_mul_f32 v142, v142, v254
 v_mul_f32 v143, v143, v254
 v_mul_f32 v144, v144, v254
 v_mul_f32 v145, v145, v254
 v_mul_f32 v146, v146, v254
 v_mfma_f32_16x16x32_bf16 v[72:75], v[36:39], a[48:51], v[72:75]
 v_mul_f32 v147, v147, v254
 v_mul_f32 v148, v148, v254
 v_mul_f32 v149, v149, v254
 v_mul_f32 v150, v150, v254
 v_mfma_f32_16x16x32_bf16 v[72:75], v[40:43], a[52:55], v[72:75]
 ds_read_b128 v[32:35], v0 offset:448
 v_mul_f32 v151, v151, v254
 v_mul_f32 v152, v152, v254
 v_mul_f32 v153, v153, v254
 v_mul_f32 v154, v154, v254
 v_mfma_f32_16x16x32_bf16 v[80:83], v[36:39], a[80:83], v[80:83]
 v_mul_f32 v155, v155, v254
 v_cvt_pk_bf16_f32 v140, v140, v141
 v_cvt_pk_bf16_f32 v141, v142, v143
 v_cvt_pk_bf16_f32 v142, v144, v145
 v_cvt_pk_bf16_f32 v143, v146, v147
 v_mfma_f32_16x16x32_bf16 v[80:83], v[40:43], a[84:87], v[80:83]
 v_cvt_pk_bf16_f32 v144, v148, v149
 v_cvt_pk_bf16_f32 v145, v150, v151
 v_cvt_pk_bf16_f32 v146, v152, v153
 v_cvt_pk_bf16_f32 v147, v154, v155
 v_mfma_f32_16x16x32_bf16 v[88:91], v[36:39], a[112:115], v[88:91]
 ds_write_b64 v20, v[140:141]
 v_xor_b32 v149, 32, v20
 ds_write_b64 v149, v[142:143]
 v_xor_b32 v150, 64, v20
 ds_write_b64 v150, v[144:145]
 v_mfma_f32_16x16x32_bf16 v[88:91], v[40:43], a[116:119], v[88:91]
 s_waitcnt lgkmcnt(4)
 ds_read_b128 v[36:39], v0 offset:896
 v_xor_b32 v151, 96, v20
 ds_write_b64 v151, v[146:147]
 ds_read_b128 v[148:151], v24
 ds_read_b128 v[152:155], v24 offset:1024
 s_waitcnt vmcnt(10)
 v_add_u32 v26, 33792, v18
 v_add_u32 v27, 33792, v19
 ds_read_b128 a[24:27], v26
 ds_read_b128 a[28:31], v27
 ds_read_b128 a[56:59], v26 offset:2048
 ds_read_b128 a[60:63], v27 offset:2048
 v_add_u32 v26, 84480, v18
 v_add_u32 v27, 84480, v19
 ds_read_b128 a[88:91], v26
 ds_read_b128 a[92:95], v27
 ds_read_b128 a[120:123], v26 offset:2048
 ds_read_b128 a[124:127], v27 offset:2048
 s_waitcnt lgkmcnt(7)
 v_mfma_f32_16x16x32_bf16 v[60:63], v[28:31], a[24:27], v[60:63]
 s_add_u32 s43, s37, 8192
 buffer_store_dwordx4 v[212:215], v25, s[24:27], s43 offen offset:128 sc0 sc1
 s_add_u32 s43, s37, 12288
 buffer_store_dwordx4 v[216:219], v25, s[24:27], s43 offen offset:128 sc0 sc1
 s_waitcnt lgkmcnt(6)
 v_mfma_f32_16x16x32_bf16 v[60:63], v[32:35], a[28:31], v[60:63]
 v_accvgpr_read_b32 v204, a208
 v_accvgpr_read_b32 v205, a209
 v_accvgpr_read_b32 v206, a210
 v_accvgpr_read_b32 v207, a211
 v_accvgpr_read_b32 v208, a212
 s_waitcnt lgkmcnt(5)
 v_mfma_f32_16x16x32_bf16 v[68:71], v[28:31], a[56:59], v[68:71]
 s_waitcnt lgkmcnt(0)
 s_barrier
 v_accvgpr_read_b32 v209, a213
 v_accvgpr_read_b32 v210, a214
 v_accvgpr_read_b32 v211, a215
 v_accvgpr_read_b32 v212, a216
 v_mfma_f32_16x16x32_bf16 v[68:71], v[32:35], a[60:63], v[68:71]
 ds_read_b128 v[40:43], v0 offset:960
 s_add_u32 s38, s35, 32768
 s_add_u32 m0, s31, 33792
 v_accvgpr_read_b32 v213, a217
 v_accvgpr_read_b32 v214, a218
 v_accvgpr_read_b32 v215, a219
 v_accvgpr_read_b32 v216, a220
 v_accvgpr_read_b32 v217, a221
 v_mfma_f32_16x16x32_bf16 v[76:79], v[28:31], a[88:91], v[76:79]
 buffer_load_dwordx4 v2, s[80:83], s38 offen nt lds
 v_add_u32 v0, 16896, v0
 s_add_u32 m0, s31, 34336
 v_accvgpr_read_b32 v218, a222
 v_accvgpr_read_b32 v219, a223
 v_mul_f32 v204, v204, v255
 v_mul_f32 v205, v205, v255
 v_mfma_f32_16x16x32_bf16 v[76:79], v[32:35], a[92:95], v[76:79]
 buffer_load_dwordx4 v2, s[80:83], s38 offen offset:512 nt lds
 s_add_u32 m0, s31, 34880
 v_mul_f32 v206, v206, v255
 v_mul_f32 v207, v207, v255
 v_mul_f32 v208, v208, v255
 v_mul_f32 v209, v209, v255
 v_mul_f32 v210, v210, v255
 v_mfma_f32_16x16x32_bf16 v[84:87], v[28:31], a[120:123], v[84:87]
 buffer_load_dwordx4 v2, s[80:83], s38 offen offset:1024 nt lds
 s_add_u32 m0, s31, 35424
 v_mul_f32 v211, v211, v255
 v_mul_f32 v212, v212, v255
 v_mul_f32 v213, v213, v255
 v_mul_f32 v214, v214, v255
 v_mfma_f32_16x16x32_bf16 v[84:87], v[32:35], a[124:127], v[84:87]
 buffer_load_dwordx4 v2, s[80:83], s38 offen offset:1536 nt lds
 ds_read_b128 v[28:31], v0
 s_add_u32 s39, s35, 32768
 s_add_u32 m0, s31, 84480
 v_mul_f32 v215, v215, v255
 v_mul_f32 v216, v216, v255
 v_mul_f32 v217, v217, v255
 v_mul_f32 v218, v218, v255
 v_mfma_f32_16x16x32_bf16 v[64:67], v[36:39], a[24:27], v[64:67]
 s_waitcnt lgkmcnt(1)
 buffer_load_dwordx4 v2, s[84:87], s39 offen nt lds
 s_add_u32 m0, s31, 85024
 v_mul_f32 v219, v219, v255
 v_cvt_pk_bf16_f32 v204, v204, v205
 v_cvt_pk_bf16_f32 v205, v206, v207
 v_cvt_pk_bf16_f32 v206, v208, v209
 v_cvt_pk_bf16_f32 v207, v210, v211
 v_mfma_f32_16x16x32_bf16 v[64:67], v[40:43], a[28:31], v[64:67]
 buffer_load_dwordx4 v2, s[84:87], s39 offen offset:512 nt lds
 s_add_u32 m0, s31, 85568
 v_cvt_pk_bf16_f32 v208, v212, v213
 v_cvt_pk_bf16_f32 v209, v214, v215
 v_cvt_pk_bf16_f32 v210, v216, v217
 v_cvt_pk_bf16_f32 v211, v218, v219
 v_mfma_f32_16x16x32_bf16 v[72:75], v[36:39], a[56:59], v[72:75]
 buffer_load_dwordx4 v2, s[84:87], s39 offen offset:1024 nt lds
 s_add_u32 m0, s31, 86112
 ds_write_b64 v20, v[204:205]
 v_xor_b32 v213, 32, v20
 ds_write_b64 v213, v[206:207]
 v_xor_b32 v214, 64, v20
 ds_write_b64 v214, v[208:209]
 v_mfma_f32_16x16x32_bf16 v[72:75], v[40:43], a[60:63], v[72:75]
 buffer_load_dwordx4 v2, s[84:87], s39 offen offset:1536 nt lds
 ds_read_b128 v[32:35], v0 offset:64
 v_xor_b32 v215, 96, v20
 ds_write_b64 v215, v[210:211]
 ds_read_b128 v[212:215], v24
 ds_read_b128 v[216:219], v24 offset:1024
 v_mfma_f32_16x16x32_bf16 v[80:83], v[36:39], a[88:91], v[80:83]
 s_add_u32 s43, s37, 16384
 buffer_store_dwordx4 v[148:151], v25, s[24:27], s43 offen offset:128 sc0 sc1
 s_add_u32 s43, s37, 20480
 buffer_store_dwordx4 v[152:155], v25, s[24:27], s43 offen offset:128 sc0 sc1
 v_mfma_f32_16x16x32_bf16 v[80:83], v[40:43], a[92:95], v[80:83]
 v_mfma_f32_16x16x32_bf16 v[88:91], v[36:39], a[120:123], v[88:91]
 v_mov_b32 v4, v20
 v_mov_b32 v5, v24
 v_mov_b32 v18, v25
 v_mfma_f32_16x16x32_bf16 v[88:91], v[40:43], a[124:127], v[88:91]
 s_waitcnt lgkmcnt(7)
 ds_read_b128 v[36:39], v0 offset:512
 s_mov_b32 s34, s35
 s_mov_b32 s92, 1
 s_mov_b32 s14, 0
 s_mov_b32 s82, 0
 s_mov_b32 s86, 0
 s_add_u32 s52, s34, 32768
 s_add_u32 s53, s34, 32768
 s_mov_b32 s4, 16896
 s_mov_b32 s5, 33792
 s_mov_b32 s6, 0
 s_mov_b32 s55, 16896
 s_mov_b32 s88, 0
 s_mov_b32 s91, 2
 s_mov_b32 s9, 2
 v_mfma_f32_16x16x32_bf16 v[92:95], v[28:31], a[0:3], 0
 s_barrier
 s_waitcnt lgkmcnt(4)
 v_mfma_f32_16x16x32_bf16 v[92:95], v[32:35], a[4:7], v[92:95]
 s_add_u32 s52, s52, 16384
 s_add_u32 m0, s31, 0
 v_mfma_f32_16x16x32_bf16 v[100:103], v[28:31], a[32:35], 0
 buffer_load_dwordx4 v2, s[16:19], s52 offen nt lds
 v_mul_f32 v156, v156, v252
 v_mul_f32 v157, v157, v252
 v_mul_f32 v158, v158, v252
 v_mul_f32 v159, v159, v252
 v_mfma_f32_16x16x32_bf16 v[100:103], v[32:35], a[36:39], v[100:103]
 ds_read_b128 v[40:43], v0 offset:576
 v_max3_f32 v20, v60, v61, v62
 v_max3_f32 v21, v68, v69, v70
 v_max3_f32 v22, v76, v77, v78
 v_max3_f32 v23, v84, v85, v86
 v_mul_f32 v160, v160, v252
 v_mul_f32 v161, v161, v252
 v_mul_f32 v162, v162, v252
 v_mfma_f32_16x16x32_bf16 v[108:111], v[28:31], a[64:67], 0
 v_max3_f32 v20, v20, v63, v64
 v_max3_f32 v21, v21, v71, v72
 v_max3_f32 v22, v22, v79, v80
 v_mul_f32 v163, v163, v252
 v_mul_f32 v164, v164, v252
 v_mul_f32 v165, v165, v252
 v_mfma_f32_16x16x32_bf16 v[108:111], v[32:35], a[68:71], v[108:111]
 s_add_u32 m0, s31, 544
 v_max3_f32 v23, v23, v87, v88
 v_max3_f32 v20, v20, v65, v66
 v_max3_f32 v21, v21, v73, v74
 v_mul_f32 v166, v166, v252
 v_mul_f32 v167, v167, v252
 v_mul_f32 v168, v168, v252
 v_mfma_f32_16x16x32_bf16 v[116:119], v[28:31], a[96:99], 0
 buffer_load_dwordx4 v2, s[16:19], s52 offen offset:512 nt lds
 v_max3_f32 v22, v22, v81, v82
 v_max3_f32 v23, v23, v89, v90
 v_max_f32 v20, v20, v67
 v_mul_f32 v169, v169, v252
 v_mul_f32 v170, v170, v252
 v_mul_f32 v171, v171, v252
 v_cvt_pk_bf16_f32 v156, v156, v157
 v_mfma_f32_16x16x32_bf16 v[116:119], v[32:35], a[100:103], v[116:119]
 s_waitcnt lgkmcnt(1)
 ds_read_b128 v[28:31], v0 offset:128
 v_max_f32 v21, v21, v75
 v_max_f32 v22, v22, v83
 v_max_f32 v23, v23, v91
 v_cvt_pk_bf16_f32 v157, v158, v159
 v_cvt_pk_bf16_f32 v158, v160, v161
 v_cvt_pk_bf16_f32 v159, v162, v163
 v_mfma_f32_16x16x32_bf16 v[96:99], v[36:39], a[0:3], 0
 s_waitcnt lgkmcnt(1)
 v_mov_b32 v24, v20
 v_mov_b32 v25, v21
 v_mov_b32 v26, v22
 v_cvt_pk_bf16_f32 v160, v164, v165
 v_cvt_pk_bf16_f32 v161, v166, v167
 v_cvt_pk_bf16_f32 v162, v168, v169
 v_mfma_f32_16x16x32_bf16 v[96:99], v[40:43], a[4:7], v[96:99]
 s_add_u32 m0, s31, 1088
 v_mov_b32 v27, v23
 v_permlane16_swap_b32 v20, v24
 v_permlane16_swap_b32 v21, v25
 v_cvt_pk_bf16_f32 v163, v170, v171
 v_add_u32 v164, s44, v4
 ds_write_b64 v164, v[156:157] offset:2048
 v_mfma_f32_16x16x32_bf16 v[104:107], v[36:39], a[32:35], 0
 buffer_load_dwordx4 v2, s[16:19], s52 offen offset:1024 nt lds
 v_permlane16_swap_b32 v22, v26
 v_permlane16_swap_b32 v23, v27
 v_max_f32 v20, v20, v24
 v_max_f32 v21, v21, v25
 v_add_u32 v165, s44, v4
 v_xor_b32 v165, 32, v165
 ds_write_b64 v165, v[158:159] offset:2048
 v_add_u32 v166, s44, v4
 v_mfma_f32_16x16x32_bf16 v[104:107], v[40:43], a[36:39], v[104:107]
 ds_read_b128 v[32:35], v0 offset:192
 v_max_f32 v22, v22, v26
 v_max_f32 v23, v23, v27
 v_mov_b32 v24, v20
 v_xor_b32 v166, 64, v166
 ds_write_b64 v166, v[160:161] offset:2048
 v_add_u32 v167, s44, v4
 v_mfma_f32_16x16x32_bf16 v[112:115], v[36:39], a[64:67], 0
 v_mov_b32 v25, v21
 v_mov_b32 v26, v22
 v_mov_b32 v27, v23
 v_xor_b32 v167, 96, v167
 ds_write_b64 v167, v[162:163] offset:2048
 s_add_u32 s43, s37, 24576
 v_mfma_f32_16x16x32_bf16 v[112:115], v[40:43], a[68:71], v[112:115]
 s_add_u32 m0, s31, 1632
 v_permlane32_swap_b32 v20, v24
 v_permlane32_swap_b32 v21, v25
 v_permlane32_swap_b32 v22, v26
 buffer_store_dwordx4 v[212:215], v18, s[24:27], s43 offen offset:128 sc0 sc1
 s_add_u32 s43, s37, 28672
 buffer_store_dwordx4 v[216:219], v18, s[24:27], s43 offen offset:128 sc0 sc1
 v_mfma_f32_16x16x32_bf16 v[120:123], v[36:39], a[96:99], 0
 buffer_load_dwordx4 v2, s[16:19], s52 offen offset:1536 nt lds
 v_permlane32_swap_b32 v23, v27
 v_max_f32 v20, v20, v24
 v_max_f32 v21, v21, v25
 v_mul_f32 v220, v220, v253
 v_mul_f32 v221, v221, v253
 v_mul_f32 v222, v222, v253
 v_mfma_f32_16x16x32_bf16 v[120:123], v[40:43], a[100:103], v[120:123]
 s_waitcnt lgkmcnt(5)
 ds_read_b128 v[36:39], v0 offset:640
 v_max_f32 v22, v22, v26
 v_max_f32 v23, v23, v27
 v_mul_f32 v6, s29, v20
 v_mul_f32 v223, v223, v253
 v_mul_f32 v224, v224, v253
 v_mul_f32 v225, v225, v253
 v_mfma_f32_16x16x32_bf16 v[92:95], v[28:31], a[8:11], v[92:95]
 s_waitcnt lgkmcnt(3)
 v_mul_f32 v7, s29, v21
 v_mul_f32 v8, s29, v22
 v_mul_f32 v9, s29, v23
 v_mul_f32 v226, v226, v253
 v_mul_f32 v227, v227, v253
 v_mul_f32 v228, v228, v253
 v_mfma_f32_16x16x32_bf16 v[92:95], v[32:35], a[12:15], v[92:95]
 v_mov_b32 v10, 0
 v_mov_b32 v11, 0
 v_mov_b32 v12, 0
 v_mul_f32 v229, v229, v253
 v_mul_f32 v230, v230, v253
 v_mul_f32 v231, v231, v253
 v_mfma_f32_16x16x32_bf16 v[100:103], v[28:31], a[40:43], v[100:103]
 v_mov_b32 v13, 0
 v_fma_f32 v60, v60, s29, -v6
 v_fma_f32 v61, v61, s29, -v6
 v_fma_f32 v62, v62, s29, -v6
 v_mul_f32 v232, v232, v253
 v_mul_f32 v233, v233, v253
 v_mul_f32 v234, v234, v253
 v_mfma_f32_16x16x32_bf16 v[100:103], v[32:35], a[44:47], v[100:103]
 ds_read_b128 v[40:43], v0 offset:704
 v_fma_f32 v63, v63, s29, -v6
 v_fma_f32 v64, v64, s29, -v6
 v_fma_f32 v65, v65, s29, -v6
 v_mul_f32 v235, v235, v253
 v_cvt_pk_bf16_f32 v220, v220, v221
 v_cvt_pk_bf16_f32 v221, v222, v223
 v_mfma_f32_16x16x32_bf16 v[108:111], v[28:31], a[72:75], v[108:111]
 v_fma_f32 v66, v66, s29, -v6
 v_fma_f32 v67, v67, s29, -v6
 v_fma_f32 v68, v68, s29, -v7
 v_cvt_pk_bf16_f32 v222, v224, v225
 v_cvt_pk_bf16_f32 v223, v226, v227
 v_cvt_pk_bf16_f32 v224, v228, v229
 v_mfma_f32_16x16x32_bf16 v[108:111], v[32:35], a[76:79], v[108:111]
 v_fma_f32 v69, v69, s29, -v7
 v_fma_f32 v70, v70, s29, -v7
 v_fma_f32 v71, v71, s29, -v7
 v_cvt_pk_bf16_f32 v225, v230, v231
 v_cvt_pk_bf16_f32 v226, v232, v233
 v_cvt_pk_bf16_f32 v227, v234, v235
 v_mfma_f32_16x16x32_bf16 v[116:119], v[28:31], a[104:107], v[116:119]
 v_fma_f32 v72, v72, s29, -v7
 v_fma_f32 v73, v73, s29, -v7
 v_fma_f32 v74, v74, s29, -v7
 v_add_u32 v228, s44, v4
 ds_write_b64 v228, v[220:221] offset:18432
 v_add_u32 v229, s44, v4
 v_mfma_f32_16x16x32_bf16 v[116:119], v[32:35], a[108:111], v[116:119]
 s_waitcnt lgkmcnt(2)
 ds_read_b128 v[28:31], v0 offset:256
 v_fma_f32 v75, v75, s29, -v7
 v_fma_f32 v76, v76, s29, -v8
 v_fma_f32 v77, v77, s29, -v8
 v_xor_b32 v229, 32, v229
 ds_write_b64 v229, v[222:223] offset:18432
 v_add_u32 v230, s44, v4
 v_mfma_f32_16x16x32_bf16 v[96:99], v[36:39], a[8:11], v[96:99]
 s_waitcnt lgkmcnt(3)
 v_fma_f32 v78, v78, s29, -v8
 v_fma_f32 v79, v79, s29, -v8
 v_fma_f32 v80, v80, s29, -v8
 v_xor_b32 v230, 64, v230
 ds_write_b64 v230, v[224:225] offset:18432
 v_add_u32 v231, s44, v4
 v_mfma_f32_16x16x32_bf16 v[96:99], v[40:43], a[12:15], v[96:99]
 v_fma_f32 v81, v81, s29, -v8
 v_fma_f32 v82, v82, s29, -v8
 v_fma_f32 v83, v83, s29, -v8
 v_fma_f32 v84, v84, s29, -v9
 v_xor_b32 v231, 96, v231
 ds_write_b64 v231, v[226:227] offset:18432
 v_mfma_f32_16x16x32_bf16 v[104:107], v[36:39], a[40:43], v[104:107]
 v_fma_f32 v85, v85, s29, -v9
 v_fma_f32 v86, v86, s29, -v9
 v_fma_f32 v87, v87, s29, -v9
 v_accvgpr_read_b32 v156, a160
 v_accvgpr_read_b32 v157, a161
 v_accvgpr_read_b32 v158, a162
 v_accvgpr_read_b32 v159, a163
 v_accvgpr_read_b32 v160, a164
 v_mfma_f32_16x16x32_bf16 v[104:107], v[40:43], a[44:47], v[104:107]
 ds_read_b128 v[32:35], v0 offset:320
 v_fma_f32 v88, v88, s29, -v9
 v_fma_f32 v89, v89, s29, -v9
 v_fma_f32 v90, v90, s29, -v9
 v_accvgpr_read_b32 v161, a165
 v_accvgpr_read_b32 v162, a166
 v_accvgpr_read_b32 v163, a167
 v_accvgpr_read_b32 v164, a168
 v_mfma_f32_16x16x32_bf16 v[112:115], v[36:39], a[72:75], v[112:115]
 v_fma_f32 v91, v91, s29, -v9
 v_exp_f32 v20, v60
 v_accvgpr_read_b32 v165, a169
 v_accvgpr_read_b32 v166, a170
 v_accvgpr_read_b32 v167, a171
 v_accvgpr_read_b32 v168, a172
 v_mfma_f32_16x16x32_bf16 v[112:115], v[40:43], a[76:79], v[112:115]
 v_exp_f32 v21, v61
 v_exp_f32 v22, v62
 v_accvgpr_read_b32 v169, a173
 v_accvgpr_read_b32 v170, a174
 v_accvgpr_read_b32 v171, a175
 v_mul_f32 v156, v156, v254
 v_mfma_f32_16x16x32_bf16 v[120:123], v[36:39], a[104:107], v[120:123]
 v_exp_f32 v23, v63
 v_mul_f32 v157, v157, v254
 v_mul_f32 v158, v158, v254
 v_mul_f32 v159, v159, v254
 v_mul_f32 v160, v160, v254
 v_mfma_f32_16x16x32_bf16 v[120:123], v[40:43], a[108:111], v[120:123]
 s_waitcnt lgkmcnt(4)
 ds_read_b128 v[36:39], v0 offset:768
 v_add_f32 v14, v20, v21
 v_cvt_pk_bf16_f32 v44, v20, v21
 v_exp_f32 v20, v64
 v_mul_f32 v161, v161, v254
 v_mul_f32 v162, v162, v254
 v_mul_f32 v163, v163, v254
 v_mul_f32 v164, v164, v254
 v_mfma_f32_16x16x32_bf16 v[92:95], v[28:31], a[16:19], v[92:95]
 s_waitcnt lgkmcnt(1)
 v_exp_f32 v21, v65
 v_mul_f32 v165, v165, v254
 v_mul_f32 v166, v166, v254
 v_mul_f32 v167, v167, v254
 v_mul_f32 v168, v168, v254
 v_mfma_f32_16x16x32_bf16 v[92:95], v[32:35], a[20:23], v[92:95]
 v_add_f32 v14, v14, v22
 v_add_f32 v14, v14, v23
 v_cvt_pk_bf16_f32 v45, v22, v23
 v_exp_f32 v22, v66
 v_mul_f32 v169, v169, v254
 v_mul_f32 v170, v170, v254
 v_mul_f32 v171, v171, v254
 v_cvt_pk_bf16_f32 v156, v156, v157
 v_mfma_f32_16x16x32_bf16 v[100:103], v[28:31], a[48:51], v[100:103]
 v_exp_f32 v23, v67
 v_cvt_pk_bf16_f32 v157, v158, v159
 v_cvt_pk_bf16_f32 v158, v160, v161
 v_cvt_pk_bf16_f32 v159, v162, v163
 v_cvt_pk_bf16_f32 v160, v164, v165
 v_mfma_f32_16x16x32_bf16 v[100:103], v[32:35], a[52:55], v[100:103]
 ds_read_b128 v[40:43], v0 offset:832
 v_add_f32 v14, v14, v20
 v_add_f32 v14, v14, v21
 v_cvt_pk_bf16_f32 v46, v20, v21
 v_cvt_pk_bf16_f32 v161, v166, v167
 v_cvt_pk_bf16_f32 v162, v168, v169
 v_cvt_pk_bf16_f32 v163, v170, v171
 ds_write_b64 v4, v[156:157]
 v_mfma_f32_16x16x32_bf16 v[108:111], v[28:31], a[80:83], v[108:111]
 v_exp_f32 v20, v68
 v_exp_f32 v21, v69
 v_xor_b32 v165, 32, v4
 ds_write_b64 v165, v[158:159]
 v_xor_b32 v166, 64, v4
 ds_write_b64 v166, v[160:161]
 v_mfma_f32_16x16x32_bf16 v[108:111], v[32:35], a[84:87], v[108:111]
 v_add_f32 v14, v14, v22
 v_add_f32 v14, v14, v23
 v_xor_b32 v167, 96, v4
 ds_write_b64 v167, v[162:163]
 ds_read_b128 v[164:167], v5
 ds_read_b128 v[168:171], v5 offset:1024
 v_mfma_f32_16x16x32_bf16 v[116:119], v[28:31], a[112:115], v[116:119]
 v_cvt_pk_bf16_f32 v47, v22, v23
 v_exp_f32 v22, v70
 v_accvgpr_read_b32 v220, a224
 v_accvgpr_read_b32 v221, a225
 v_accvgpr_read_b32 v222, a226
 v_accvgpr_read_b32 v223, a227
 v_accvgpr_read_b32 v224, a228
 v_mfma_f32_16x16x32_bf16 v[116:119], v[32:35], a[116:119], v[116:119]
 s_waitcnt lgkmcnt(7)
 ds_read_b128 v[28:31], v0 offset:384
 v_exp_f32 v23, v71
 v_add_f32 v15, v20, v21
 v_accvgpr_read_b32 v225, a229
 v_accvgpr_read_b32 v226, a230
 v_accvgpr_read_b32 v227, a231
 v_accvgpr_read_b32 v228, a232
 v_mfma_f32_16x16x32_bf16 v[96:99], v[36:39], a[16:19], v[96:99]
 s_waitcnt lgkmcnt(7)
 v_cvt_pk_bf16_f32 v48, v20, v21
 v_exp_f32 v20, v72
 v_exp_f32 v21, v73
 v_accvgpr_read_b32 v229, a233
 v_accvgpr_read_b32 v230, a234
 v_accvgpr_read_b32 v231, a235
 v_accvgpr_read_b32 v232, a236
 v_accvgpr_read_b32 v233, a237
 v_mfma_f32_16x16x32_bf16 v[96:99], v[40:43], a[20:23], v[96:99]
 v_add_f32 v15, v15, v22
 v_add_f32 v15, v15, v23
 v_accvgpr_read_b32 v234, a238
 v_accvgpr_read_b32 v235, a239
 v_mul_f32 v220, v220, v255
 v_mul_f32 v221, v221, v255
 v_mfma_f32_16x16x32_bf16 v[104:107], v[36:39], a[48:51], v[104:107]
 v_cvt_pk_bf16_f32 v49, v22, v23
 v_exp_f32 v22, v74
 v_mul_f32 v222, v222, v255
 v_mul_f32 v223, v223, v255
 v_mul_f32 v224, v224, v255
 v_mul_f32 v225, v225, v255
 v_mul_f32 v226, v226, v255
 v_mfma_f32_16x16x32_bf16 v[104:107], v[40:43], a[52:55], v[104:107]
 ds_read_b128 v[32:35], v0 offset:448
 v_exp_f32 v23, v75
 v_add_f32 v15, v15, v20
 v_mul_f32 v227, v227, v255
 v_mul_f32 v228, v228, v255
 v_mul_f32 v229, v229, v255
 v_mul_f32 v230, v230, v255
 v_mfma_f32_16x16x32_bf16 v[112:115], v[36:39], a[80:83], v[112:115]
 v_add_f32 v15, v15, v21
 v_cvt_pk_bf16_f32 v50, v20, v21
 v_exp_f32 v20, v76
 v_mul_f32 v231, v231, v255
 v_mul_f32 v232, v232, v255
 v_mul_f32 v233, v233, v255
 v_mul_f32 v234, v234, v255
 v_mfma_f32_16x16x32_bf16 v[112:115], v[40:43], a[84:87], v[112:115]
 v_exp_f32 v21, v77
 v_mul_f32 v235, v235, v255
 v_cvt_pk_bf16_f32 v220, v220, v221
 v_cvt_pk_bf16_f32 v221, v222, v223
 v_cvt_pk_bf16_f32 v222, v224, v225
 v_cvt_pk_bf16_f32 v223, v226, v227
 v_mfma_f32_16x16x32_bf16 v[120:123], v[36:39], a[112:115], v[120:123]
 v_add_f32 v15, v15, v22
 v_add_f32 v15, v15, v23
 v_cvt_pk_bf16_f32 v51, v22, v23
 v_cvt_pk_bf16_f32 v224, v228, v229
 v_cvt_pk_bf16_f32 v225, v230, v231
 v_cvt_pk_bf16_f32 v226, v232, v233
 v_cvt_pk_bf16_f32 v227, v234, v235
 v_mfma_f32_16x16x32_bf16 v[120:123], v[40:43], a[116:119], v[120:123]
 s_waitcnt lgkmcnt(1)
 ds_read_b128 v[36:39], v0 offset:896
 v_exp_f32 v22, v78
 v_exp_f32 v23, v79
 ds_write_b64 v4, v[220:221]
 v_xor_b32 v229, 32, v4
 ds_write_b64 v229, v[222:223]
 v_xor_b32 v230, 64, v4
 ds_write_b64 v230, v[224:225]
 v_mfma_f32_16x16x32_bf16 v[92:95], v[28:31], a[24:27], v[92:95]
 s_waitcnt lgkmcnt(4)
 v_add_f32 v16, v20, v21
 v_cvt_pk_bf16_f32 v52, v20, v21
 v_exp_f32 v20, v80
 v_xor_b32 v231, 96, v4
 ds_write_b64 v231, v[226:227]
 ds_read_b128 v[228:231], v5
 ds_read_b128 v[232:235], v5 offset:1024
 v_mfma_f32_16x16x32_bf16 v[92:95], v[32:35], a[28:31], v[92:95]
 v_exp_f32 v21, v81
 s_add_u32 s43, s37, 16384
 buffer_store_dwordx4 v[164:167], v18, s[24:27], s43 offen offset:256 sc0 sc1
 s_add_u32 s43, s37, 20480
 buffer_store_dwordx4 v[168:171], v18, s[24:27], s43 offen offset:256 sc0 sc1
 v_mfma_f32_16x16x32_bf16 v[100:103], v[28:31], a[56:59], v[100:103]
 v_add_f32 v16, v16, v22
 v_add_f32 v16, v16, v23
 v_cvt_pk_bf16_f32 v53, v22, v23
 v_mul_f32 v172, v172, v252
 v_mul_f32 v173, v173, v252
 v_mul_f32 v174, v174, v252
 v_mul_f32 v175, v175, v252
 v_mfma_f32_16x16x32_bf16 v[100:103], v[32:35], a[60:63], v[100:103]
 ds_read_b128 v[40:43], v0 offset:960
 v_exp_f32 v22, v82
 v_exp_f32 v23, v83
 v_mul_f32 v176, v176, v252
 v_mul_f32 v177, v177, v252
 v_mul_f32 v178, v178, v252
 v_mfma_f32_16x16x32_bf16 v[108:111], v[28:31], a[88:91], v[108:111]
 v_add_f32 v16, v16, v20
 v_add_f32 v16, v16, v21
 v_mul_f32 v179, v179, v252
 v_mul_f32 v180, v180, v252
 v_mul_f32 v181, v181, v252
 v_mfma_f32_16x16x32_bf16 v[108:111], v[32:35], a[92:95], v[108:111]
 v_cvt_pk_bf16_f32 v54, v20, v21
 v_exp_f32 v20, v84
 v_mul_f32 v182, v182, v252
 v_mul_f32 v183, v183, v252
 v_mul_f32 v184, v184, v252
 v_mfma_f32_16x16x32_bf16 v[116:119], v[28:31], a[120:123], v[116:119]
 v_exp_f32 v21, v85
 v_add_f32 v16, v16, v22
 v_mul_f32 v185, v185, v252
 v_mul_f32 v186, v186, v252
 v_mul_f32 v187, v187, v252
 v_mfma_f32_16x16x32_bf16 v[116:119], v[32:35], a[124:127], v[116:119]
 s_waitcnt lgkmcnt(7)
 ds_read_b64_tr_b16 v[28:29], v1
 v_add_f32 v16, v16, v23
 v_cvt_pk_bf16_f32 v55, v22, v23
 v_exp_f32 v22, v86
 v_cvt_pk_bf16_f32 v172, v172, v173
 v_cvt_pk_bf16_f32 v173, v174, v175
 v_cvt_pk_bf16_f32 v174, v176, v177
 v_mfma_f32_16x16x32_bf16 v[96:99], v[36:39], a[24:27], v[96:99]
 s_waitcnt lgkmcnt(1)
 ds_read_b64_tr_b16 v[30:31], v1 offset:512
 v_exp_f32 v23, v87
 v_add_f32 v17, v20, v21
 v_cvt_pk_bf16_f32 v175, v178, v179
 v_cvt_pk_bf16_f32 v176, v180, v181
 v_cvt_pk_bf16_f32 v177, v182, v183
 v_mfma_f32_16x16x32_bf16 v[96:99], v[40:43], a[28:31], v[96:99]
 v_cvt_pk_bf16_f32 v56, v20, v21
 v_exp_f32 v20, v88
 v_cvt_pk_bf16_f32 v178, v184, v185
 v_cvt_pk_bf16_f32 v179, v186, v187
 ds_write_b64 v4, v[172:173]
 v_mfma_f32_16x16x32_bf16 v[104:107], v[36:39], a[56:59], v[104:107]
 v_exp_f32 v21, v89
 v_add_f32 v17, v17, v22
 v_xor_b32 v181, 32, v4
 ds_write_b64 v181, v[174:175]
 v_xor_b32 v182, 64, v4
 v_mfma_f32_16x16x32_bf16 v[104:107], v[40:43], a[60:63], v[104:107]
 ds_read_b64_tr_b16 v[32:33], v1 offset:32
 v_add_f32 v17, v17, v23
 v_cvt_pk_bf16_f32 v57, v22, v23
 v_exp_f32 v22, v90
 ds_write_b64 v182, v[176:177]
 v_xor_b32 v183, 96, v4
 ds_write_b64 v183, v[178:179]
 v_mfma_f32_16x16x32_bf16 v[112:115], v[36:39], a[88:91], v[112:115]
 ds_read_b64_tr_b16 v[34:35], v1 offset:544
 v_exp_f32 v23, v91
 ds_read_b128 v[180:183], v5
 ds_read_b128 v[184:187], v5 offset:1024
 s_add_u32 s43, s37, 24576
 v_mfma_f32_16x16x32_bf16 v[112:115], v[40:43], a[92:95], v[112:115]
 v_add_f32 v17, v17, v20
 v_add_f32 v17, v17, v21
 v_cvt_pk_bf16_f32 v58, v20, v21
 buffer_store_dwordx4 v[228:231], v18, s[24:27], s43 offen offset:256 sc0 sc1
 s_add_u32 s43, s37, 28672
 buffer_store_dwordx4 v[232:235], v18, s[24:27], s43 offen offset:256 sc0 sc1
 v_mfma_f32_16x16x32_bf16 v[120:123], v[36:39], a[120:123], v[120:123]
 v_add_f32 v17, v17, v22
 v_add_f32 v17, v17, v23
 v_cvt_pk_bf16_f32 v59, v22, v23
 v_mfma_f32_16x16x32_bf16 v[120:123], v[40:43], a[124:127], v[120:123]
 s_waitcnt lgkmcnt(8)
 ds_read_b64_tr_b16 v[36:37], v1 offset:64
 v_mfma_f32_16x16x32_bf16 v[124:127], v[28:31], v[44:47], 0
 s_waitcnt vmcnt(26)
 s_barrier
 s_waitcnt lgkmcnt(3)
 ds_read_b64_tr_b16 v[38:39], v1 offset:576
 v_mfma_f32_16x16x32_bf16 v[128:131], v[32:35], v[44:47], 0
 s_add_u32 s53, s53, 16384
 s_add_u32 m0, s31, 101376
 v_add_f32 v10, v10, v14
 v_add_f32 v11, v11, v15
 v_mul_f32 v236, v236, v253
 v_mul_f32 v237, v237, v253
 v_mul_f32 v238, v238, v253
 v_mul_f32 v239, v239, v253
 v_mfma_f32_16x16x32_bf16 v[188:191], v[28:31], v[48:51], 0
 buffer_load_dwordx4 v2, s[20:23], s53 offen nt lds
 v_add_f32 v12, v12, v16
 v_mul_f32 v240, v240, v253
 v_mul_f32 v241, v241, v253
 v_mul_f32 v242, v242, v253
 v_mfma_f32_16x16x32_bf16 v[192:195], v[32:35], v[48:51], 0
 ds_read_b64_tr_b16 v[40:41], v1 offset:96
 v_add_f32 v13, v13, v17
 v_mul_f32 v243, v243, v253
 v_mul_f32 v244, v244, v253
 v_mul_f32 v245, v245, v253
 v_mul_f32 v246, v246, v253
 v_mfma_f32_16x16x32_bf16 a[128:131], v[28:31], v[52:55], 0
 ds_read_b64_tr_b16 v[42:43], v1 offset:608
 v_mul_f32 v247, v247, v253
 v_mul_f32 v248, v248, v253
 v_mul_f32 v249, v249, v253
 v_mfma_f32_16x16x32_bf16 a[132:135], v[32:35], v[52:55], 0
 s_add_u32 m0, s31, 101920
 v_mul_f32 v250, v250, v253
 v_mul_f32 v251, v251, v253
 v_cvt_pk_bf16_f32 v236, v236, v237
 v_mfma_f32_16x16x32_bf16 a[192:195], v[28:31], v[56:59], 0
 buffer_load_dwordx4 v2, s[20:23], s53 offen offset:512 nt lds
 v_cvt_pk_bf16_f32 v237, v238, v239
 v_cvt_pk_bf16_f32 v238, v240, v241
 v_cvt_pk_bf16_f32 v239, v242, v243
 v_cvt_pk_bf16_f32 v240, v244, v245
 v_mfma_f32_16x16x32_bf16 a[196:199], v[32:35], v[56:59], 0
 s_waitcnt lgkmcnt(2)
 ds_read_b64_tr_b16 v[28:29], v1 offset:128
 v_cvt_pk_bf16_f32 v241, v246, v247
 v_cvt_pk_bf16_f32 v242, v248, v249
 v_cvt_pk_bf16_f32 v243, v250, v251
 v_mfma_f32_16x16x32_bf16 v[132:135], v[36:39], v[44:47], 0
 s_waitcnt lgkmcnt(1)
 ds_read_b64_tr_b16 v[30:31], v1 offset:640
 ds_write_b64 v4, v[236:237]
 v_xor_b32 v245, 32, v4
 ds_write_b64 v245, v[238:239]
 v_mfma_f32_16x16x32_bf16 v[136:139], v[40:43], v[44:47], 0
 s_add_u32 m0, s31, 102464
 v_xor_b32 v246, 64, v4
 ds_write_b64 v246, v[240:241]
 v_xor_b32 v247, 96, v4
 ds_write_b64 v247, v[242:243]
 v_mfma_f32_16x16x32_bf16 v[196:199], v[36:39], v[48:51], 0
 buffer_load_dwordx4 v2, s[20:23], s53 offen offset:1024 nt lds
 ds_read_b128 v[244:247], v5
 ds_read_b128 v[248:251], v5 offset:1024
 s_add_u32 s43, s37, 0
 v_mfma_f32_16x16x32_bf16 v[200:203], v[40:43], v[48:51], 0
 ds_read_b64_tr_b16 v[32:33], v1 offset:160
 buffer_store_dwordx4 v[180:183], v18, s[24:27], s43 offen offset:384 sc0 sc1
 s_add_u32 s43, s37, 4096
 buffer_store_dwordx4 v[184:187], v18, s[24:27], s43 offen offset:384 sc0 sc1
 v_mfma_f32_16x16x32_bf16 a[136:139], v[36:39], v[52:55], 0
 ds_read_b64_tr_b16 v[34:35], v1 offset:672
 v_accvgpr_read_b32 v172, a176
 v_accvgpr_read_b32 v173, a177
 v_accvgpr_read_b32 v174, a178
 v_accvgpr_read_b32 v175, a179
 v_accvgpr_read_b32 v176, a180
 v_mfma_f32_16x16x32_bf16 a[140:143], v[40:43], v[52:55], 0
 s_add_u32 m0, s31, 103008
 v_accvgpr_read_b32 v177, a181
 v_accvgpr_read_b32 v178, a182
 v_accvgpr_read_b32 v179, a183
 v_accvgpr_read_b32 v180, a184
 v_accvgpr_read_b32 v181, a185
 v_mfma_f32_16x16x32_bf16 a[200:203], v[36:39], v[56:59], 0
 buffer_load_dwordx4 v2, s[20:23], s53 offen offset:1536 nt lds
 v_accvgpr_read_b32 v182, a186
 v_accvgpr_read_b32 v183, a187
 v_accvgpr_read_b32 v184, a188
 v_accvgpr_read_b32 v185, a189
 v_accvgpr_read_b32 v186, a190
 v_mfma_f32_16x16x32_bf16 a[204:207], v[40:43], v[56:59], 0
 s_waitcnt lgkmcnt(8)
 ds_read_b64_tr_b16 v[36:37], v1 offset:192
 v_accvgpr_read_b32 v187, a191
 v_mul_f32 v172, v172, v254
 v_mul_f32 v173, v173, v254
 v_mul_f32 v174, v174, v254
 v_mul_f32 v175, v175, v254
 v_mfma_f32_16x16x32_bf16 v[140:143], v[28:31], v[44:47], 0
 s_waitcnt lgkmcnt(1)
 ds_read_b64_tr_b16 v[38:39], v1 offset:704
 v_mul_f32 v176, v176, v254
 v_mul_f32 v177, v177, v254
 v_mul_f32 v178, v178, v254
 v_mul_f32 v179, v179, v254
 v_mul_f32 v180, v180, v254
 v_mfma_f32_16x16x32_bf16 v[144:147], v[32:35], v[44:47], 0
 s_add_u32 s52, s52, 16384
 s_add_u32 m0, s31, 16896
 v_mul_f32 v181, v181, v254
 v_mul_f32 v182, v182, v254
 v_mul_f32 v183, v183, v254
 v_mul_f32 v184, v184, v254
 v_mfma_f32_16x16x32_bf16 v[204:207], v[28:31], v[48:51], 0
 buffer_load_dwordx4 v2, s[16:19], s52 offen nt lds
 v_mul_f32 v185, v185, v254
 v_mul_f32 v186, v186, v254
 v_mul_f32 v187, v187, v254
 v_cvt_pk_bf16_f32 v172, v172, v173
 v_cvt_pk_bf16_f32 v173, v174, v175
 v_mfma_f32_16x16x32_bf16 v[208:211], v[32:35], v[48:51], 0
 ds_read_b64_tr_b16 v[40:41], v1 offset:224
 v_cvt_pk_bf16_f32 v174, v176, v177
 v_cvt_pk_bf16_f32 v175, v178, v179
 v_cvt_pk_bf16_f32 v176, v180, v181
 v_cvt_pk_bf16_f32 v177, v182, v183
 v_cvt_pk_bf16_f32 v178, v184, v185
 v_mfma_f32_16x16x32_bf16 a[144:147], v[28:31], v[52:55], 0
 ds_read_b64_tr_b16 v[42:43], v1 offset:736
 v_fma_f32 v92, v92, s29, -v6
 v_cvt_pk_bf16_f32 v179, v186, v187
 ds_write_b64 v4, v[172:173]
 v_xor_b32 v181, 32, v4
 ds_write_b64 v181, v[174:175]
 v_xor_b32 v182, 64, v4
 v_mfma_f32_16x16x32_bf16 a[148:151], v[32:35], v[52:55], 0
 s_add_u32 m0, s31, 17440
 v_fma_f32 v93, v93, s29, -v6
 v_fma_f32 v94, v94, s29, -v6
 ds_write_b64 v182, v[176:177]
 v_xor_b32 v183, 96, v4
 ds_write_b64 v183, v[178:179]
 ds_read_b128 v[180:183], v5
 ds_read_b128 v[184:187], v5 offset:1024
 v_mfma_f32_16x16x32_bf16 a[208:211], v[28:31], v[56:59], 0
 buffer_load_dwordx4 v2, s[16:19], s52 offen offset:512 nt lds
 v_fma_f32 v95, v95, s29, -v6
 s_add_u32 s43, s37, 8192
 buffer_store_dwordx4 v[244:247], v18, s[24:27], s43 offen offset:384 sc0 sc1
 s_add_u32 s43, s37, 12288
 buffer_store_dwordx4 v[248:251], v18, s[24:27], s43 offen offset:384 sc0 sc1
 v_mfma_f32_16x16x32_bf16 a[212:215], v[32:35], v[56:59], 0
 s_waitcnt lgkmcnt(8)
 ds_read_b64_tr_b16 v[28:29], v1 offset:256
 v_fma_f32 v96, v96, s29, -v6
 v_accvgpr_read_b32 v236, a240
 v_accvgpr_read_b32 v237, a241
 v_accvgpr_read_b32 v238, a242
 v_accvgpr_read_b32 v239, a243
 v_accvgpr_read_b32 v240, a244
 v_mfma_f32_16x16x32_bf16 v[148:151], v[36:39], v[44:47], 0
 s_waitcnt lgkmcnt(7)
 ds_read_b64_tr_b16 v[30:31], v1 offset:768
 v_fma_f32 v97, v97, s29, -v6
 v_accvgpr_read_b32 v241, a245
 v_accvgpr_read_b32 v242, a246
 v_accvgpr_read_b32 v243, a247
 v_accvgpr_read_b32 v244, a248
 v_mfma_f32_16x16x32_bf16 v[152:155], v[40:43], v[44:47], 0
 s_add_u32 m0, s31, 17984
 v_fma_f32 v98, v98, s29, -v6
 v_fma_f32 v99, v99, s29, -v6
 v_accvgpr_read_b32 v245, a249
 v_accvgpr_read_b32 v246, a250
 v_accvgpr_read_b32 v247, a251
 v_accvgpr_read_b32 v248, a252
 v_accvgpr_read_b32 v249, a253
 v_mfma_f32_16x16x32_bf16 v[212:215], v[36:39], v[48:51], 0
 buffer_load_dwordx4 v2, s[16:19], s52 offen offset:1024 nt lds
 v_fma_f32 v100, v100, s29, -v7
 v_accvgpr_read_b32 v250, a254
 v_accvgpr_read_b32 v251, a255
 v_mul_f32 v236, v236, v255
 v_mul_f32 v237, v237, v255
 v_mfma_f32_16x16x32_bf16 v[216:219], v[40:43], v[48:51], 0
 ds_read_b64_tr_b16 v[32:33], v1 offset:288
 v_fma_f32 v101, v101, s29, -v7
 v_mul_f32 v238, v238, v255
 v_mul_f32 v239, v239, v255
 v_mul_f32 v240, v240, v255
 v_mul_f32 v241, v241, v255
 v_mul_f32 v242, v242, v255
 v_mfma_f32_16x16x32_bf16 a[152:155], v[36:39], v[52:55], 0
 ds_read_b64_tr_b16 v[34:35], v1 offset:800
 v_fma_f32 v102, v102, s29, -v7
 v_mul_f32 v243, v243, v255
 v_mul_f32 v244, v244, v255
 v_mul_f32 v245, v245, v255
 v_mul_f32 v246, v246, v255
 v_mfma_f32_16x16x32_bf16 a[156:159], v[40:43], v[52:55], 0
 s_add_u32 m0, s31, 18528
 v_fma_f32 v103, v103, s29, -v7
 v_fma_f32 v104, v104, s29, -v7
 v_mul_f32 v247, v247, v255
 v_mul_f32 v248, v248, v255
 v_mul_f32 v249, v249, v255
 v_mul_f32 v250, v250, v255
 v_mfma_f32_16x16x32_bf16 a[216:219], v[36:39], v[56:59], 0
 buffer_load_dwordx4 v2, s[16:19], s52 offen offset:1536 nt lds
 v_add_u32 v0, 16896, v0
 v_mul_f32 v251, v251, v255
 v_cvt_pk_bf16_f32 v236, v236, v237
 v_cvt_pk_bf16_f32 v237, v238, v239
 v_cvt_pk_bf16_f32 v238, v240, v241
 v_cvt_pk_bf16_f32 v239, v242, v243
 v_mfma_f32_16x16x32_bf16 a[220:223], v[40:43], v[56:59], 0
 s_waitcnt lgkmcnt(2)
 ds_read_b64_tr_b16 v[36:37], v1 offset:320
 v_fma_f32 v105, v105, s29, -v7
 v_cvt_pk_bf16_f32 v240, v244, v245
 v_cvt_pk_bf16_f32 v241, v246, v247
 v_cvt_pk_bf16_f32 v242, v248, v249
 v_cvt_pk_bf16_f32 v243, v250, v251
 v_mfma_f32_16x16x32_bf16 v[156:159], v[28:31], v[44:47], 0
 s_waitcnt lgkmcnt(1)
 ds_read_b64_tr_b16 v[38:39], v1 offset:832
 v_fma_f32 v106, v106, s29, -v7
 ds_write_b64 v4, v[236:237]
 v_xor_b32 v245, 32, v4
 ds_write_b64 v245, v[238:239]
 v_xor_b32 v246, 64, v4
 ds_write_b64 v246, v[240:241]
 v_mfma_f32_16x16x32_bf16 v[160:163], v[32:35], v[44:47], 0
 v_fma_f32 v107, v107, s29, -v7
 v_fma_f32 v108, v108, s29, -v8
 v_xor_b32 v247, 96, v4
 ds_write_b64 v247, v[242:243]
 ds_read_b128 v[244:247], v5
 ds_read_b128 v[248:251], v5 offset:1024
 v_mfma_f32_16x16x32_bf16 v[220:223], v[28:31], v[48:51], 0
 v_fma_f32 v109, v109, s29, -v8
 v_fma_f32 v110, v110, s29, -v8
 s_add_u32 s43, s37, 16384
 buffer_store_dwordx4 v[180:183], v18, s[24:27], s43 offen offset:384 sc0 sc1
 s_add_u32 s43, s37, 20480
 buffer_store_dwordx4 v[184:187], v18, s[24:27], s43 offen offset:384 sc0 sc1
 v_mfma_f32_16x16x32_bf16 v[224:227], v[32:35], v[48:51], 0
 ds_read_b64_tr_b16 v[40:41], v1 offset:352
 v_fma_f32 v111, v111, s29, -v8
 v_mfma_f32_16x16x32_bf16 a[160:163], v[28:31], v[52:55], 0
 ds_read_b64_tr_b16 v[42:43], v1 offset:864
 v_fma_f32 v112, v112, s29, -v8
 s_add_u32 s43, s37, 24576
 s_waitcnt lgkmcnt(3)
 buffer_store_dwordx4 v[244:247], v18, s[24:27], s43 offen offset:384 sc0 sc1
 s_add_u32 s43, s37, 28672
 s_waitcnt lgkmcnt(2)
 buffer_store_dwordx4 v[248:251], v18, s[24:27], s43 offen offset:384 sc0 sc1
 v_mfma_f32_16x16x32_bf16 a[164:167], v[32:35], v[52:55], 0
 v_fma_f32 v113, v113, s29, -v8
 v_fma_f32 v114, v114, s29, -v8
 s_mov_b32 s37, s50
 v_add_u32 v5, s44, v5
 v_mfma_f32_16x16x32_bf16 a[224:227], v[28:31], v[56:59], 0
 v_fma_f32 v115, v115, s29, -v8
 v_fma_f32 v116, v116, s29, -v9
 v_mfma_f32_16x16x32_bf16 a[228:231], v[32:35], v[56:59], 0
 ds_read_b64_tr_b16 v[28:29], v1 offset:384
 v_fma_f32 v117, v117, s29, -v9
 v_mfma_f32_16x16x32_bf16 v[164:167], v[36:39], v[44:47], 0
 s_waitcnt lgkmcnt(1)
 ds_read_b64_tr_b16 v[30:31], v1 offset:896
 v_fma_f32 v118, v118, s29, -v9
 v_mfma_f32_16x16x32_bf16 v[168:171], v[40:43], v[44:47], 0
 v_fma_f32 v119, v119, s29, -v9
 v_fma_f32 v120, v120, s29, -v9
 v_mfma_f32_16x16x32_bf16 v[228:231], v[36:39], v[48:51], 0
 v_fma_f32 v121, v121, s29, -v9
 v_fma_f32 v122, v122, s29, -v9
 v_mfma_f32_16x16x32_bf16 v[232:235], v[40:43], v[48:51], 0
 ds_read_b64_tr_b16 v[32:33], v1 offset:416
 v_fma_f32 v123, v123, s29, -v9
 v_mfma_f32_16x16x32_bf16 a[168:171], v[36:39], v[52:55], 0
 ds_read_b64_tr_b16 v[34:35], v1 offset:928
 v_mfma_f32_16x16x32_bf16 a[172:175], v[40:43], v[52:55], 0
 v_mfma_f32_16x16x32_bf16 a[232:235], v[36:39], v[56:59], 0
 s_waitcnt vmcnt(32)
 s_barrier
 v_mfma_f32_16x16x32_bf16 a[236:239], v[40:43], v[56:59], 0
 s_waitcnt lgkmcnt(2)
 ds_read_b64_tr_b16 v[36:37], v1 offset:448
 v_mfma_f32_16x16x32_bf16 v[172:175], v[28:31], v[44:47], 0
 s_waitcnt lgkmcnt(1)
 ds_read_b64_tr_b16 v[38:39], v1 offset:960
 v_mfma_f32_16x16x32_bf16 v[176:179], v[32:35], v[44:47], 0
 v_mfma_f32_16x16x32_bf16 v[236:239], v[28:31], v[48:51], 0
 v_mfma_f32_16x16x32_bf16 v[240:243], v[32:35], v[48:51], 0
 ds_read_b64_tr_b16 v[40:41], v1 offset:480
 v_mfma_f32_16x16x32_bf16 a[176:179], v[28:31], v[52:55], 0
 ds_read_b64_tr_b16 v[42:43], v1 offset:992
 v_mfma_f32_16x16x32_bf16 a[180:183], v[32:35], v[52:55], 0
 v_mfma_f32_16x16x32_bf16 a[240:243], v[28:31], v[56:59], 0
 v_add_u32 v1, 16896, v1
 v_mfma_f32_16x16x32_bf16 a[244:247], v[32:35], v[56:59], 0
 s_waitcnt lgkmcnt(2)
 ds_read_b128 v[28:31], v0
 v_mfma_f32_16x16x32_bf16 v[180:183], v[36:39], v[44:47], 0
 s_waitcnt lgkmcnt(1)
 v_mfma_f32_16x16x32_bf16 v[184:187], v[40:43], v[44:47], 0
 v_mfma_f32_16x16x32_bf16 v[244:247], v[36:39], v[48:51], 0
 v_mfma_f32_16x16x32_bf16 v[248:251], v[40:43], v[48:51], 0
 ds_read_b128 v[32:35], v0 offset:64
 v_mfma_f32_16x16x32_bf16 a[184:187], v[36:39], v[52:55], 0
 v_exp_f32 v20, v92
 v_mfma_f32_16x16x32_bf16 a[188:191], v[40:43], v[52:55], 0
 v_exp_f32 v21, v93
 v_mfma_f32_16x16x32_bf16 a[248:251], v[36:39], v[56:59], 0
 v_add_f32 v14, v20, v21
 v_mfma_f32_16x16x32_bf16 a[252:255], v[40:43], v[56:59], 0
 s_waitcnt lgkmcnt(1)
 ds_read_b128 v[36:39], v0 offset:512
 v_cvt_pk_bf16_f32 v44, v20, v21
 s_branch L_first
L_last:
 v_mfma_f32_16x16x32_bf16 v[124:127], v[28:31], v[60:63], v[124:127]
 s_waitcnt lgkmcnt(1)
 ds_read_b64_tr_b16 v[38:39], v1 offset:576
 v_add_f32 v10, v10, v14
 v_mfma_f32_16x16x32_bf16 v[128:131], v[32:35], v[60:63], v[128:131]
 v_add_f32 v11, v11, v15
 v_add_f32 v12, v12, v16
 v_mfma_f32_16x16x32_bf16 v[188:191], v[28:31], v[64:67], v[188:191]
 v_add_f32 v13, v13, v17
 v_mfma_f32_16x16x32_bf16 v[192:195], v[32:35], v[64:67], v[192:195]
 ds_read_b64_tr_b16 v[40:41], v1 offset:96
 v_mfma_f32_16x16x32_bf16 a[128:131], v[28:31], v[68:71], a[128:131]
 ds_read_b64_tr_b16 v[42:43], v1 offset:608
 v_mfma_f32_16x16x32_bf16 a[132:135], v[32:35], v[68:71], a[132:135]
 v_and_b32 v252, 15, v3
 v_lshrrev_b32 v253, 5, v3
 v_and_b32 v254, 7, v3
 v_xor_b32 v253, v253, v254
 v_mfma_f32_16x16x32_bf16 a[192:195], v[28:31], v[72:75], a[192:195]
 v_lshlrev_b32 v253, 4, v253
 v_lshlrev_b32 v252, 7, v252
 v_add_u32 v252, v252, v253
 v_bfe_u32 v253, v3, 4, 1
 v_mfma_f32_16x16x32_bf16 a[196:199], v[32:35], v[72:75], a[196:199]
 s_waitcnt lgkmcnt(2)
 ds_read_b64_tr_b16 v[28:29], v1 offset:128
 v_lshlrev_b32 v253, 3, v253
 v_add_u32 v252, v252, v253
 v_add_u32 v252, s33, v252
 v_add_u32 v20, 151040, v252
 v_mfma_f32_16x16x32_bf16 v[132:135], v[36:39], v[60:63], v[132:135]
 s_waitcnt lgkmcnt(1)
 ds_read_b64_tr_b16 v[30:31], v1 offset:640
 v_lshrrev_b32 v252, 3, v3
 v_xor_b32 v253, v254, v252
 v_lshlrev_b32 v253, 4, v253
 v_lshlrev_b32 v255, 7, v252
 v_mfma_f32_16x16x32_bf16 v[136:139], v[40:43], v[60:63], v[136:139]
 v_add_u32 v253, v253, v255
 v_add_u32 v253, s33, v253
 v_add_u32 v24, 151040, v253
 v_lshlrev_b32 v252, 9, v252
 v_mfma_f32_16x16x32_bf16 v[196:199], v[36:39], v[64:67], v[196:199]
 v_lshlrev_b32 v254, 4, v254
 v_add_u32 v25, v252, v254
 v_mov_b32 v252, v10
 v_mov_b32 v253, v11
 v_mfma_f32_16x16x32_bf16 v[200:203], v[40:43], v[64:67], v[200:203]
 ds_read_b64_tr_b16 v[32:33], v1 offset:160
 v_mov_b32 v254, v12
 v_mov_b32 v255, v13
 v_permlane16_swap_b32 v10, v252
 v_mfma_f32_16x16x32_bf16 a[136:139], v[36:39], v[68:71], a[136:139]
 ds_read_b64_tr_b16 v[34:35], v1 offset:672
 v_permlane16_swap_b32 v11, v253
 v_permlane16_swap_b32 v12, v254
 v_permlane16_swap_b32 v13, v255
 v_add_f32 v10, v10, v252
 v_mfma_f32_16x16x32_bf16 a[140:143], v[40:43], v[68:71], a[140:143]
 v_add_f32 v11, v11, v253
 v_add_f32 v12, v12, v254
 v_add_f32 v13, v13, v255
 v_mov_b32 v252, v10
 v_mfma_f32_16x16x32_bf16 a[200:203], v[36:39], v[72:75], a[200:203]
 v_mov_b32 v253, v11
 v_mov_b32 v254, v12
 v_mov_b32 v255, v13
 v_permlane32_swap_b32 v10, v252
 v_mfma_f32_16x16x32_bf16 a[204:207], v[40:43], v[72:75], a[204:207]
 s_waitcnt lgkmcnt(2)
 ds_read_b64_tr_b16 v[36:37], v1 offset:192
 v_permlane32_swap_b32 v11, v253
 v_permlane32_swap_b32 v12, v254
 v_permlane32_swap_b32 v13, v255
 v_add_f32 v10, v10, v252
 v_mfma_f32_16x16x32_bf16 v[140:143], v[28:31], v[60:63], v[140:143]
 s_waitcnt lgkmcnt(1)
 ds_read_b64_tr_b16 v[38:39], v1 offset:704
 v_add_f32 v11, v11, v253
 v_add_f32 v12, v12, v254
 v_add_f32 v13, v13, v255
 v_rcp_f32 v252, v10
 v_mfma_f32_16x16x32_bf16 v[144:147], v[32:35], v[60:63], v[144:147]
 v_rcp_f32 v253, v11
 v_rcp_f32 v254, v12
 v_mfma_f32_16x16x32_bf16 v[204:207], v[28:31], v[64:67], v[204:207]
 v_rcp_f32 v255, v13
 v_mfma_f32_16x16x32_bf16 v[208:211], v[32:35], v[64:67], v[208:211]
 ds_read_b64_tr_b16 v[40:41], v1 offset:224
 v_mfma_f32_16x16x32_bf16 a[144:147], v[28:31], v[68:71], a[144:147]
 ds_read_b64_tr_b16 v[42:43], v1 offset:736
 v_mul_f32 v124, v124, v252
 v_mul_f32 v125, v125, v252
 v_mul_f32 v126, v126, v252
 v_mul_f32 v127, v127, v252
 v_mul_f32 v128, v128, v252
 v_mul_f32 v129, v129, v252
 v_mul_f32 v130, v130, v252
 v_mul_f32 v131, v131, v252
 v_mul_f32 v132, v132, v252
 v_mul_f32 v133, v133, v252
 v_mul_f32 v134, v134, v252
 v_mfma_f32_16x16x32_bf16 a[148:151], v[32:35], v[68:71], a[148:151]
 v_mul_f32 v135, v135, v252
 v_mul_f32 v136, v136, v252
 v_mul_f32 v137, v137, v252
 v_mul_f32 v138, v138, v252
 v_mul_f32 v139, v139, v252
 v_cvt_pk_bf16_f32 v124, v124, v125
 v_cvt_pk_bf16_f32 v125, v126, v127
 v_cvt_pk_bf16_f32 v126, v128, v129
 v_cvt_pk_bf16_f32 v127, v130, v131
 v_cvt_pk_bf16_f32 v128, v132, v133
 v_cvt_pk_bf16_f32 v129, v134, v135
 v_mfma_f32_16x16x32_bf16 a[208:211], v[28:31], v[72:75], a[208:211]
 v_cvt_pk_bf16_f32 v130, v136, v137
 v_cvt_pk_bf16_f32 v131, v138, v139
 ds_write_b64 v20, v[124:125]
 v_xor_b32 v133, 32, v20
 ds_write_b64 v133, v[126:127]
 v_xor_b32 v134, 64, v20
 ds_write_b64 v134, v[128:129]
 v_xor_b32 v135, 96, v20
 ds_write_b64 v135, v[130:131]
 ds_read_b128 v[132:135], v24
 ds_read_b128 v[136:139], v24 offset:1024
 v_mfma_f32_16x16x32_bf16 a[212:215], v[32:35], v[72:75], a[212:215]
 s_waitcnt lgkmcnt(8)
 ds_read_b64_tr_b16 v[28:29], v1 offset:256
 v_mul_f32 v188, v188, v253
 v_mul_f32 v189, v189, v253
 v_mul_f32 v190, v190, v253
 v_mul_f32 v191, v191, v253
 v_mul_f32 v192, v192, v253
 v_mul_f32 v193, v193, v253
 v_mul_f32 v194, v194, v253
 v_mul_f32 v195, v195, v253
 v_mul_f32 v196, v196, v253
 v_mul_f32 v197, v197, v253
 v_mfma_f32_16x16x32_bf16 v[148:151], v[36:39], v[60:63], v[148:151]
 s_waitcnt lgkmcnt(7)
 ds_read_b64_tr_b16 v[30:31], v1 offset:768
 v_mul_f32 v198, v198, v253
 v_mul_f32 v199, v199, v253
 v_mul_f32 v200, v200, v253
 v_mul_f32 v201, v201, v253
 v_mul_f32 v202, v202, v253
 v_mul_f32 v203, v203, v253
 v_cvt_pk_bf16_f32 v188, v188, v189
 v_cvt_pk_bf16_f32 v189, v190, v191
 v_cvt_pk_bf16_f32 v190, v192, v193
 v_mfma_f32_16x16x32_bf16 v[152:155], v[40:43], v[60:63], v[152:155]
 v_cvt_pk_bf16_f32 v191, v194, v195
 v_cvt_pk_bf16_f32 v192, v196, v197
 v_cvt_pk_bf16_f32 v193, v198, v199
 v_cvt_pk_bf16_f32 v194, v200, v201
 v_cvt_pk_bf16_f32 v195, v202, v203
 ds_write_b64 v20, v[188:189]
 v_xor_b32 v197, 32, v20
 ds_write_b64 v197, v[190:191]
 v_xor_b32 v198, 64, v20
 v_mfma_f32_16x16x32_bf16 v[212:215], v[36:39], v[64:67], v[212:215]
 ds_write_b64 v198, v[192:193]
 v_xor_b32 v199, 96, v20
 ds_write_b64 v199, v[194:195]
 ds_read_b128 v[196:199], v24
 ds_read_b128 v[200:203], v24 offset:1024
 s_add_u32 s43, s37, 0
 s_waitcnt lgkmcnt(9)
 buffer_store_dwordx4 v[132:135], v25, s[24:27], s43 offen sc0 sc1
 s_add_u32 s43, s37, 4096
 s_waitcnt lgkmcnt(8)
 buffer_store_dwordx4 v[136:139], v25, s[24:27], s43 offen sc0 sc1
 v_mfma_f32_16x16x32_bf16 v[216:219], v[40:43], v[64:67], v[216:219]
 ds_read_b64_tr_b16 v[32:33], v1 offset:288
 v_accvgpr_read_b32 v124, a128
 v_accvgpr_read_b32 v125, a129
 v_accvgpr_read_b32 v126, a130
 v_accvgpr_read_b32 v127, a131
 v_accvgpr_read_b32 v128, a132
 v_accvgpr_read_b32 v129, a133
 v_accvgpr_read_b32 v130, a134
 v_accvgpr_read_b32 v131, a135
 v_accvgpr_read_b32 v132, a136
 v_accvgpr_read_b32 v133, a137
 v_accvgpr_read_b32 v134, a138
 v_accvgpr_read_b32 v135, a139
 v_accvgpr_read_b32 v136, a140
 v_accvgpr_read_b32 v137, a141
 v_mfma_f32_16x16x32_bf16 a[152:155], v[36:39], v[68:71], a[152:155]
 ds_read_b64_tr_b16 v[34:35], v1 offset:800
 v_accvgpr_read_b32 v138, a142
 v_accvgpr_read_b32 v139, a143
 v_mul_f32 v124, v124, v254
 v_mul_f32 v125, v125, v254
 v_mul_f32 v126, v126, v254
 v_mul_f32 v127, v127, v254
 v_mul_f32 v128, v128, v254
 v_mul_f32 v129, v129, v254
 v_mul_f32 v130, v130, v254
 v_mul_f32 v131, v131, v254
 v_mul_f32 v132, v132, v254
 v_mul_f32 v133, v133, v254
 v_mul_f32 v134, v134, v254
 v_mfma_f32_16x16x32_bf16 a[156:159], v[40:43], v[68:71], a[156:159]
 v_mul_f32 v135, v135, v254
 v_mul_f32 v136, v136, v254
 v_mul_f32 v137, v137, v254
 v_mul_f32 v138, v138, v254
 v_mul_f32 v139, v139, v254
 v_cvt_pk_bf16_f32 v124, v124, v125
 v_cvt_pk_bf16_f32 v125, v126, v127
 v_cvt_pk_bf16_f32 v126, v128, v129
 v_cvt_pk_bf16_f32 v127, v130, v131
 v_cvt_pk_bf16_f32 v128, v132, v133
 v_cvt_pk_bf16_f32 v129, v134, v135
 v_cvt_pk_bf16_f32 v130, v136, v137
 v_cvt_pk_bf16_f32 v131, v138, v139
 v_mfma_f32_16x16x32_bf16 a[216:219], v[36:39], v[72:75], a[216:219]
 ds_write_b64 v20, v[124:125]
 v_xor_b32 v133, 32, v20
 ds_write_b64 v133, v[126:127]
 v_xor_b32 v134, 64, v20
 ds_write_b64 v134, v[128:129]
 v_xor_b32 v135, 96, v20
 ds_write_b64 v135, v[130:131]
 ds_read_b128 v[132:135], v24
 ds_read_b128 v[136:139], v24 offset:1024
 s_add_u32 s43, s37, 8192
 s_waitcnt lgkmcnt(9)
 buffer_store_dwordx4 v[196:199], v25, s[24:27], s43 offen sc0 sc1
 s_add_u32 s43, s37, 12288
 s_waitcnt lgkmcnt(8)
 buffer_store_dwordx4 v[200:203], v25, s[24:27], s43 offen sc0 sc1
 v_mfma_f32_16x16x32_bf16 a[220:223], v[40:43], v[72:75], a[220:223]
 ds_read_b64_tr_b16 v[36:37], v1 offset:320
 v_accvgpr_read_b32 v188, a192
 v_accvgpr_read_b32 v189, a193
 v_accvgpr_read_b32 v190, a194
 v_accvgpr_read_b32 v191, a195
 v_accvgpr_read_b32 v192, a196
 v_accvgpr_read_b32 v193, a197
 v_accvgpr_read_b32 v194, a198
 v_accvgpr_read_b32 v195, a199
 v_accvgpr_read_b32 v196, a200
 v_accvgpr_read_b32 v197, a201
 v_accvgpr_read_b32 v198, a202
 v_accvgpr_read_b32 v199, a203
 v_accvgpr_read_b32 v200, a204
 v_accvgpr_read_b32 v201, a205
 v_accvgpr_read_b32 v202, a206
 v_accvgpr_read_b32 v203, a207
 v_mul_f32 v188, v188, v255
 v_mul_f32 v189, v189, v255
 v_mfma_f32_16x16x32_bf16 v[156:159], v[28:31], v[60:63], v[156:159]
 s_waitcnt lgkmcnt(7)
 ds_read_b64_tr_b16 v[38:39], v1 offset:832
 v_mul_f32 v190, v190, v255
 v_mul_f32 v191, v191, v255
 v_mul_f32 v192, v192, v255
 v_mul_f32 v193, v193, v255
 v_mul_f32 v194, v194, v255
 v_mul_f32 v195, v195, v255
 v_mul_f32 v196, v196, v255
 v_mul_f32 v197, v197, v255
 v_mul_f32 v198, v198, v255
 v_mul_f32 v199, v199, v255
 v_mul_f32 v200, v200, v255
 v_mul_f32 v201, v201, v255
 v_mul_f32 v202, v202, v255
 v_mul_f32 v203, v203, v255
 v_cvt_pk_bf16_f32 v188, v188, v189
 v_cvt_pk_bf16_f32 v189, v190, v191
 v_cvt_pk_bf16_f32 v190, v192, v193
 v_cvt_pk_bf16_f32 v191, v194, v195
 v_mfma_f32_16x16x32_bf16 v[160:163], v[32:35], v[60:63], v[160:163]
 v_cvt_pk_bf16_f32 v192, v196, v197
 v_cvt_pk_bf16_f32 v193, v198, v199
 v_cvt_pk_bf16_f32 v194, v200, v201
 v_cvt_pk_bf16_f32 v195, v202, v203
 ds_write_b64 v20, v[188:189]
 v_xor_b32 v197, 32, v20
 ds_write_b64 v197, v[190:191]
 v_xor_b32 v198, 64, v20
 ds_write_b64 v198, v[192:193]
 v_xor_b32 v199, 96, v20
 ds_write_b64 v199, v[194:195]
 ds_read_b128 v[196:199], v24
 ds_read_b128 v[200:203], v24 offset:1024
 s_add_u32 s43, s37, 16384
 s_waitcnt lgkmcnt(9)
 buffer_store_dwordx4 v[132:135], v25, s[24:27], s43 offen sc0 sc1
 s_add_u32 s43, s37, 20480
 s_waitcnt lgkmcnt(8)
 buffer_store_dwordx4 v[136:139], v25, s[24:27], s43 offen sc0 sc1
 v_mfma_f32_16x16x32_bf16 v[220:223], v[28:31], v[64:67], v[220:223]
 v_mfma_f32_16x16x32_bf16 v[224:227], v[32:35], v[64:67], v[224:227]
 ds_read_b64_tr_b16 v[40:41], v1 offset:352
 v_mul_f32 v140, v140, v252
 v_mul_f32 v141, v141, v252
 v_mul_f32 v142, v142, v252
 v_mul_f32 v143, v143, v252
 v_mul_f32 v144, v144, v252
 v_mul_f32 v145, v145, v252
 v_mul_f32 v146, v146, v252
 v_mul_f32 v147, v147, v252
 v_mul_f32 v148, v148, v252
 v_mul_f32 v149, v149, v252
 v_mul_f32 v150, v150, v252
 v_mul_f32 v151, v151, v252
 v_mul_f32 v152, v152, v252
 v_mfma_f32_16x16x32_bf16 a[160:163], v[28:31], v[68:71], a[160:163]
 ds_read_b64_tr_b16 v[42:43], v1 offset:864
 v_mul_f32 v153, v153, v252
 v_mul_f32 v154, v154, v252
 v_mul_f32 v155, v155, v252
 v_cvt_pk_bf16_f32 v140, v140, v141
 v_cvt_pk_bf16_f32 v141, v142, v143
 v_cvt_pk_bf16_f32 v142, v144, v145
 v_cvt_pk_bf16_f32 v143, v146, v147
 v_cvt_pk_bf16_f32 v144, v148, v149
 v_cvt_pk_bf16_f32 v145, v150, v151
 v_cvt_pk_bf16_f32 v146, v152, v153
 v_cvt_pk_bf16_f32 v147, v154, v155
 ds_write_b64 v20, v[140:141]
 v_mfma_f32_16x16x32_bf16 a[164:167], v[32:35], v[68:71], a[164:167]
 v_xor_b32 v149, 32, v20
 ds_write_b64 v149, v[142:143]
 v_xor_b32 v150, 64, v20
 ds_write_b64 v150, v[144:145]
 v_xor_b32 v151, 96, v20
 ds_write_b64 v151, v[146:147]
 ds_read_b128 v[148:151], v24
 ds_read_b128 v[152:155], v24 offset:1024
 s_add_u32 s43, s37, 24576
 s_waitcnt lgkmcnt(9)
 buffer_store_dwordx4 v[196:199], v25, s[24:27], s43 offen sc0 sc1
 s_add_u32 s43, s37, 28672
 s_waitcnt lgkmcnt(8)
 buffer_store_dwordx4 v[200:203], v25, s[24:27], s43 offen sc0 sc1
 v_mfma_f32_16x16x32_bf16 a[224:227], v[28:31], v[72:75], a[224:227]
 v_mul_f32 v204, v204, v253
 v_mul_f32 v205, v205, v253
 v_mul_f32 v206, v206, v253
 v_mul_f32 v207, v207, v253
 v_mul_f32 v208, v208, v253
 v_mul_f32 v209, v209, v253
 v_mul_f32 v210, v210, v253
 v_mul_f32 v211, v211, v253
 v_mul_f32 v212, v212, v253
 v_mul_f32 v213, v213, v253
 v_mfma_f32_16x16x32_bf16 a[228:231], v[32:35], v[72:75], a[228:231]
 ds_read_b64_tr_b16 v[28:29], v1 offset:384
 v_mul_f32 v214, v214, v253
 v_mul_f32 v215, v215, v253
 v_mul_f32 v216, v216, v253
 v_mul_f32 v217, v217, v253
 v_mul_f32 v218, v218, v253
 v_mul_f32 v219, v219, v253
 v_cvt_pk_bf16_f32 v204, v204, v205
 v_cvt_pk_bf16_f32 v205, v206, v207
 v_cvt_pk_bf16_f32 v206, v208, v209
 v_mfma_f32_16x16x32_bf16 v[164:167], v[36:39], v[60:63], v[164:167]
 s_waitcnt lgkmcnt(7)
 ds_read_b64_tr_b16 v[30:31], v1 offset:896
 v_cvt_pk_bf16_f32 v207, v210, v211
 v_cvt_pk_bf16_f32 v208, v212, v213
 v_cvt_pk_bf16_f32 v209, v214, v215
 v_cvt_pk_bf16_f32 v210, v216, v217
 v_cvt_pk_bf16_f32 v211, v218, v219
 ds_write_b64 v20, v[204:205]
 v_xor_b32 v213, 32, v20
 ds_write_b64 v213, v[206:207]
 v_xor_b32 v214, 64, v20
 v_mfma_f32_16x16x32_bf16 v[168:171], v[40:43], v[60:63], v[168:171]
 ds_write_b64 v214, v[208:209]
 v_xor_b32 v215, 96, v20
 ds_write_b64 v215, v[210:211]
 ds_read_b128 v[212:215], v24
 ds_read_b128 v[216:219], v24 offset:1024
 s_add_u32 s43, s37, 0
 s_waitcnt lgkmcnt(9)
 buffer_store_dwordx4 v[148:151], v25, s[24:27], s43 offen offset:128 sc0 sc1
 s_add_u32 s43, s37, 4096
 s_waitcnt lgkmcnt(8)
 buffer_store_dwordx4 v[152:155], v25, s[24:27], s43 offen offset:128 sc0 sc1
 v_mfma_f32_16x16x32_bf16 v[228:231], v[36:39], v[64:67], v[228:231]
 v_accvgpr_read_b32 v140, a144
 v_accvgpr_read_b32 v141, a145
 v_accvgpr_read_b32 v142, a146
 v_accvgpr_read_b32 v143, a147
 v_accvgpr_read_b32 v144, a148
 v_accvgpr_read_b32 v145, a149
 v_accvgpr_read_b32 v146, a150
 v_accvgpr_read_b32 v147, a151
 v_accvgpr_read_b32 v148, a152
 v_accvgpr_read_b32 v149, a153
 v_accvgpr_read_b32 v150, a154
 v_accvgpr_read_b32 v151, a155
 v_accvgpr_read_b32 v152, a156
 v_accvgpr_read_b32 v153, a157
 v_accvgpr_read_b32 v154, a158
 v_accvgpr_read_b32 v155, a159
 v_mul_f32 v140, v140, v254
 v_mul_f32 v141, v141, v254
 v_mfma_f32_16x16x32_bf16 v[232:235], v[40:43], v[64:67], v[232:235]
 ds_read_b64_tr_b16 v[32:33], v1 offset:416
 v_mul_f32 v142, v142, v254
 v_mul_f32 v143, v143, v254
 v_mul_f32 v144, v144, v254
 v_mul_f32 v145, v145, v254
 v_mul_f32 v146, v146, v254
 v_mul_f32 v147, v147, v254
 v_mul_f32 v148, v148, v254
 v_mul_f32 v149, v149, v254
 v_mul_f32 v150, v150, v254
 v_mul_f32 v151, v151, v254
 v_mul_f32 v152, v152, v254
 v_mul_f32 v153, v153, v254
 v_mul_f32 v154, v154, v254
 v_mul_f32 v155, v155, v254
 v_cvt_pk_bf16_f32 v140, v140, v141
 v_cvt_pk_bf16_f32 v141, v142, v143
 v_cvt_pk_bf16_f32 v142, v144, v145
 v_cvt_pk_bf16_f32 v143, v146, v147
 v_mfma_f32_16x16x32_bf16 a[168:171], v[36:39], v[68:71], a[168:171]
 ds_read_b64_tr_b16 v[34:35], v1 offset:928
 v_cvt_pk_bf16_f32 v144, v148, v149
 v_cvt_pk_bf16_f32 v145, v150, v151
 v_cvt_pk_bf16_f32 v146, v152, v153
 v_cvt_pk_bf16_f32 v147, v154, v155
 ds_write_b64 v20, v[140:141]
 v_xor_b32 v149, 32, v20
 ds_write_b64 v149, v[142:143]
 v_xor_b32 v150, 64, v20
 ds_write_b64 v150, v[144:145]
 v_xor_b32 v151, 96, v20
 ds_write_b64 v151, v[146:147]
 ds_read_b128 v[148:151], v24
 ds_read_b128 v[152:155], v24 offset:1024
 s_add_u32 s43, s37, 8192
 s_waitcnt lgkmcnt(9)
 buffer_store_dwordx4 v[212:215], v25, s[24:27], s43 offen offset:128 sc0 sc1
 s_add_u32 s43, s37, 12288
 s_waitcnt lgkmcnt(8)
 buffer_store_dwordx4 v[216:219], v25, s[24:27], s43 offen offset:128 sc0 sc1
 v_mfma_f32_16x16x32_bf16 a[172:175], v[40:43], v[68:71], a[172:175]
 v_accvgpr_read_b32 v204, a208
 v_accvgpr_read_b32 v205, a209
 v_accvgpr_read_b32 v206, a210
 v_accvgpr_read_b32 v207, a211
 v_accvgpr_read_b32 v208, a212
 v_accvgpr_read_b32 v209, a213
 v_accvgpr_read_b32 v210, a214
 v_accvgpr_read_b32 v211, a215
 v_accvgpr_read_b32 v212, a216
 v_accvgpr_read_b32 v213, a217
 v_accvgpr_read_b32 v214, a218
 v_accvgpr_read_b32 v215, a219
 v_accvgpr_read_b32 v216, a220
 v_accvgpr_read_b32 v217, a221
 v_mfma_f32_16x16x32_bf16 a[232:235], v[36:39], v[72:75], a[232:235]
 v_accvgpr_read_b32 v218, a222
 v_accvgpr_read_b32 v219, a223
 v_mul_f32 v204, v204, v255
 v_mul_f32 v205, v205, v255
 v_mul_f32 v206, v206, v255
 v_mul_f32 v207, v207, v255
 v_mul_f32 v208, v208, v255
 v_mul_f32 v209, v209, v255
 v_mul_f32 v210, v210, v255
 v_mul_f32 v211, v211, v255
 v_mul_f32 v212, v212, v255
 v_mul_f32 v213, v213, v255
 v_mul_f32 v214, v214, v255
 v_mfma_f32_16x16x32_bf16 a[236:239], v[40:43], v[72:75], a[236:239]
 ds_read_b64_tr_b16 v[36:37], v1 offset:448
 v_mul_f32 v215, v215, v255
 v_mul_f32 v216, v216, v255
 v_mul_f32 v217, v217, v255
 v_mul_f32 v218, v218, v255
 v_mul_f32 v219, v219, v255
 v_cvt_pk_bf16_f32 v204, v204, v205
 v_cvt_pk_bf16_f32 v205, v206, v207
 v_cvt_pk_bf16_f32 v206, v208, v209
 v_cvt_pk_bf16_f32 v207, v210, v211
 v_cvt_pk_bf16_f32 v208, v212, v213
 v_cvt_pk_bf16_f32 v209, v214, v215
 v_cvt_pk_bf16_f32 v210, v216, v217
 v_cvt_pk_bf16_f32 v211, v218, v219
 v_mfma_f32_16x16x32_bf16 v[172:175], v[28:31], v[60:63], v[172:175]
 s_waitcnt lgkmcnt(7)
 ds_read_b64_tr_b16 v[38:39], v1 offset:960
 ds_write_b64 v20, v[204:205]
 v_xor_b32 v213, 32, v20
 ds_write_b64 v213, v[206:207]
 v_xor_b32 v214, 64, v20
 ds_write_b64 v214, v[208:209]
 v_xor_b32 v215, 96, v20
 ds_write_b64 v215, v[210:211]
 ds_read_b128 v[212:215], v24
 ds_read_b128 v[216:219], v24 offset:1024
 s_add_u32 s43, s37, 16384
 s_waitcnt lgkmcnt(9)
 buffer_store_dwordx4 v[148:151], v25, s[24:27], s43 offen offset:128 sc0 sc1
 s_add_u32 s43, s37, 20480
 s_waitcnt lgkmcnt(8)
 buffer_store_dwordx4 v[152:155], v25, s[24:27], s43 offen offset:128 sc0 sc1
 v_mfma_f32_16x16x32_bf16 v[176:179], v[32:35], v[60:63], v[176:179]
 v_mfma_f32_16x16x32_bf16 v[236:239], v[28:31], v[64:67], v[236:239]
 v_mfma_f32_16x16x32_bf16 v[240:243], v[32:35], v[64:67], v[240:243]
 ds_read_b64_tr_b16 v[40:41], v1 offset:480
 v_mul_f32 v156, v156, v252
 v_mul_f32 v157, v157, v252
 v_mul_f32 v158, v158, v252
 v_mul_f32 v159, v159, v252
 v_mul_f32 v160, v160, v252
 v_mul_f32 v161, v161, v252
 v_mul_f32 v162, v162, v252
 v_mul_f32 v163, v163, v252
 v_mul_f32 v164, v164, v252
 v_mul_f32 v165, v165, v252
 v_mul_f32 v166, v166, v252
 v_mul_f32 v167, v167, v252
 v_mul_f32 v168, v168, v252
 v_mul_f32 v169, v169, v252
 v_mul_f32 v170, v170, v252
 v_mul_f32 v171, v171, v252
 v_cvt_pk_bf16_f32 v156, v156, v157
 v_cvt_pk_bf16_f32 v157, v158, v159
 v_cvt_pk_bf16_f32 v158, v160, v161
 v_mfma_f32_16x16x32_bf16 a[176:179], v[28:31], v[68:71], a[176:179]
 ds_read_b64_tr_b16 v[42:43], v1 offset:992
 v_cvt_pk_bf16_f32 v159, v162, v163
 v_cvt_pk_bf16_f32 v160, v164, v165
 v_cvt_pk_bf16_f32 v161, v166, v167
 v_cvt_pk_bf16_f32 v162, v168, v169
 v_cvt_pk_bf16_f32 v163, v170, v171
 ds_write_b64 v20, v[156:157]
 v_xor_b32 v165, 32, v20
 ds_write_b64 v165, v[158:159]
 v_xor_b32 v166, 64, v20
 ds_write_b64 v166, v[160:161]
 v_xor_b32 v167, 96, v20
 ds_write_b64 v167, v[162:163]
 ds_read_b128 v[164:167], v24
 ds_read_b128 v[168:171], v24 offset:1024
 s_add_u32 s43, s37, 24576
 s_waitcnt lgkmcnt(9)
 buffer_store_dwordx4 v[212:215], v25, s[24:27], s43 offen offset:128 sc0 sc1
 s_add_u32 s43, s37, 28672
 s_waitcnt lgkmcnt(8)
 buffer_store_dwordx4 v[216:219], v25, s[24:27], s43 offen offset:128 sc0 sc1
 v_mfma_f32_16x16x32_bf16 a[180:183], v[32:35], v[68:71], a[180:183]
 v_mul_f32 v220, v220, v253
 v_mul_f32 v221, v221, v253
 v_mul_f32 v222, v222, v253
 v_mul_f32 v223, v223, v253
 v_mul_f32 v224, v224, v253
 v_mul_f32 v225, v225, v253
 v_mul_f32 v226, v226, v253
 v_mul_f32 v227, v227, v253
 v_mul_f32 v228, v228, v253
 v_mul_f32 v229, v229, v253
 v_mul_f32 v230, v230, v253
 v_mul_f32 v231, v231, v253
 v_mul_f32 v232, v232, v253
 v_mfma_f32_16x16x32_bf16 a[240:243], v[28:31], v[72:75], a[240:243]
 v_mul_f32 v233, v233, v253
 v_mul_f32 v234, v234, v253
 v_mul_f32 v235, v235, v253
 v_cvt_pk_bf16_f32 v220, v220, v221
 v_cvt_pk_bf16_f32 v221, v222, v223
 v_cvt_pk_bf16_f32 v222, v224, v225
 v_cvt_pk_bf16_f32 v223, v226, v227
 v_cvt_pk_bf16_f32 v224, v228, v229
 v_cvt_pk_bf16_f32 v225, v230, v231
 v_cvt_pk_bf16_f32 v226, v232, v233
 v_cvt_pk_bf16_f32 v227, v234, v235
 ds_write_b64 v20, v[220:221]
 v_mfma_f32_16x16x32_bf16 a[244:247], v[32:35], v[72:75], a[244:247]
 v_xor_b32 v229, 32, v20
 ds_write_b64 v229, v[222:223]
 v_xor_b32 v230, 64, v20
 ds_write_b64 v230, v[224:225]
 v_xor_b32 v231, 96, v20
 ds_write_b64 v231, v[226:227]
 ds_read_b128 v[228:231], v24
 ds_read_b128 v[232:235], v24 offset:1024
 s_add_u32 s43, s37, 0
 s_waitcnt lgkmcnt(7)
 buffer_store_dwordx4 v[164:167], v25, s[24:27], s43 offen offset:256 sc0 sc1
 s_add_u32 s43, s37, 4096
 s_waitcnt lgkmcnt(6)
 buffer_store_dwordx4 v[168:171], v25, s[24:27], s43 offen offset:256 sc0 sc1
 v_mfma_f32_16x16x32_bf16 v[180:183], v[36:39], v[60:63], v[180:183]
 v_accvgpr_read_b32 v156, a160
 v_accvgpr_read_b32 v157, a161
 v_accvgpr_read_b32 v158, a162
 v_accvgpr_read_b32 v159, a163
 v_accvgpr_read_b32 v160, a164
 v_accvgpr_read_b32 v161, a165
 v_accvgpr_read_b32 v162, a166
 v_accvgpr_read_b32 v163, a167
 v_accvgpr_read_b32 v164, a168
 v_accvgpr_read_b32 v165, a169
 v_accvgpr_read_b32 v166, a170
 v_accvgpr_read_b32 v167, a171
 v_accvgpr_read_b32 v168, a172
 v_accvgpr_read_b32 v169, a173
 v_mfma_f32_16x16x32_bf16 v[184:187], v[40:43], v[60:63], v[184:187]
 v_accvgpr_read_b32 v170, a174
 v_accvgpr_read_b32 v171, a175
 v_mul_f32 v156, v156, v254
 v_mul_f32 v157, v157, v254
 v_mul_f32 v158, v158, v254
 v_mul_f32 v159, v159, v254
 v_mul_f32 v160, v160, v254
 v_mul_f32 v161, v161, v254
 v_mul_f32 v162, v162, v254
 v_mul_f32 v163, v163, v254
 v_mul_f32 v164, v164, v254
 v_mul_f32 v165, v165, v254
 v_mul_f32 v166, v166, v254
 v_mfma_f32_16x16x32_bf16 v[244:247], v[36:39], v[64:67], v[244:247]
 v_mul_f32 v167, v167, v254
 v_mul_f32 v168, v168, v254
 v_mul_f32 v169, v169, v254
 v_mul_f32 v170, v170, v254
 v_mul_f32 v171, v171, v254
 v_cvt_pk_bf16_f32 v156, v156, v157
 v_cvt_pk_bf16_f32 v157, v158, v159
 v_cvt_pk_bf16_f32 v158, v160, v161
 v_cvt_pk_bf16_f32 v159, v162, v163
 v_cvt_pk_bf16_f32 v160, v164, v165
 v_cvt_pk_bf16_f32 v161, v166, v167
 v_cvt_pk_bf16_f32 v162, v168, v169
 v_cvt_pk_bf16_f32 v163, v170, v171
 v_mfma_f32_16x16x32_bf16 v[248:251], v[40:43], v[64:67], v[248:251]
 ds_write_b64 v20, v[156:157]
 v_xor_b32 v165, 32, v20
 ds_write_b64 v165, v[158:159]
 v_xor_b32 v166, 64, v20
 ds_write_b64 v166, v[160:161]
 v_xor_b32 v167, 96, v20
 ds_write_b64 v167, v[162:163]
 ds_read_b128 v[164:167], v24
 ds_read_b128 v[168:171], v24 offset:1024
 s_add_u32 s43, s37, 8192
 s_waitcnt lgkmcnt(7)
 buffer_store_dwordx4 v[228:231], v25, s[24:27], s43 offen offset:256 sc0 sc1
 s_add_u32 s43, s37, 12288
 s_waitcnt lgkmcnt(6)
 buffer_store_dwordx4 v[232:235], v25, s[24:27], s43 offen offset:256 sc0 sc1
 v_mfma_f32_16x16x32_bf16 a[184:187], v[36:39], v[68:71], a[184:187]
 v_accvgpr_read_b32 v220, a224
 v_accvgpr_read_b32 v221, a225
 v_accvgpr_read_b32 v222, a226
 v_accvgpr_read_b32 v223, a227
 v_accvgpr_read_b32 v224, a228
 v_accvgpr_read_b32 v225, a229
 v_accvgpr_read_b32 v226, a230
 v_accvgpr_read_b32 v227, a231
 v_accvgpr_read_b32 v228, a232
 v_accvgpr_read_b32 v229, a233
 v_accvgpr_read_b32 v230, a234
 v_accvgpr_read_b32 v231, a235
 v_accvgpr_read_b32 v232, a236
 v_accvgpr_read_b32 v233, a237
 v_mfma_f32_16x16x32_bf16 a[188:191], v[40:43], v[68:71], a[188:191]
 v_accvgpr_read_b32 v234, a238
 v_accvgpr_read_b32 v235, a239
 v_mul_f32 v220, v220, v255
 v_mul_f32 v221, v221, v255
 v_mul_f32 v222, v222, v255
 v_mul_f32 v223, v223, v255
 v_mul_f32 v224, v224, v255
 v_mul_f32 v225, v225, v255
 v_mul_f32 v226, v226, v255
 v_mul_f32 v227, v227, v255
 v_mul_f32 v228, v228, v255
 v_mul_f32 v229, v229, v255
 v_mul_f32 v230, v230, v255
 v_mfma_f32_16x16x32_bf16 a[248:251], v[36:39], v[72:75], a[248:251]
 v_mul_f32 v231, v231, v255
 v_mul_f32 v232, v232, v255
 v_mul_f32 v233, v233, v255
 v_mul_f32 v234, v234, v255
 v_mul_f32 v235, v235, v255
 v_cvt_pk_bf16_f32 v220, v220, v221
 v_cvt_pk_bf16_f32 v221, v222, v223
 v_cvt_pk_bf16_f32 v222, v224, v225
 v_cvt_pk_bf16_f32 v223, v226, v227
 v_cvt_pk_bf16_f32 v224, v228, v229
 v_cvt_pk_bf16_f32 v225, v230, v231
 v_cvt_pk_bf16_f32 v226, v232, v233
 v_cvt_pk_bf16_f32 v227, v234, v235
 v_mfma_f32_16x16x32_bf16 a[252:255], v[40:43], v[72:75], a[252:255]
 ds_write_b64 v20, v[220:221]
 v_xor_b32 v229, 32, v20
 ds_write_b64 v229, v[222:223]
 v_xor_b32 v230, 64, v20
 ds_write_b64 v230, v[224:225]
 v_xor_b32 v231, 96, v20
 ds_write_b64 v231, v[226:227]
 ds_read_b128 v[228:231], v24
 ds_read_b128 v[232:235], v24 offset:1024
 s_add_u32 s43, s37, 16384
 s_waitcnt lgkmcnt(7)
 buffer_store_dwordx4 v[164:167], v25, s[24:27], s43 offen offset:256 sc0 sc1
 s_add_u32 s43, s37, 20480
 s_waitcnt lgkmcnt(6)
 buffer_store_dwordx4 v[168:171], v25, s[24:27], s43 offen offset:256 sc0 sc1
L_fin:
 s_nop 7
 v_mov_b32 v6, v252
 v_mov_b32 v7, v252
 v_mov_b32 v8, v253
 v_mov_b32 v9, v253
 v_mov_b32 v14, v254
 v_mov_b32 v15, v254
 v_mov_b32 v16, v255
 v_mov_b32 v17, v255
 v_pk_mul_f32 v[172:173], v[172:173], v[6:7]
 v_pk_mul_f32 v[174:175], v[174:175], v[6:7]
 v_pk_mul_f32 v[176:177], v[176:177], v[6:7]
 v_pk_mul_f32 v[178:179], v[178:179], v[6:7]
 v_pk_mul_f32 v[180:181], v[180:181], v[6:7]
 v_pk_mul_f32 v[182:183], v[182:183], v[6:7]
 v_pk_mul_f32 v[184:185], v[184:185], v[6:7]
 v_pk_mul_f32 v[186:187], v[186:187], v[6:7]
 v_cvt_pk_bf16_f32 v172, v172, v173
 v_cvt_pk_bf16_f32 v173, v174, v175
 v_cvt_pk_bf16_f32 v174, v176, v177
 v_cvt_pk_bf16_f32 v175, v178, v179
 v_cvt_pk_bf16_f32 v176, v180, v181
 v_cvt_pk_bf16_f32 v177, v182, v183
 v_cvt_pk_bf16_f32 v178, v184, v185
 v_cvt_pk_bf16_f32 v179, v186, v187
 ds_write_b64 v20, v[172:173]
 v_xor_b32 v181, 32, v20
 ds_write_b64 v181, v[174:175]
 v_xor_b32 v182, 64, v20
 ds_write_b64 v182, v[176:177]
 v_xor_b32 v183, 96, v20
 ds_write_b64 v183, v[178:179]
 ds_read_b128 v[180:183], v24
 ds_read_b128 v[184:187], v24 offset:1024
 s_add_u32 s43, s37, 24576
 s_waitcnt lgkmcnt(7)
 buffer_store_dwordx4 v[228:231], v25, s[24:27], s43 offen offset:256 sc0 sc1
 s_add_u32 s43, s37, 28672
 s_waitcnt lgkmcnt(6)
 buffer_store_dwordx4 v[232:235], v25, s[24:27], s43 offen offset:256 sc0 sc1
 v_pk_mul_f32 v[236:237], v[236:237], v[8:9]
 v_pk_mul_f32 v[238:239], v[238:239], v[8:9]
 v_pk_mul_f32 v[240:241], v[240:241], v[8:9]
 v_pk_mul_f32 v[242:243], v[242:243], v[8:9]
 v_pk_mul_f32 v[244:245], v[244:245], v[8:9]
 v_pk_mul_f32 v[246:247], v[246:247], v[8:9]
 v_pk_mul_f32 v[248:249], v[248:249], v[8:9]
 v_pk_mul_f32 v[250:251], v[250:251], v[8:9]
 v_cvt_pk_bf16_f32 v236, v236, v237
 v_cvt_pk_bf16_f32 v237, v238, v239
 v_cvt_pk_bf16_f32 v238, v240, v241
 v_cvt_pk_bf16_f32 v239, v242, v243
 v_cvt_pk_bf16_f32 v240, v244, v245
 v_cvt_pk_bf16_f32 v241, v246, v247
 v_cvt_pk_bf16_f32 v242, v248, v249
 v_cvt_pk_bf16_f32 v243, v250, v251
 ds_write_b64 v20, v[236:237]
 v_xor_b32 v245, 32, v20
 ds_write_b64 v245, v[238:239]
 v_xor_b32 v246, 64, v20
 ds_write_b64 v246, v[240:241]
 v_xor_b32 v247, 96, v20
 ds_write_b64 v247, v[242:243]
 ds_read_b128 v[244:247], v24
 ds_read_b128 v[248:251], v24 offset:1024
 s_add_u32 s43, s37, 0
 s_waitcnt lgkmcnt(7)
 buffer_store_dwordx4 v[180:183], v25, s[24:27], s43 offen offset:384 sc0 sc1
 s_add_u32 s43, s37, 4096
 s_waitcnt lgkmcnt(6)
 buffer_store_dwordx4 v[184:187], v25, s[24:27], s43 offen offset:384 sc0 sc1
 v_accvgpr_read_b32 v172, a176
 v_accvgpr_read_b32 v173, a177
 v_accvgpr_read_b32 v174, a178
 v_accvgpr_read_b32 v175, a179
 v_accvgpr_read_b32 v176, a180
 v_accvgpr_read_b32 v177, a181
 v_accvgpr_read_b32 v178, a182
 v_accvgpr_read_b32 v179, a183
 v_accvgpr_read_b32 v180, a184
 v_accvgpr_read_b32 v181, a185
 v_accvgpr_read_b32 v182, a186
 v_accvgpr_read_b32 v183, a187
 v_accvgpr_read_b32 v184, a188
 v_accvgpr_read_b32 v185, a189
 v_accvgpr_read_b32 v186, a190
 v_accvgpr_read_b32 v187, a191
 v_pk_mul_f32 v[172:173], v[172:173], v[14:15]
 v_pk_mul_f32 v[174:175], v[174:175], v[14:15]
 v_pk_mul_f32 v[176:177], v[176:177], v[14:15]
 v_pk_mul_f32 v[178:179], v[178:179], v[14:15]
 v_pk_mul_f32 v[180:181], v[180:181], v[14:15]
 v_pk_mul_f32 v[182:183], v[182:183], v[14:15]
 v_pk_mul_f32 v[184:185], v[184:185], v[14:15]
 v_pk_mul_f32 v[186:187], v[186:187], v[14:15]
 v_cvt_pk_bf16_f32 v172, v172, v173
 v_cvt_pk_bf16_f32 v173, v174, v175
 v_cvt_pk_bf16_f32 v174, v176, v177
 v_cvt_pk_bf16_f32 v175, v178, v179
 v_cvt_pk_bf16_f32 v176, v180, v181
 v_cvt_pk_bf16_f32 v177, v182, v183
 v_cvt_pk_bf16_f32 v178, v184, v185
 v_cvt_pk_bf16_f32 v179, v186, v187
 ds_write_b64 v20, v[172:173]
 v_xor_b32 v181, 32, v20
 ds_write_b64 v181, v[174:175]
 v_xor_b32 v182, 64, v20
 ds_write_b64 v182, v[176:177]
 v_xor_b32 v183, 96, v20
 ds_write_b64 v183, v[178:179]
 ds_read_b128 v[180:183], v24
 ds_read_b128 v[184:187], v24 offset:1024
 s_add_u32 s43, s37, 8192
 s_waitcnt lgkmcnt(7)
 buffer_store_dwordx4 v[244:247], v25, s[24:27], s43 offen offset:384 sc0 sc1
 s_add_u32 s43, s37, 12288
 s_waitcnt lgkmcnt(6)
 buffer_store_dwordx4 v[248:251], v25, s[24:27], s43 offen offset:384 sc0 sc1
 v_accvgpr_read_b32 v236, a240
 v_accvgpr_read_b32 v237, a241
 v_accvgpr_read_b32 v238, a242
 v_accvgpr_read_b32 v239, a243
 v_accvgpr_read_b32 v240, a244
 v_accvgpr_read_b32 v241, a245
 v_accvgpr_read_b32 v242, a246
 v_accvgpr_read_b32 v243, a247
 v_accvgpr_read_b32 v244, a248
 v_accvgpr_read_b32 v245, a249
 v_accvgpr_read_b32 v246, a250
 v_accvgpr_read_b32 v247, a251
 v_accvgpr_read_b32 v248, a252
 v_accvgpr_read_b32 v249, a253
 v_accvgpr_read_b32 v250, a254
 v_accvgpr_read_b32 v251, a255
 v_pk_mul_f32 v[236:237], v[236:237], v[16:17]
 v_pk_mul_f32 v[238:239], v[238:239], v[16:17]
 v_pk_mul_f32 v[240:241], v[240:241], v[16:17]
 v_pk_mul_f32 v[242:243], v[242:243], v[16:17]
 v_pk_mul_f32 v[244:245], v[244:245], v[16:17]
 v_pk_mul_f32 v[246:247], v[246:247], v[16:17]
 v_pk_mul_f32 v[248:249], v[248:249], v[16:17]
 v_pk_mul_f32 v[250:251], v[250:251], v[16:17]
 v_cvt_pk_bf16_f32 v236, v236, v237
 v_cvt_pk_bf16_f32 v237, v238, v239
 v_cvt_pk_bf16_f32 v238, v240, v241
 v_cvt_pk_bf16_f32 v239, v242, v243
 v_cvt_pk_bf16_f32 v240, v244, v245
 v_cvt_pk_bf16_f32 v241, v246, v247
 v_cvt_pk_bf16_f32 v242, v248, v249
 v_cvt_pk_bf16_f32 v243, v250, v251
 ds_write_b64 v20, v[236:237]
 v_xor_b32 v245, 32, v20
 ds_write_b64 v245, v[238:239]
 v_xor_b32 v246, 64, v20
 ds_write_b64 v246, v[240:241]
 v_xor_b32 v247, 96, v20
 ds_write_b64 v247, v[242:243]
 ds_read_b128 v[244:247], v24
 ds_read_b128 v[248:251], v24 offset:1024
 s_add_u32 s43, s37, 16384
 s_waitcnt lgkmcnt(7)
 buffer_store_dwordx4 v[180:183], v25, s[24:27], s43 offen offset:384 sc0 sc1
 s_add_u32 s43, s37, 20480
 s_waitcnt lgkmcnt(6)
 buffer_store_dwordx4 v[184:187], v25, s[24:27], s43 offen offset:384 sc0 sc1
 s_add_u32 s43, s37, 24576
 s_waitcnt lgkmcnt(1)
 buffer_store_dwordx4 v[244:247], v25, s[24:27], s43 offen offset:384 sc0 sc1
 s_add_u32 s43, s37, 28672
 s_waitcnt lgkmcnt(0)
 buffer_store_dwordx4 v[248:251], v25, s[24:27], s43 offen offset:384 sc0 sc1
L_done:
 s_endpgm
L_o_dr0a:
 ds_read_b128 v[24:27], v5
 ds_read_b128 v[252:255], v5 offset:1024
 s_branch L_b_dr0a
L_o_dr0b:
 s_add_u32 s43, s45, 0
 s_waitcnt lgkmcnt(5)
 buffer_store_dwordx4 v[24:27], v18, s[24:27], s43 offen sc0 sc1
 s_add_u32 s43, s45, 4096
 s_waitcnt lgkmcnt(4)
 buffer_store_dwordx4 v[252:255], v18, s[24:27], s43 offen sc0 sc1
 s_branch L_b_dr0b
L_o_xq:
 s_add_u32 s42, s7, 0
 s_add_u32 m0, s8, 0
 s_nop 0
 buffer_load_dwordx4 v4, s[12:15], s42 offen nt lds
 s_add_u32 s42, s7, 4096
 s_add_u32 m0, s8, 1024
 s_nop 0
 buffer_load_dwordx4 v5, s[12:15], s42 offen nt lds
 s_add_u32 s42, s7, 8192
 s_add_u32 m0, s8, 2048
 s_nop 0
 buffer_load_dwordx4 v4, s[12:15], s42 offen nt lds
 s_add_u32 s42, s7, 12288
 s_add_u32 m0, s8, 3072
 s_nop 0
 buffer_load_dwordx4 v5, s[12:15], s42 offen nt lds
 s_add_u32 s7, s7, 16384
 s_add_u32 s8, s8, 16384
 s_branch L_b_xq
L_o_dr1a:
 ds_read_b128 v[24:27], v5 offset:2048
 ds_read_b128 v[252:255], v5 offset:3072
 s_branch L_b_dr1a
L_o_dr1b:
 s_add_u32 s43, s45, 0
 s_waitcnt lgkmcnt(5)
 buffer_store_dwordx4 v[24:27], v18, s[24:27], s43 offen offset:256 sc0 sc1
 s_add_u32 s43, s45, 4096
 s_waitcnt lgkmcnt(4)
 buffer_store_dwordx4 v[252:255], v18, s[24:27], s43 offen offset:256 sc0 sc1
 v_add_u32 v5, 16384, v5
 s_add_u32 s45, s45, 8192
 s_branch L_b_dr1b
L_rare_F1:
 s_call_b64 s[40:41], L_resc_1
 s_branch L_back_F1
L_rare_F0:
 s_call_b64 s[40:41], L_resc_0
 s_branch L_back_F0
L_rare_L1:
 s_call_b64 s[40:41], L_resc_1
 s_branch L_back_L1
L_rare_L0:
 s_call_b64 s[40:41], L_resc_0
 s_branch L_back_L0
L_rare_T11:
 s_call_b64 s[40:41], L_resc_1
 s_branch L_back_T11
L_rare_T12:
 s_call_b64 s[40:41], L_resc_0
 s_branch L_back_T12
L_rare_T13:
 s_call_b64 s[40:41], L_resc_1
 s_branch L_back_T13
L_rare_T14:
 s_call_b64 s[40:41], L_resc_0
 s_branch L_back_T14
L_rare_T15:
 s_call_b64 s[40:41], L_resc_2
 s_branch L_back_T15
L_resc_0:
 s_nop 7
 s_nop 7
 v_max3_f32 v252, v60, v61, v62
 v_max3_f32 v252, v252, v63, v64
 v_max3_f32 v252, v252, v65, v66
 v_max_f32 v252, v252, v67
 v_mov_b32 v253, v252
 s_nop 1
 v_permlane16_swap_b32 v252, v253
 v_max_f32 v252, v252, v253
 v_mov_b32 v253, v252
 s_nop 1
 v_permlane32_swap_b32 v252, v253
 v_max_f32 v252, v252, v253
 v_max_f32 v252, 0, v252
 v_sub_f32 v254, 0, v252
 v_exp_f32 v254, v254
 v_add_f32 v6, v6, v252
 v_mul_f32 v10, v10, v254
 v_sub_f32 v20, v60, v252
 v_sub_f32 v21, v61, v252
 v_exp_f32 v20, v20
 v_exp_f32 v21, v21
 s_nop 0
 v_add_f32 v14, v20, v21
 v_cvt_pk_bf16_f32 v44, v20, v21
 v_sub_f32 v20, v62, v252
 v_sub_f32 v21, v63, v252
 v_exp_f32 v20, v20
 v_exp_f32 v21, v21
 s_nop 0
 v_add_f32 v14, v14, v20
 v_add_f32 v14, v14, v21
 v_cvt_pk_bf16_f32 v45, v20, v21
 v_sub_f32 v20, v64, v252
 v_sub_f32 v21, v65, v252
 v_exp_f32 v20, v20
 v_exp_f32 v21, v21
 s_nop 0
 v_add_f32 v14, v14, v20
 v_add_f32 v14, v14, v21
 v_cvt_pk_bf16_f32 v46, v20, v21
 v_sub_f32 v20, v66, v252
 v_sub_f32 v21, v67, v252
 v_exp_f32 v20, v20
 v_exp_f32 v21, v21
 s_nop 0
 v_add_f32 v14, v14, v20
 v_add_f32 v14, v14, v21
 v_cvt_pk_bf16_f32 v47, v20, v21
 v_mul_f32 v124, v124, v254
 v_mul_f32 v125, v125, v254
 v_mul_f32 v126, v126, v254
 v_mul_f32 v127, v127, v254
 v_mul_f32 v128, v128, v254
 v_mul_f32 v129, v129, v254
 v_mul_f32 v130, v130, v254
 v_mul_f32 v131, v131, v254
 v_mul_f32 v132, v132, v254
 v_mul_f32 v133, v133, v254
 v_mul_f32 v134, v134, v254
 v_mul_f32 v135, v135, v254
 v_mul_f32 v136, v136, v254
 v_mul_f32 v137, v137, v254
 v_mul_f32 v138, v138, v254
 v_mul_f32 v139, v139, v254
 v_mul_f32 v140, v140, v254
 v_mul_f32 v141, v141, v254
 v_mul_f32 v142, v142, v254
 v_mul_f32 v143, v143, v254
 v_mul_f32 v144, v144, v254
 v_mul_f32 v145, v145, v254
 v_mul_f32 v146, v146, v254
 v_mul_f32 v147, v147, v254
 v_mul_f32 v148, v148, v254
 v_mul_f32 v149, v149, v254
 v_mul_f32 v150, v150, v254
 v_mul_f32 v151, v151, v254
 v_mul_f32 v152, v152, v254
 v_mul_f32 v153, v153, v254
 v_mul_f32 v154, v154, v254
 v_mul_f32 v155, v155, v254
 v_mul_f32 v156, v156, v254
 v_mul_f32 v157, v157, v254
 v_mul_f32 v158, v158, v254
 v_mul_f32 v159, v159, v254
 v_mul_f32 v160, v160, v254
 v_mul_f32 v161, v161, v254
 v_mul_f32 v162, v162, v254
 v_mul_f32 v163, v163, v254
 v_mul_f32 v164, v164, v254
 v_mul_f32 v165, v165, v254
 v_mul_f32 v166, v166, v254
 v_mul_f32 v167, v167, v254
 v_mul_f32 v168, v168, v254
 v_mul_f32 v169, v169, v254
 v_mul_f32 v170, v170, v254
 v_mul_f32 v171, v171, v254
 v_mul_f32 v172, v172, v254
 v_mul_f32 v173, v173, v254
 v_mul_f32 v174, v174, v254
 v_mul_f32 v175, v175, v254
 v_mul_f32 v176, v176, v254
 v_mul_f32 v177, v177, v254
 v_mul_f32 v178, v178, v254
 v_mul_f32 v179, v179, v254
 v_mul_f32 v180, v180, v254
 v_mul_f32 v181, v181, v254
 v_mul_f32 v182, v182, v254
 v_mul_f32 v183, v183, v254
 v_mul_f32 v184, v184, v254
 v_mul_f32 v185, v185, v254
 v_mul_f32 v186, v186, v254
 v_mul_f32 v187, v187, v254
 v_max3_f32 v252, v68, v69, v70
 v_max3_f32 v252, v252, v71, v72
 v_max3_f32 v252, v252, v73, v74
 v_max_f32 v252, v252, v75
 v_mov_b32 v253, v252
 s_nop 1
 v_permlane16_swap_b32 v252, v253
 v_max_f32 v252, v252, v253
 v_mov_b32 v253, v252
 s_nop 1
 v_permlane32_swap_b32 v252, v253
 v_max_f32 v252, v252, v253
 v_max_f32 v252, 0, v252
 v_sub_f32 v254, 0, v252
 v_exp_f32 v254, v254
 v_add_f32 v7, v7, v252
 v_mul_f32 v11, v11, v254
 v_sub_f32 v20, v68, v252
 v_sub_f32 v21, v69, v252
 v_exp_f32 v20, v20
 v_exp_f32 v21, v21
 s_nop 0
 v_add_f32 v15, v20, v21
 v_cvt_pk_bf16_f32 v48, v20, v21
 v_sub_f32 v20, v70, v252
 v_sub_f32 v21, v71, v252
 v_exp_f32 v20, v20
 v_exp_f32 v21, v21
 s_nop 0
 v_add_f32 v15, v15, v20
 v_add_f32 v15, v15, v21
 v_cvt_pk_bf16_f32 v49, v20, v21
 v_sub_f32 v20, v72, v252
 v_sub_f32 v21, v73, v252
 v_exp_f32 v20, v20
 v_exp_f32 v21, v21
 s_nop 0
 v_add_f32 v15, v15, v20
 v_add_f32 v15, v15, v21
 v_cvt_pk_bf16_f32 v50, v20, v21
 v_sub_f32 v20, v74, v252
 v_sub_f32 v21, v75, v252
 v_exp_f32 v20, v20
 v_exp_f32 v21, v21
 s_nop 0
 v_add_f32 v15, v15, v20
 v_add_f32 v15, v15, v21
 v_cvt_pk_bf16_f32 v51, v20, v21
 v_mul_f32 v188, v188, v254
 v_mul_f32 v189, v189, v254
 v_mul_f32 v190, v190, v254
 v_mul_f32 v191, v191, v254
 v_mul_f32 v192, v192, v254
 v_mul_f32 v193, v193, v254
 v_mul_f32 v194, v194, v254
 v_mul_f32 v195, v195, v254
 v_mul_f32 v196, v196, v254
 v_mul_f32 v197, v197, v254
 v_mul_f32 v198, v198, v254
 v_mul_f32 v199, v199, v254
 v_mul_f32 v200, v200, v254
 v_mul_f32 v201, v201, v254
 v_mul_f32 v202, v202, v254
 v_mul_f32 v203, v203, v254
 v_mul_f32 v204, v204, v254
 v_mul_f32 v205, v205, v254
 v_mul_f32 v206, v206, v254
 v_mul_f32 v207, v207, v254
 v_mul_f32 v208, v208, v254
 v_mul_f32 v209, v209, v254
 v_mul_f32 v210, v210, v254
 v_mul_f32 v211, v211, v254
 v_mul_f32 v212, v212, v254
 v_mul_f32 v213, v213, v254
 v_mul_f32 v214, v214, v254
 v_mul_f32 v215, v215, v254
 v_mul_f32 v216, v216, v254
 v_mul_f32 v217, v217, v254
 v_mul_f32 v218, v218, v254
 v_mul_f32 v219, v219, v254
 v_mul_f32 v220, v220, v254
 v_mul_f32 v221, v221, v254
 v_mul_f32 v222, v222, v254
 v_mul_f32 v223, v223, v254
 v_mul_f32 v224, v224, v254
 v_mul_f32 v225, v225, v254
 v_mul_f32 v226, v226, v254
 v_mul_f32 v227, v227, v254
 v_mul_f32 v228, v228, v254
 v_mul_f32 v229, v229, v254
 v_mul_f32 v230, v230, v254
 v_mul_f32 v231, v231, v254
 v_mul_f32 v232, v232, v254
 v_mul_f32 v233, v233, v254
 v_mul_f32 v234, v234, v254
 v_mul_f32 v235, v235, v254
 v_mul_f32 v236, v236, v254
 v_mul_f32 v237, v237, v254
 v_mul_f32 v238, v238, v254
 v_mul_f32 v239, v239, v254
 v_mul_f32 v240, v240, v254
 v_mul_f32 v241, v241, v254
 v_mul_f32 v242, v242, v254
 v_mul_f32 v243, v243, v254
 v_mul_f32 v244, v244, v254
 v_mul_f32 v245, v245, v254
 v_mul_f32 v246, v246, v254
 v_mul_f32 v247, v247, v254
 v_mul_f32 v248, v248, v254
 v_mul_f32 v249, v249, v254
 v_mul_f32 v250, v250, v254
 v_mul_f32 v251, v251, v254
 v_max3_f32 v252, v76, v77, v78
 v_max3_f32 v252, v252, v79, v80
 v_max3_f32 v252, v252, v81, v82
 v_max_f32 v252, v252, v83
 v_mov_b32 v253, v252
 s_nop 1
 v_permlane16_swap_b32 v252, v253
 v_max_f32 v252, v252, v253
 v_mov_b32 v253, v252
 s_nop 1
 v_permlane32_swap_b32 v252, v253
 v_max_f32 v252, v252, v253
 v_max_f32 v252, 0, v252
 v_sub_f32 v254, 0, v252
 v_exp_f32 v254, v254
 v_add_f32 v8, v8, v252
 v_mul_f32 v12, v12, v254
 v_sub_f32 v20, v76, v252
 v_sub_f32 v21, v77, v252
 v_exp_f32 v20, v20
 v_exp_f32 v21, v21
 s_nop 0
 v_add_f32 v16, v20, v21
 v_cvt_pk_bf16_f32 v52, v20, v21
 v_sub_f32 v20, v78, v252
 v_sub_f32 v21, v79, v252
 v_exp_f32 v20, v20
 v_exp_f32 v21, v21
 s_nop 0
 v_add_f32 v16, v16, v20
 v_add_f32 v16, v16, v21
 v_cvt_pk_bf16_f32 v53, v20, v21
 v_sub_f32 v20, v80, v252
 v_sub_f32 v21, v81, v252
 v_exp_f32 v20, v20
 v_exp_f32 v21, v21
 s_nop 0
 v_add_f32 v16, v16, v20
 v_add_f32 v16, v16, v21
 v_cvt_pk_bf16_f32 v54, v20, v21
 v_sub_f32 v20, v82, v252
 v_sub_f32 v21, v83, v252
 v_exp_f32 v20, v20
 v_exp_f32 v21, v21
 s_nop 0
 v_add_f32 v16, v16, v20
 v_add_f32 v16, v16, v21
 v_cvt_pk_bf16_f32 v55, v20, v21
 v_accvgpr_read_b32 v20, a128
 v_accvgpr_read_b32 v21, a129
 v_accvgpr_read_b32 v22, a130
 v_accvgpr_read_b32 v23, a131
 v_accvgpr_read_b32 v24, a132
 v_accvgpr_read_b32 v25, a133
 v_accvgpr_read_b32 v26, a134
 v_accvgpr_read_b32 v27, a135
 v_mul_f32 v20, v20, v254
 v_mul_f32 v21, v21, v254
 v_mul_f32 v22, v22, v254
 v_mul_f32 v23, v23, v254
 v_mul_f32 v24, v24, v254
 v_mul_f32 v25, v25, v254
 v_mul_f32 v26, v26, v254
 v_mul_f32 v27, v27, v254
 v_accvgpr_write_b32 a128, v20
 v_accvgpr_write_b32 a129, v21
 v_accvgpr_write_b32 a130, v22
 v_accvgpr_write_b32 a131, v23
 v_accvgpr_write_b32 a132, v24
 v_accvgpr_write_b32 a133, v25
 v_accvgpr_write_b32 a134, v26
 v_accvgpr_write_b32 a135, v27
 v_accvgpr_read_b32 v20, a136
 v_accvgpr_read_b32 v21, a137
 v_accvgpr_read_b32 v22, a138
 v_accvgpr_read_b32 v23, a139
 v_accvgpr_read_b32 v24, a140
 v_accvgpr_read_b32 v25, a141
 v_accvgpr_read_b32 v26, a142
 v_accvgpr_read_b32 v27, a143
 v_mul_f32 v20, v20, v254
 v_mul_f32 v21, v21, v254
 v_mul_f32 v22, v22, v254
 v_mul_f32 v23, v23, v254
 v_mul_f32 v24, v24, v254
 v_mul_f32 v25, v25, v254
 v_mul_f32 v26, v26, v254
 v_mul_f32 v27, v27, v254
 v_accvgpr_write_b32 a136, v20
 v_accvgpr_write_b32 a137, v21
 v_accvgpr_write_b32 a138, v22
 v_accvgpr_write_b32 a139, v23
 v_accvgpr_write_b32 a140, v24
 v_accvgpr_write_b32 a141, v25
 v_accvgpr_write_b32 a142, v26
 v_accvgpr_write_b32 a143, v27
 v_accvgpr_read_b32 v20, a144
 v_accvgpr_read_b32 v21, a145
 v_accvgpr_read_b32 v22, a146
 v_accvgpr_read_b32 v23, a147
 v_accvgpr_read_b32 v24, a148
 v_accvgpr_read_b32 v25, a149
 v_accvgpr_read_b32 v26, a150
 v_accvgpr_read_b32 v27, a151
 v_mul_f32 v20, v20, v254
 v_mul_f32 v21, v21, v254
 v_mul_f32 v22, v22, v254
 v_mul_f32 v23, v23, v254
 v_mul_f32 v24, v24, v254
 v_mul_f32 v25, v25, v254
 v_mul_f32 v26, v26, v254
 v_mul_f32 v27, v27, v254
 v_accvgpr_write_b32 a144, v20
 v_accvgpr_write_b32 a145, v21
 v_accvgpr_write_b32 a146, v22
 v_accvgpr_write_b32 a147, v23
 v_accvgpr_write_b32 a148, v24
 v_accvgpr_write_b32 a149, v25
 v_accvgpr_write_b32 a150, v26
 v_accvgpr_write_b32 a151, v27
 v_accvgpr_read_b32 v20, a152
 v_accvgpr_read_b32 v21, a153
 v_accvgpr_read_b32 v22, a154
 v_accvgpr_read_b32 v23, a155
 v_accvgpr_read_b32 v24, a156
 v_accvgpr_read_b32 v25, a157
 v_accvgpr_read_b32 v26, a158
 v_accvgpr_read_b32 v27, a159
 v_mul_f32 v20, v20, v254
 v_mul_f32 v21, v21, v254
 v_mul_f32 v22, v22, v254
 v_mul_f32 v23, v23, v254
 v_mul_f32 v24, v24, v254
 v_mul_f32 v25, v25, v254
 v_mul_f32 v26, v26, v254
 v_mul_f32 v27, v27, v254
 v_accvgpr_write_b32 a152, v20
 v_accvgpr_write_b32 a153, v21
 v_accvgpr_write_b32 a154, v22
 v_accvgpr_write_b32 a155, v23
 v_accvgpr_write_b32 a156, v24
 v_accvgpr_write_b32 a157, v25
 v_accvgpr_write_b32 a158, v26
 v_accvgpr_write_b32 a159, v27
 v_accvgpr_read_b32 v20, a160
 v_accvgpr_read_b32 v21, a161
 v_accvgpr_read_b32 v22, a162
 v_accvgpr_read_b32 v23, a163
 v_accvgpr_read_b32 v24, a164
 v_accvgpr_read_b32 v25, a165
 v_accvgpr_read_b32 v26, a166
 v_accvgpr_read_b32 v27, a167
 v_mul_f32 v20, v20, v254
 v_mul_f32 v21, v21, v254
 v_mul_f32 v22, v22, v254
 v_mul_f32 v23, v23, v254
 v_mul_f32 v24, v24, v254
 v_mul_f32 v25, v25, v254
 v_mul_f32 v26, v26, v254
 v_mul_f32 v27, v27, v254
 v_accvgpr_write_b32 a160, v20
 v_accvgpr_write_b32 a161, v21
 v_accvgpr_write_b32 a162, v22
 v_accvgpr_write_b32 a163, v23
 v_accvgpr_write_b32 a164, v24
 v_accvgpr_write_b32 a165, v25
 v_accvgpr_write_b32 a166, v26
 v_accvgpr_write_b32 a167, v27
 v_accvgpr_read_b32 v20, a168
 v_accvgpr_read_b32 v21, a169
 v_accvgpr_read_b32 v22, a170
 v_accvgpr_read_b32 v23, a171
 v_accvgpr_read_b32 v24, a172
 v_accvgpr_read_b32 v25, a173
 v_accvgpr_read_b32 v26, a174
 v_accvgpr_read_b32 v27, a175
 v_mul_f32 v20, v20, v254
 v_mul_f32 v21, v21, v254
 v_mul_f32 v22, v22, v254
 v_mul_f32 v23, v23, v254
 v_mul_f32 v24, v24, v254
 v_mul_f32 v25, v25, v254
 v_mul_f32 v26, v26, v254
 v_mul_f32 v27, v27, v254
 v_accvgpr_write_b32 a168, v20
 v_accvgpr_write_b32 a169, v21
 v_accvgpr_write_b32 a170, v22
 v_accvgpr_write_b32 a171, v23
 v_accvgpr_write_b32 a172, v24
 v_accvgpr_write_b32 a173, v25
 v_accvgpr_write_b32 a174, v26
 v_accvgpr_write_b32 a175, v27
 v_accvgpr_read_b32 v20, a176
 v_accvgpr_read_b32 v21, a177
 v_accvgpr_read_b32 v22, a178
 v_accvgpr_read_b32 v23, a179
 v_accvgpr_read_b32 v24, a180
 v_accvgpr_read_b32 v25, a181
 v_accvgpr_read_b32 v26, a182
 v_accvgpr_read_b32 v27, a183
 v_mul_f32 v20, v20, v254
 v_mul_f32 v21, v21, v254
 v_mul_f32 v22, v22, v254
 v_mul_f32 v23, v23, v254
 v_mul_f32 v24, v24, v254
 v_mul_f32 v25, v25, v254
 v_mul_f32 v26, v26, v254
 v_mul_f32 v27, v27, v254
 v_accvgpr_write_b32 a176, v20
 v_accvgpr_write_b32 a177, v21
 v_accvgpr_write_b32 a178, v22
 v_accvgpr_write_b32 a179, v23
 v_accvgpr_write_b32 a180, v24
 v_accvgpr_write_b32 a181, v25
 v_accvgpr_write_b32 a182, v26
 v_accvgpr_write_b32 a183, v27
 v_accvgpr_read_b32 v20, a184
 v_accvgpr_read_b32 v21, a185
 v_accvgpr_read_b32 v22, a186
 v_accvgpr_read_b32 v23, a187
 v_accvgpr_read_b32 v24, a188
 v_accvgpr_read_b32 v25, a189
 v_accvgpr_read_b32 v26, a190
 v_accvgpr_read_b32 v27, a191
 v_mul_f32 v20, v20, v254
 v_mul_f32 v21, v21, v254
 v_mul_f32 v22, v22, v254
 v_mul_f32 v23, v23, v254
 v_mul_f32 v24, v24, v254
 v_mul_f32 v25, v25, v254
 v_mul_f32 v26, v26, v254
 v_mul_f32 v27, v27, v254
 v_accvgpr_write_b32 a184, v20
 v_accvgpr_write_b32 a185, v21
 v_accvgpr_write_b32 a186, v22
 v_accvgpr_write_b32 a187, v23
 v_accvgpr_write_b32 a188, v24
 v_accvgpr_write_b32 a189, v25
 v_accvgpr_write_b32 a190, v26
 v_accvgpr_write_b32 a191, v27
 v_max3_f32 v252, v84, v85, v86
 v_max3_f32 v252, v252, v87, v88
 v_max3_f32 v252, v252, v89, v90
 v_max_f32 v252, v252, v91
 v_mov_b32 v253, v252
 s_nop 1
 v_permlane16_swap_b32 v252, v253
 v_max_f32 v252, v252, v253
 v_mov_b32 v253, v252
 s_nop 1
 v_permlane32_swap_b32 v252, v253
 v_max_f32 v252, v252, v253
 v_max_f32 v252, 0, v252
 v_sub_f32 v254, 0, v252
 v_exp_f32 v254, v254
 v_add_f32 v9, v9, v252
 v_mul_f32 v13, v13, v254
 v_sub_f32 v20, v84, v252
 v_sub_f32 v21, v85, v252
 v_exp_f32 v20, v20
 v_exp_f32 v21, v21
 s_nop 0
 v_add_f32 v17, v20, v21
 v_cvt_pk_bf16_f32 v56, v20, v21
 v_sub_f32 v20, v86, v252
 v_sub_f32 v21, v87, v252
 v_exp_f32 v20, v20
 v_exp_f32 v21, v21
 s_nop 0
 v_add_f32 v17, v17, v20
 v_add_f32 v17, v17, v21
 v_cvt_pk_bf16_f32 v57, v20, v21
 v_sub_f32 v20, v88, v252
 v_sub_f32 v21, v89, v252
 v_exp_f32 v20, v20
 v_exp_f32 v21, v21
 s_nop 0
 v_add_f32 v17, v17, v20
 v_add_f32 v17, v17, v21
 v_cvt_pk_bf16_f32 v58, v20, v21
 v_sub_f32 v20, v90, v252
 v_sub_f32 v21, v91, v252
 v_exp_f32 v20, v20
 v_exp_f32 v21, v21
 s_nop 0
 v_add_f32 v17, v17, v20
 v_add_f32 v17, v17, v21
 v_cvt_pk_bf16_f32 v59, v20, v21
 v_accvgpr_read_b32 v20, a192
 v_accvgpr_read_b32 v21, a193
 v_accvgpr_read_b32 v22, a194
 v_accvgpr_read_b32 v23, a195
 v_accvgpr_read_b32 v24, a196
 v_accvgpr_read_b32 v25, a197
 v_accvgpr_read_b32 v26, a198
 v_accvgpr_read_b32 v27, a199
 v_mul_f32 v20, v20, v254
 v_mul_f32 v21, v21, v254
 v_mul_f32 v22, v22, v254
 v_mul_f32 v23, v23, v254
 v_mul_f32 v24, v24, v254
 v_mul_f32 v25, v25, v254
 v_mul_f32 v26, v26, v254
 v_mul_f32 v27, v27, v254
 v_accvgpr_write_b32 a192, v20
 v_accvgpr_write_b32 a193, v21
 v_accvgpr_write_b32 a194, v22
 v_accvgpr_write_b32 a195, v23
 v_accvgpr_write_b32 a196, v24
 v_accvgpr_write_b32 a197, v25
 v_accvgpr_write_b32 a198, v26
 v_accvgpr_write_b32 a199, v27
 v_accvgpr_read_b32 v20, a200
 v_accvgpr_read_b32 v21, a201
 v_accvgpr_read_b32 v22, a202
 v_accvgpr_read_b32 v23, a203
 v_accvgpr_read_b32 v24, a204
 v_accvgpr_read_b32 v25, a205
 v_accvgpr_read_b32 v26, a206
 v_accvgpr_read_b32 v27, a207
 v_mul_f32 v20, v20, v254
 v_mul_f32 v21, v21, v254
 v_mul_f32 v22, v22, v254
 v_mul_f32 v23, v23, v254
 v_mul_f32 v24, v24, v254
 v_mul_f32 v25, v25, v254
 v_mul_f32 v26, v26, v254
 v_mul_f32 v27, v27, v254
 v_accvgpr_write_b32 a200, v20
 v_accvgpr_write_b32 a201, v21
 v_accvgpr_write_b32 a202, v22
 v_accvgpr_write_b32 a203, v23
 v_accvgpr_write_b32 a204, v24
 v_accvgpr_write_b32 a205, v25
 v_accvgpr_write_b32 a206, v26
 v_accvgpr_write_b32 a207, v27
 v_accvgpr_read_b32 v20, a208
 v_accvgpr_read_b32 v21, a209
 v_accvgpr_read_b32 v22, a210
 v_accvgpr_read_b32 v23, a211
 v_accvgpr_read_b32 v24, a212
 v_accvgpr_read_b32 v25, a213
 v_accvgpr_read_b32 v26, a214
 v_accvgpr_read_b32 v27, a215
 v_mul_f32 v20, v20, v254
 v_mul_f32 v21, v21, v254
 v_mul_f32 v22, v22, v254
 v_mul_f32 v23, v23, v254
 v_mul_f32 v24, v24, v254
 v_mul_f32 v25, v25, v254
 v_mul_f32 v26, v26, v254
 v_mul_f32 v27, v27, v254
 v_accvgpr_write_b32 a208, v20
 v_accvgpr_write_b32 a209, v21
 v_accvgpr_write_b32 a210, v22
 v_accvgpr_write_b32 a211, v23
 v_accvgpr_write_b32 a212, v24
 v_accvgpr_write_b32 a213, v25
 v_accvgpr_write_b32 a214, v26
 v_accvgpr_write_b32 a215, v27
 v_accvgpr_read_b32 v20, a216
 v_accvgpr_read_b32 v21, a217
 v_accvgpr_read_b32 v22, a218
 v_accvgpr_read_b32 v23, a219
 v_accvgpr_read_b32 v24, a220
 v_accvgpr_read_b32 v25, a221
 v_accvgpr_read_b32 v26, a222
 v_accvgpr_read_b32 v27, a223
 v_mul_f32 v20, v20, v254
 v_mul_f32 v21, v21, v254
 v_mul_f32 v22, v22, v254
 v_mul_f32 v23, v23, v254
 v_mul_f32 v24, v24, v254
 v_mul_f32 v25, v25, v254
 v_mul_f32 v26, v26, v254
 v_mul_f32 v27, v27, v254
 v_accvgpr_write_b32 a216, v20
 v_accvgpr_write_b32 a217, v21
 v_accvgpr_write_b32 a218, v22
 v_accvgpr_write_b32 a219, v23
 v_accvgpr_write_b32 a220, v24
 v_accvgpr_write_b32 a221, v25
 v_accvgpr_write_b32 a222, v26
 v_accvgpr_write_b32 a223, v27
 v_accvgpr_read_b32 v20, a224
 v_accvgpr_read_b32 v21, a225
 v_accvgpr_read_b32 v22, a226
 v_accvgpr_read_b32 v23, a227
 v_accvgpr_read_b32 v24, a228
 v_accvgpr_read_b32 v25, a229
 v_accvgpr_read_b32 v26, a230
 v_accvgpr_read_b32 v27, a231
 v_mul_f32 v20, v20, v254
 v_mul_f32 v21, v21, v254
 v_mul_f32 v22, v22, v254
 v_mul_f32 v23, v23, v254
 v_mul_f32 v24, v24, v254
 v_mul_f32 v25, v25, v254
 v_mul_f32 v26, v26, v254
 v_mul_f32 v27, v27, v254
 v_accvgpr_write_b32 a224, v20
 v_accvgpr_write_b32 a225, v21
 v_accvgpr_write_b32 a226, v22
 v_accvgpr_write_b32 a227, v23
 v_accvgpr_write_b32 a228, v24
 v_accvgpr_write_b32 a229, v25
 v_accvgpr_write_b32 a230, v26
 v_accvgpr_write_b32 a231, v27
 v_accvgpr_read_b32 v20, a232
 v_accvgpr_read_b32 v21, a233
 v_accvgpr_read_b32 v22, a234
 v_accvgpr_read_b32 v23, a235
 v_accvgpr_read_b32 v24, a236
 v_accvgpr_read_b32 v25, a237
 v_accvgpr_read_b32 v26, a238
 v_accvgpr_read_b32 v27, a239
 v_mul_f32 v20, v20, v254
 v_mul_f32 v21, v21, v254
 v_mul_f32 v22, v22, v254
 v_mul_f32 v23, v23, v254
 v_mul_f32 v24, v24, v254
 v_mul_f32 v25, v25, v254
 v_mul_f32 v26, v26, v254
 v_mul_f32 v27, v27, v254
 v_accvgpr_write_b32 a232, v20
 v_accvgpr_write_b32 a233, v21
 v_accvgpr_write_b32 a234, v22
 v_accvgpr_write_b32 a235, v23
 v_accvgpr_write_b32 a236, v24
 v_accvgpr_write_b32 a237, v25
 v_accvgpr_write_b32 a238, v26
 v_accvgpr_write_b32 a239, v27
 v_accvgpr_read_b32 v20, a240
 v_accvgpr_read_b32 v21, a241
 v_accvgpr_read_b32 v22, a242
 v_accvgpr_read_b32 v23, a243
 v_accvgpr_read_b32 v24, a244
 v_accvgpr_read_b32 v25, a245
 v_accvgpr_read_b32 v26, a246
 v_accvgpr_read_b32 v27, a247
 v_mul_f32 v20, v20, v254
 v_mul_f32 v21, v21, v254
 v_mul_f32 v22, v22, v254
 v_mul_f32 v23, v23, v254
 v_mul_f32 v24, v24, v254
 v_mul_f32 v25, v25, v254
 v_mul_f32 v26, v26, v254
 v_mul_f32 v27, v27, v254
 v_accvgpr_write_b32 a240, v20
 v_accvgpr_write_b32 a241, v21
 v_accvgpr_write_b32 a242, v22
 v_accvgpr_write_b32 a243, v23
 v_accvgpr_write_b32 a244, v24
 v_accvgpr_write_b32 a245, v25
 v_accvgpr_write_b32 a246, v26
 v_accvgpr_write_b32 a247, v27
 v_accvgpr_read_b32 v20, a248
 v_accvgpr_read_b32 v21, a249
 v_accvgpr_read_b32 v22, a250
 v_accvgpr_read_b32 v23, a251
 v_accvgpr_read_b32 v24, a252
 v_accvgpr_read_b32 v25, a253
 v_accvgpr_read_b32 v26, a254
 v_accvgpr_read_b32 v27, a255
 v_mul_f32 v20, v20, v254
 v_mul_f32 v21, v21, v254
 v_mul_f32 v22, v22, v254
 v_mul_f32 v23, v23, v254
 v_mul_f32 v24, v24, v254
 v_mul_f32 v25, v25, v254
 v_mul_f32 v26, v26, v254
 v_mul_f32 v27, v27, v254
 v_accvgpr_write_b32 a248, v20
 v_accvgpr_write_b32 a249, v21
 v_accvgpr_write_b32 a250, v22
 v_accvgpr_write_b32 a251, v23
 v_accvgpr_write_b32 a252, v24
 v_accvgpr_write_b32 a253, v25
 v_accvgpr_write_b32 a254, v26
 v_accvgpr_write_b32 a255, v27
 s_nop 3
 s_setpc_b64 s[40:41]
L_resc_1:
 s_nop 7
 s_nop 7
 v_max3_f32 v252, v92, v93, v94
 v_max3_f32 v252, v252, v95, v96
 v_max3_f32 v252, v252, v97, v98
 v_max_f32 v252, v252, v99
 v_mov_b32 v253, v252
 s_nop 1
 v_permlane16_swap_b32 v252, v253
 v_max_f32 v252, v252, v253
 v_mov_b32 v253, v252
 s_nop 1
 v_permlane32_swap_b32 v252, v253
 v_max_f32 v252, v252, v253
 v_max_f32 v252, 0, v252
 v_sub_f32 v254, 0, v252
 v_exp_f32 v254, v254
 v_add_f32 v6, v6, v252
 v_mul_f32 v10, v10, v254
 v_sub_f32 v20, v92, v252
 v_sub_f32 v21, v93, v252
 v_exp_f32 v20, v20
 v_exp_f32 v21, v21
 s_nop 0
 v_add_f32 v14, v20, v21
 v_cvt_pk_bf16_f32 v44, v20, v21
 v_sub_f32 v20, v94, v252
 v_sub_f32 v21, v95, v252
 v_exp_f32 v20, v20
 v_exp_f32 v21, v21
 s_nop 0
 v_add_f32 v14, v14, v20
 v_add_f32 v14, v14, v21
 v_cvt_pk_bf16_f32 v45, v20, v21
 v_sub_f32 v20, v96, v252
 v_sub_f32 v21, v97, v252
 v_exp_f32 v20, v20
 v_exp_f32 v21, v21
 s_nop 0
 v_add_f32 v14, v14, v20
 v_add_f32 v14, v14, v21
 v_cvt_pk_bf16_f32 v46, v20, v21
 v_sub_f32 v20, v98, v252
 v_sub_f32 v21, v99, v252
 v_exp_f32 v20, v20
 v_exp_f32 v21, v21
 s_nop 0
 v_add_f32 v14, v14, v20
 v_add_f32 v14, v14, v21
 v_cvt_pk_bf16_f32 v47, v20, v21
 v_mul_f32 v124, v124, v254
 v_mul_f32 v125, v125, v254
 v_mul_f32 v126, v126, v254
 v_mul_f32 v127, v127, v254
 v_mul_f32 v128, v128, v254
 v_mul_f32 v129, v129, v254
 v_mul_f32 v130, v130, v254
 v_mul_f32 v131, v131, v254
 v_mul_f32 v132, v132, v254
 v_mul_f32 v133, v133, v254
 v_mul_f32 v134, v134, v254
 v_mul_f32 v135, v135, v254
 v_mul_f32 v136, v136, v254
 v_mul_f32 v137, v137, v254
 v_mul_f32 v138, v138, v254
 v_mul_f32 v139, v139, v254
 v_mul_f32 v140, v140, v254
 v_mul_f32 v141, v141, v254
 v_mul_f32 v142, v142, v254
 v_mul_f32 v143, v143, v254
 v_mul_f32 v144, v144, v254
 v_mul_f32 v145, v145, v254
 v_mul_f32 v146, v146, v254
 v_mul_f32 v147, v147, v254
 v_mul_f32 v148, v148, v254
 v_mul_f32 v149, v149, v254
 v_mul_f32 v150, v150, v254
 v_mul_f32 v151, v151, v254
 v_mul_f32 v152, v152, v254
 v_mul_f32 v153, v153, v254
 v_mul_f32 v154, v154, v254
 v_mul_f32 v155, v155, v254
 v_mul_f32 v156, v156, v254
 v_mul_f32 v157, v157, v254
 v_mul_f32 v158, v158, v254
 v_mul_f32 v159, v159, v254
 v_mul_f32 v160, v160, v254
 v_mul_f32 v161, v161, v254
 v_mul_f32 v162, v162, v254
 v_mul_f32 v163, v163, v254
 v_mul_f32 v164, v164, v254
 v_mul_f32 v165, v165, v254
 v_mul_f32 v166, v166, v254
 v_mul_f32 v167, v167, v254
 v_mul_f32 v168, v168, v254
 v_mul_f32 v169, v169, v254
 v_mul_f32 v170, v170, v254
 v_mul_f32 v171, v171, v254
 v_mul_f32 v172, v172, v254
 v_mul_f32 v173, v173, v254
 v_mul_f32 v174, v174, v254
 v_mul_f32 v175, v175, v254
 v_mul_f32 v176, v176, v254
 v_mul_f32 v177, v177, v254
 v_mul_f32 v178, v178, v254
 v_mul_f32 v179, v179, v254
 v_mul_f32 v180, v180, v254
 v_mul_f32 v181, v181, v254
 v_mul_f32 v182, v182, v254
 v_mul_f32 v183, v183, v254
 v_mul_f32 v184, v184, v254
 v_mul_f32 v185, v185, v254
 v_mul_f32 v186, v186, v254
 v_mul_f32 v187, v187, v254
 v_max3_f32 v252, v100, v101, v102
 v_max3_f32 v252, v252, v103, v104
 v_max3_f32 v252, v252, v105, v106
 v_max_f32 v252, v252, v107
 v_mov_b32 v253, v252
 s_nop 1
 v_permlane16_swap_b32 v252, v253
 v_max_f32 v252, v252, v253
 v_mov_b32 v253, v252
 s_nop 1
 v_permlane32_swap_b32 v252, v253
 v_max_f32 v252, v252, v253
 v_max_f32 v252, 0, v252
 v_sub_f32 v254, 0, v252
 v_exp_f32 v254, v254
 v_add_f32 v7, v7, v252
 v_mul_f32 v11, v11, v254
 v_sub_f32 v20, v100, v252
 v_sub_f32 v21, v101, v252
 v_exp_f32 v20, v20
 v_exp_f32 v21, v21
 s_nop 0
 v_add_f32 v15, v20, v21
 v_cvt_pk_bf16_f32 v48, v20, v21
 v_sub_f32 v20, v102, v252
 v_sub_f32 v21, v103, v252
 v_exp_f32 v20, v20
 v_exp_f32 v21, v21
 s_nop 0
 v_add_f32 v15, v15, v20
 v_add_f32 v15, v15, v21
 v_cvt_pk_bf16_f32 v49, v20, v21
 v_sub_f32 v20, v104, v252
 v_sub_f32 v21, v105, v252
 v_exp_f32 v20, v20
 v_exp_f32 v21, v21
 s_nop 0
 v_add_f32 v15, v15, v20
 v_add_f32 v15, v15, v21
 v_cvt_pk_bf16_f32 v50, v20, v21
 v_sub_f32 v20, v106, v252
 v_sub_f32 v21, v107, v252
 v_exp_f32 v20, v20
 v_exp_f32 v21, v21
 s_nop 0
 v_add_f32 v15, v15, v20
 v_add_f32 v15, v15, v21
 v_cvt_pk_bf16_f32 v51, v20, v21
 v_mul_f32 v188, v188, v254
 v_mul_f32 v189, v189, v254
 v_mul_f32 v190, v190, v254
 v_mul_f32 v191, v191, v254
 v_mul_f32 v192, v192, v254
 v_mul_f32 v193, v193, v254
 v_mul_f32 v194, v194, v254
 v_mul_f32 v195, v195, v254
 v_mul_f32 v196, v196, v254
 v_mul_f32 v197, v197, v254
 v_mul_f32 v198, v198, v254
 v_mul_f32 v199, v199, v254
 v_mul_f32 v200, v200, v254
 v_mul_f32 v201, v201, v254
 v_mul_f32 v202, v202, v254
 v_mul_f32 v203, v203, v254
 v_mul_f32 v204, v204, v254
 v_mul_f32 v205, v205, v254
 v_mul_f32 v206, v206, v254
 v_mul_f32 v207, v207, v254
 v_mul_f32 v208, v208, v254
 v_mul_f32 v209, v209, v254
 v_mul_f32 v210, v210, v254
 v_mul_f32 v211, v211, v254
 v_mul_f32 v212, v212, v254
 v_mul_f32 v213, v213, v254
 v_mul_f32 v214, v214, v254
 v_mul_f32 v215, v215, v254
 v_mul_f32 v216, v216, v254
 v_mul_f32 v217, v217, v254
 v_mul_f32 v218, v218, v254
 v_mul_f32 v219, v219, v254
 v_mul_f32 v220, v220, v254
 v_mul_f32 v221, v221, v254
 v_mul_f32 v222, v222, v254
 v_mul_f32 v223, v223, v254
 v_mul_f32 v224, v224, v254
 v_mul_f32 v225, v225, v254
 v_mul_f32 v226, v226, v254
 v_mul_f32 v227, v227, v254
 v_mul_f32 v228, v228, v254
 v_mul_f32 v229, v229, v254
 v_mul_f32 v230, v230, v254
 v_mul_f32 v231, v231, v254
 v_mul_f32 v232, v232, v254
 v_mul_f32 v233, v233, v254
 v_mul_f32 v234, v234, v254
 v_mul_f32 v235, v235, v254
 v_mul_f32 v236, v236, v254
 v_mul_f32 v237, v237, v254
 v_mul_f32 v238, v238, v254
 v_mul_f32 v239, v239, v254
 v_mul_f32 v240, v240, v254
 v_mul_f32 v241, v241, v254
 v_mul_f32 v242, v242, v254
 v_mul_f32 v243, v243, v254
 v_mul_f32 v244, v244, v254
 v_mul_f32 v245, v245, v254
 v_mul_f32 v246, v246, v254
 v_mul_f32 v247, v247, v254
 v_mul_f32 v248, v248, v254
 v_mul_f32 v249, v249, v254
 v_mul_f32 v250, v250, v254
 v_mul_f32 v251, v251, v254
 v_max3_f32 v252, v108, v109, v110
 v_max3_f32 v252, v252, v111, v112
 v_max3_f32 v252, v252, v113, v114
 v_max_f32 v252, v252, v115
 v_mov_b32 v253, v252
 s_nop 1
 v_permlane16_swap_b32 v252, v253
 v_max_f32 v252, v252, v253
 v_mov_b32 v253, v252
 s_nop 1
 v_permlane32_swap_b32 v252, v253
 v_max_f32 v252, v252, v253
 v_max_f32 v252, 0, v252
 v_sub_f32 v254, 0, v252
 v_exp_f32 v254, v254
 v_add_f32 v8, v8, v252
 v_mul_f32 v12, v12, v254
 v_sub_f32 v20, v108, v252
 v_sub_f32 v21, v109, v252
 v_exp_f32 v20, v20
 v_exp_f32 v21, v21
 s_nop 0
 v_add_f32 v16, v20, v21
 v_cvt_pk_bf16_f32 v52, v20, v21
 v_sub_f32 v20, v110, v252
 v_sub_f32 v21, v111, v252
 v_exp_f32 v20, v20
 v_exp_f32 v21, v21
 s_nop 0
 v_add_f32 v16, v16, v20
 v_add_f32 v16, v16, v21
 v_cvt_pk_bf16_f32 v53, v20, v21
 v_sub_f32 v20, v112, v252
 v_sub_f32 v21, v113, v252
 v_exp_f32 v20, v20
 v_exp_f32 v21, v21
 s_nop 0
 v_add_f32 v16, v16, v20
 v_add_f32 v16, v16, v21
 v_cvt_pk_bf16_f32 v54, v20, v21
 v_sub_f32 v20, v114, v252
 v_sub_f32 v21, v115, v252
 v_exp_f32 v20, v20
 v_exp_f32 v21, v21
 s_nop 0
 v_add_f32 v16, v16, v20
 v_add_f32 v16, v16, v21
 v_cvt_pk_bf16_f32 v55, v20, v21
 v_accvgpr_read_b32 v20, a128
 v_accvgpr_read_b32 v21, a129
 v_accvgpr_read_b32 v22, a130
 v_accvgpr_read_b32 v23, a131
 v_accvgpr_read_b32 v24, a132
 v_accvgpr_read_b32 v25, a133
 v_accvgpr_read_b32 v26, a134
 v_accvgpr_read_b32 v27, a135
 v_mul_f32 v20, v20, v254
 v_mul_f32 v21, v21, v254
 v_mul_f32 v22, v22, v254
 v_mul_f32 v23, v23, v254
 v_mul_f32 v24, v24, v254
 v_mul_f32 v25, v25, v254
 v_mul_f32 v26, v26, v254
 v_mul_f32 v27, v27, v254
 v_accvgpr_write_b32 a128, v20
 v_accvgpr_write_b32 a129, v21
 v_accvgpr_write_b32 a130, v22
 v_accvgpr_write_b32 a131, v23
 v_accvgpr_write_b32 a132, v24
 v_accvgpr_write_b32 a133, v25
 v_accvgpr_write_b32 a134, v26
 v_accvgpr_write_b32 a135, v27
 v_accvgpr_read_b32 v20, a136
 v_accvgpr_read_b32 v21, a137
 v_accvgpr_read_b32 v22, a138
 v_accvgpr_read_b32 v23, a139
 v_accvgpr_read_b32 v24, a140
 v_accvgpr_read_b32 v25, a141
 v_accvgpr_read_b32 v26, a142
 v_accvgpr_read_b32 v27, a143
 v_mul_f32 v20, v20, v254
 v_mul_f32 v21, v21, v254
 v_mul_f32 v22, v22, v254
 v_mul_f32 v23, v23, v254
 v_mul_f32 v24, v24, v254
 v_mul_f32 v25, v25, v254
 v_mul_f32 v26, v26, v254
 v_mul_f32 v27, v27, v254
 v_accvgpr_write_b32 a136, v20
 v_accvgpr_write_b32 a137, v21
 v_accvgpr_write_b32 a138, v22
 v_accvgpr_write_b32 a139, v23
 v_accvgpr_write_b32 a140, v24
 v_accvgpr_write_b32 a141, v25
 v_accvgpr_write_b32 a142, v26
 v_accvgpr_write_b32 a143, v27
 v_accvgpr_read_b32 v20, a144
 v_accvgpr_read_b32 v21, a145
 v_accvgpr_read_b32 v22, a146
 v_accvgpr_read_b32 v23, a147
 v_accvgpr_read_b32 v24, a148
 v_accvgpr_read_b32 v25, a149
 v_accvgpr_read_b32 v26, a150
 v_accvgpr_read_b32 v27, a151
 v_mul_f32 v20, v20, v254
 v_mul_f32 v21, v21, v254
 v_mul_f32 v22, v22, v254
 v_mul_f32 v23, v23, v254
 v_mul_f32 v24, v24, v254
 v_mul_f32 v25, v25, v254
 v_mul_f32 v26, v26, v254
 v_mul_f32 v27, v27, v254
 v_accvgpr_write_b32 a144, v20
 v_accvgpr_write_b32 a145, v21
 v_accvgpr_write_b32 a146, v22
 v_accvgpr_write_b32 a147, v23
 v_accvgpr_write_b32 a148, v24
 v_accvgpr_write_b32 a149, v25
 v_accvgpr_write_b32 a150, v26
 v_accvgpr_write_b32 a151, v27
 v_accvgpr_read_b32 v20, a152
 v_accvgpr_read_b32 v21, a153
 v_accvgpr_read_b32 v22, a154
 v_accvgpr_read_b32 v23, a155
 v_accvgpr_read_b32 v24, a156
 v_accvgpr_read_b32 v25, a157
 v_accvgpr_read_b32 v26, a158
 v_accvgpr_read_b32 v27, a159
 v_mul_f32 v20, v20, v254
 v_mul_f32 v21, v21, v254
 v_mul_f32 v22, v22, v254
 v_mul_f32 v23, v23, v254
 v_mul_f32 v24, v24, v254
 v_mul_f32 v25, v25, v254
 v_mul_f32 v26, v26, v254
 v_mul_f32 v27, v27, v254
 v_accvgpr_write_b32 a152, v20
 v_accvgpr_write_b32 a153, v21
 v_accvgpr_write_b32 a154, v22
 v_accvgpr_write_b32 a155, v23
 v_accvgpr_write_b32 a156, v24
 v_accvgpr_write_b32 a157, v25
 v_accvgpr_write_b32 a158, v26
 v_accvgpr_write_b32 a159, v27
 v_accvgpr_read_b32 v20, a160
 v_accvgpr_read_b32 v21, a161
 v_accvgpr_read_b32 v22, a162
 v_accvgpr_read_b32 v23, a163
 v_accvgpr_read_b32 v24, a164
 v_accvgpr_read_b32 v25, a165
 v_accvgpr_read_b32 v26, a166
 v_accvgpr_read_b32 v27, a167
 v_mul_f32 v20, v20, v254
 v_mul_f32 v21, v21, v254
 v_mul_f32 v22, v22, v254
 v_mul_f32 v23, v23, v254
 v_mul_f32 v24, v24, v254
 v_mul_f32 v25, v25, v254
 v_mul_f32 v26, v26, v254
 v_mul_f32 v27, v27, v254
 v_accvgpr_write_b32 a160, v20
 v_accvgpr_write_b32 a161, v21
 v_accvgpr_write_b32 a162, v22
 v_accvgpr_write_b32 a163, v23
 v_accvgpr_write_b32 a164, v24
 v_accvgpr_write_b32 a165, v25
 v_accvgpr_write_b32 a166, v26
 v_accvgpr_write_b32 a167, v27
 v_accvgpr_read_b32 v20, a168
 v_accvgpr_read_b32 v21, a169
 v_accvgpr_read_b32 v22, a170
 v_accvgpr_read_b32 v23, a171
 v_accvgpr_read_b32 v24, a172
 v_accvgpr_read_b32 v25, a173
 v_accvgpr_read_b32 v26, a174
 v_accvgpr_read_b32 v27, a175
 v_mul_f32 v20, v20, v254
 v_mul_f32 v21, v21, v254
 v_mul_f32 v22, v22, v254
 v_mul_f32 v23, v23, v254
 v_mul_f32 v24, v24, v254
 v_mul_f32 v25, v25, v254
 v_mul_f32 v26, v26, v254
 v_mul_f32 v27, v27, v254
 v_accvgpr_write_b32 a168, v20
 v_accvgpr_write_b32 a169, v21
 v_accvgpr_write_b32 a170, v22
 v_accvgpr_write_b32 a171, v23
 v_accvgpr_write_b32 a172, v24
 v_accvgpr_write_b32 a173, v25
 v_accvgpr_write_b32 a174, v26
 v_accvgpr_write_b32 a175, v27
 v_accvgpr_read_b32 v20, a176
 v_accvgpr_read_b32 v21, a177
 v_accvgpr_read_b32 v22, a178
 v_accvgpr_read_b32 v23, a179
 v_accvgpr_read_b32 v24, a180
 v_accvgpr_read_b32 v25, a181
 v_accvgpr_read_b32 v26, a182
 v_accvgpr_read_b32 v27, a183
 v_mul_f32 v20, v20, v254
 v_mul_f32 v21, v21, v254
 v_mul_f32 v22, v22, v254
 v_mul_f32 v23, v23, v254
 v_mul_f32 v24, v24, v254
 v_mul_f32 v25, v25, v254
 v_mul_f32 v26, v26, v254
 v_mul_f32 v27, v27, v254
 v_accvgpr_write_b32 a176, v20
 v_accvgpr_write_b32 a177, v21
 v_accvgpr_write_b32 a178, v22
 v_accvgpr_write_b32 a179, v23
 v_accvgpr_write_b32 a180, v24
 v_accvgpr_write_b32 a181, v25
 v_accvgpr_write_b32 a182, v26
 v_accvgpr_write_b32 a183, v27
 v_accvgpr_read_b32 v20, a184
 v_accvgpr_read_b32 v21, a185
 v_accvgpr_read_b32 v22, a186
 v_accvgpr_read_b32 v23, a187
 v_accvgpr_read_b32 v24, a188
 v_accvgpr_read_b32 v25, a189
 v_accvgpr_read_b32 v26, a190
 v_accvgpr_read_b32 v27, a191
 v_mul_f32 v20, v20, v254
 v_mul_f32 v21, v21, v254
 v_mul_f32 v22, v22, v254
 v_mul_f32 v23, v23, v254
 v_mul_f32 v24, v24, v254
 v_mul_f32 v25, v25, v254
 v_mul_f32 v26, v26, v254
 v_mul_f32 v27, v27, v254
 v_accvgpr_write_b32 a184, v20
 v_accvgpr_write_b32 a185, v21
 v_accvgpr_write_b32 a186, v22
 v_accvgpr_write_b32 a187, v23
 v_accvgpr_write_b32 a188, v24
 v_accvgpr_write_b32 a189, v25
 v_accvgpr_write_b32 a190, v26
 v_accvgpr_write_b32 a191, v27
 v_max3_f32 v252, v116, v117, v118
 v_max3_f32 v252, v252, v119, v120
 v_max3_f32 v252, v252, v121, v122
 v_max_f32 v252, v252, v123
 v_mov_b32 v253, v252
 s_nop 1
 v_permlane16_swap_b32 v252, v253
 v_max_f32 v252, v252, v253
 v_mov_b32 v253, v252
 s_nop 1
 v_permlane32_swap_b32 v252, v253
 v_max_f32 v252, v252, v253
 v_max_f32 v252, 0, v252
 v_sub_f32 v254, 0, v252
 v_exp_f32 v254, v254
 v_add_f32 v9, v9, v252
 v_mul_f32 v13, v13, v254
 v_sub_f32 v20, v116, v252
 v_sub_f32 v21, v117, v252
 v_exp_f32 v20, v20
 v_exp_f32 v21, v21
 s_nop 0
 v_add_f32 v17, v20, v21
 v_cvt_pk_bf16_f32 v56, v20, v21
 v_sub_f32 v20, v118, v252
 v_sub_f32 v21, v119, v252
 v_exp_f32 v20, v20
 v_exp_f32 v21, v21
 s_nop 0
 v_add_f32 v17, v17, v20
 v_add_f32 v17, v17, v21
 v_cvt_pk_bf16_f32 v57, v20, v21
 v_sub_f32 v20, v120, v252
 v_sub_f32 v21, v121, v252
 v_exp_f32 v20, v20
 v_exp_f32 v21, v21
 s_nop 0
 v_add_f32 v17, v17, v20
 v_add_f32 v17, v17, v21
 v_cvt_pk_bf16_f32 v58, v20, v21
 v_sub_f32 v20, v122, v252
 v_sub_f32 v21, v123, v252
 v_exp_f32 v20, v20
 v_exp_f32 v21, v21
 s_nop 0
 v_add_f32 v17, v17, v20
 v_add_f32 v17, v17, v21
 v_cvt_pk_bf16_f32 v59, v20, v21
 v_accvgpr_read_b32 v20, a192
 v_accvgpr_read_b32 v21, a193
 v_accvgpr_read_b32 v22, a194
 v_accvgpr_read_b32 v23, a195
 v_accvgpr_read_b32 v24, a196
 v_accvgpr_read_b32 v25, a197
 v_accvgpr_read_b32 v26, a198
 v_accvgpr_read_b32 v27, a199
 v_mul_f32 v20, v20, v254
 v_mul_f32 v21, v21, v254
 v_mul_f32 v22, v22, v254
 v_mul_f32 v23, v23, v254
 v_mul_f32 v24, v24, v254
 v_mul_f32 v25, v25, v254
 v_mul_f32 v26, v26, v254
 v_mul_f32 v27, v27, v254
 v_accvgpr_write_b32 a192, v20
 v_accvgpr_write_b32 a193, v21
 v_accvgpr_write_b32 a194, v22
 v_accvgpr_write_b32 a195, v23
 v_accvgpr_write_b32 a196, v24
 v_accvgpr_write_b32 a197, v25
 v_accvgpr_write_b32 a198, v26
 v_accvgpr_write_b32 a199, v27
 v_accvgpr_read_b32 v20, a200
 v_accvgpr_read_b32 v21, a201
 v_accvgpr_read_b32 v22, a202
 v_accvgpr_read_b32 v23, a203
 v_accvgpr_read_b32 v24, a204
 v_accvgpr_read_b32 v25, a205
 v_accvgpr_read_b32 v26, a206
 v_accvgpr_read_b32 v27, a207
 v_mul_f32 v20, v20, v254
 v_mul_f32 v21, v21, v254
 v_mul_f32 v22, v22, v254
 v_mul_f32 v23, v23, v254
 v_mul_f32 v24, v24, v254
 v_mul_f32 v25, v25, v254
 v_mul_f32 v26, v26, v254
 v_mul_f32 v27, v27, v254
 v_accvgpr_write_b32 a200, v20
 v_accvgpr_write_b32 a201, v21
 v_accvgpr_write_b32 a202, v22
 v_accvgpr_write_b32 a203, v23
 v_accvgpr_write_b32 a204, v24
 v_accvgpr_write_b32 a205, v25
 v_accvgpr_write_b32 a206, v26
 v_accvgpr_write_b32 a207, v27
 v_accvgpr_read_b32 v20, a208
 v_accvgpr_read_b32 v21, a209
 v_accvgpr_read_b32 v22, a210
 v_accvgpr_read_b32 v23, a211
 v_accvgpr_read_b32 v24, a212
 v_accvgpr_read_b32 v25, a213
 v_accvgpr_read_b32 v26, a214
 v_accvgpr_read_b32 v27, a215
 v_mul_f32 v20, v20, v254
 v_mul_f32 v21, v21, v254
 v_mul_f32 v22, v22, v254
 v_mul_f32 v23, v23, v254
 v_mul_f32 v24, v24, v254
 v_mul_f32 v25, v25, v254
 v_mul_f32 v26, v26, v254
 v_mul_f32 v27, v27, v254
 v_accvgpr_write_b32 a208, v20
 v_accvgpr_write_b32 a209, v21
 v_accvgpr_write_b32 a210, v22
 v_accvgpr_write_b32 a211, v23
 v_accvgpr_write_b32 a212, v24
 v_accvgpr_write_b32 a213, v25
 v_accvgpr_write_b32 a214, v26
 v_accvgpr_write_b32 a215, v27
 v_accvgpr_read_b32 v20, a216
 v_accvgpr_read_b32 v21, a217
 v_accvgpr_read_b32 v22, a218
 v_accvgpr_read_b32 v23, a219
 v_accvgpr_read_b32 v24, a220
 v_accvgpr_read_b32 v25, a221
 v_accvgpr_read_b32 v26, a222
 v_accvgpr_read_b32 v27, a223
 v_mul_f32 v20, v20, v254
 v_mul_f32 v21, v21, v254
 v_mul_f32 v22, v22, v254
 v_mul_f32 v23, v23, v254
 v_mul_f32 v24, v24, v254
 v_mul_f32 v25, v25, v254
 v_mul_f32 v26, v26, v254
 v_mul_f32 v27, v27, v254
 v_accvgpr_write_b32 a216, v20
 v_accvgpr_write_b32 a217, v21
 v_accvgpr_write_b32 a218, v22
 v_accvgpr_write_b32 a219, v23
 v_accvgpr_write_b32 a220, v24
 v_accvgpr_write_b32 a221, v25
 v_accvgpr_write_b32 a222, v26
 v_accvgpr_write_b32 a223, v27
 v_accvgpr_read_b32 v20, a224
 v_accvgpr_read_b32 v21, a225
 v_accvgpr_read_b32 v22, a226
 v_accvgpr_read_b32 v23, a227
 v_accvgpr_read_b32 v24, a228
 v_accvgpr_read_b32 v25, a229
 v_accvgpr_read_b32 v26, a230
 v_accvgpr_read_b32 v27, a231
 v_mul_f32 v20, v20, v254
 v_mul_f32 v21, v21, v254
 v_mul_f32 v22, v22, v254
 v_mul_f32 v23, v23, v254
 v_mul_f32 v24, v24, v254
 v_mul_f32 v25, v25, v254
 v_mul_f32 v26, v26, v254
 v_mul_f32 v27, v27, v254
 v_accvgpr_write_b32 a224, v20
 v_accvgpr_write_b32 a225, v21
 v_accvgpr_write_b32 a226, v22
 v_accvgpr_write_b32 a227, v23
 v_accvgpr_write_b32 a228, v24
 v_accvgpr_write_b32 a229, v25
 v_accvgpr_write_b32 a230, v26
 v_accvgpr_write_b32 a231, v27
 v_accvgpr_read_b32 v20, a232
 v_accvgpr_read_b32 v21, a233
 v_accvgpr_read_b32 v22, a234
 v_accvgpr_read_b32 v23, a235
 v_accvgpr_read_b32 v24, a236
 v_accvgpr_read_b32 v25, a237
 v_accvgpr_read_b32 v26, a238
 v_accvgpr_read_b32 v27, a239
 v_mul_f32 v20, v20, v254
 v_mul_f32 v21, v21, v254
 v_mul_f32 v22, v22, v254
 v_mul_f32 v23, v23, v254
 v_mul_f32 v24, v24, v254
 v_mul_f32 v25, v25, v254
 v_mul_f32 v26, v26, v254
 v_mul_f32 v27, v27, v254
 v_accvgpr_write_b32 a232, v20
 v_accvgpr_write_b32 a233, v21
 v_accvgpr_write_b32 a234, v22
 v_accvgpr_write_b32 a235, v23
 v_accvgpr_write_b32 a236, v24
 v_accvgpr_write_b32 a237, v25
 v_accvgpr_write_b32 a238, v26
 v_accvgpr_write_b32 a239, v27
 v_accvgpr_read_b32 v20, a240
 v_accvgpr_read_b32 v21, a241
 v_accvgpr_read_b32 v22, a242
 v_accvgpr_read_b32 v23, a243
 v_accvgpr_read_b32 v24, a244
 v_accvgpr_read_b32 v25, a245
 v_accvgpr_read_b32 v26, a246
 v_accvgpr_read_b32 v27, a247
 v_mul_f32 v20, v20, v254
 v_mul_f32 v21, v21, v254
 v_mul_f32 v22, v22, v254
 v_mul_f32 v23, v23, v254
 v_mul_f32 v24, v24, v254
 v_mul_f32 v25, v25, v254
 v_mul_f32 v26, v26, v254
 v_mul_f32 v27, v27, v254
 v_accvgpr_write_b32 a240, v20
 v_accvgpr_write_b32 a241, v21
 v_accvgpr_write_b32 a242, v22
 v_accvgpr_write_b32 a243, v23
 v_accvgpr_write_b32 a244, v24
 v_accvgpr_write_b32 a245, v25
 v_accvgpr_write_b32 a246, v26
 v_accvgpr_write_b32 a247, v27
 v_accvgpr_read_b32 v20, a248
 v_accvgpr_read_b32 v21, a249
 v_accvgpr_read_b32 v22, a250
 v_accvgpr_read_b32 v23, a251
 v_accvgpr_read_b32 v24, a252
 v_accvgpr_read_b32 v25, a253
 v_accvgpr_read_b32 v26, a254
 v_accvgpr_read_b32 v27, a255
 v_mul_f32 v20, v20, v254
 v_mul_f32 v21, v21, v254
 v_mul_f32 v22, v22, v254
 v_mul_f32 v23, v23, v254
 v_mul_f32 v24, v24, v254
 v_mul_f32 v25, v25, v254
 v_mul_f32 v26, v26, v254
 v_mul_f32 v27, v27, v254
 v_accvgpr_write_b32 a248, v20
 v_accvgpr_write_b32 a249, v21
 v_accvgpr_write_b32 a250, v22
 v_accvgpr_write_b32 a251, v23
 v_accvgpr_write_b32 a252, v24
 v_accvgpr_write_b32 a253, v25
 v_accvgpr_write_b32 a254, v26
 v_accvgpr_write_b32 a255, v27
 s_nop 3
 s_setpc_b64 s[40:41]
L_resc_2:
 s_nop 7
 s_nop 7
 v_max3_f32 v252, v92, v93, v94
 v_max3_f32 v252, v252, v95, v96
 v_max3_f32 v252, v252, v97, v98
 v_max_f32 v252, v252, v99
 v_mov_b32 v253, v252
 s_nop 1
 v_permlane16_swap_b32 v252, v253
 v_max_f32 v252, v252, v253
 v_mov_b32 v253, v252
 s_nop 1
 v_permlane32_swap_b32 v252, v253
 v_max_f32 v252, v252, v253
 v_max_f32 v252, 0, v252
 v_sub_f32 v254, 0, v252
 v_exp_f32 v254, v254
 v_add_f32 v6, v6, v252
 v_mul_f32 v10, v10, v254
 v_sub_f32 v20, v92, v252
 v_sub_f32 v21, v93, v252
 v_exp_f32 v20, v20
 v_exp_f32 v21, v21
 s_nop 0
 v_add_f32 v14, v20, v21
 v_cvt_pk_bf16_f32 v60, v20, v21
 v_sub_f32 v20, v94, v252
 v_sub_f32 v21, v95, v252
 v_exp_f32 v20, v20
 v_exp_f32 v21, v21
 s_nop 0
 v_add_f32 v14, v14, v20
 v_add_f32 v14, v14, v21
 v_cvt_pk_bf16_f32 v61, v20, v21
 v_sub_f32 v20, v96, v252
 v_sub_f32 v21, v97, v252
 v_exp_f32 v20, v20
 v_exp_f32 v21, v21
 s_nop 0
 v_add_f32 v14, v14, v20
 v_add_f32 v14, v14, v21
 v_cvt_pk_bf16_f32 v62, v20, v21
 v_sub_f32 v20, v98, v252
 v_sub_f32 v21, v99, v252
 v_exp_f32 v20, v20
 v_exp_f32 v21, v21
 s_nop 0
 v_add_f32 v14, v14, v20
 v_add_f32 v14, v14, v21
 v_cvt_pk_bf16_f32 v63, v20, v21
 v_mul_f32 v124, v124, v254
 v_mul_f32 v125, v125, v254
 v_mul_f32 v126, v126, v254
 v_mul_f32 v127, v127, v254
 v_mul_f32 v128, v128, v254
 v_mul_f32 v129, v129, v254
 v_mul_f32 v130, v130, v254
 v_mul_f32 v131, v131, v254
 v_mul_f32 v132, v132, v254
 v_mul_f32 v133, v133, v254
 v_mul_f32 v134, v134, v254
 v_mul_f32 v135, v135, v254
 v_mul_f32 v136, v136, v254
 v_mul_f32 v137, v137, v254
 v_mul_f32 v138, v138, v254
 v_mul_f32 v139, v139, v254
 v_mul_f32 v140, v140, v254
 v_mul_f32 v141, v141, v254
 v_mul_f32 v142, v142, v254
 v_mul_f32 v143, v143, v254
 v_mul_f32 v144, v144, v254
 v_mul_f32 v145, v145, v254
 v_mul_f32 v146, v146, v254
 v_mul_f32 v147, v147, v254
 v_mul_f32 v148, v148, v254
 v_mul_f32 v149, v149, v254
 v_mul_f32 v150, v150, v254
 v_mul_f32 v151, v151, v254
 v_mul_f32 v152, v152, v254
 v_mul_f32 v153, v153, v254
 v_mul_f32 v154, v154, v254
 v_mul_f32 v155, v155, v254
 v_mul_f32 v156, v156, v254
 v_mul_f32 v157, v157, v254
 v_mul_f32 v158, v158, v254
 v_mul_f32 v159, v159, v254
 v_mul_f32 v160, v160, v254
 v_mul_f32 v161, v161, v254
 v_mul_f32 v162, v162, v254
 v_mul_f32 v163, v163, v254
 v_mul_f32 v164, v164, v254
 v_mul_f32 v165, v165, v254
 v_mul_f32 v166, v166, v254
 v_mul_f32 v167, v167, v254
 v_mul_f32 v168, v168, v254
 v_mul_f32 v169, v169, v254
 v_mul_f32 v170, v170, v254
 v_mul_f32 v171, v171, v254
 v_mul_f32 v172, v172, v254
 v_mul_f32 v173, v173, v254
 v_mul_f32 v174, v174, v254
 v_mul_f32 v175, v175, v254
 v_mul_f32 v176, v176, v254
 v_mul_f32 v177, v177, v254
 v_mul_f32 v178, v178, v254
 v_mul_f32 v179, v179, v254
 v_mul_f32 v180, v180, v254
 v_mul_f32 v181, v181, v254
 v_mul_f32 v182, v182, v254
 v_mul_f32 v183, v183, v254
 v_mul_f32 v184, v184, v254
 v_mul_f32 v185, v185, v254
 v_mul_f32 v186, v186, v254
 v_mul_f32 v187, v187, v254
 v_max3_f32 v252, v100, v101, v102
 v_max3_f32 v252, v252, v103, v104
 v_max3_f32 v252, v252, v105, v106
 v_max_f32 v252, v252, v107
 v_mov_b32 v253, v252
 s_nop 1
 v_permlane16_swap_b32 v252, v253
 v_max_f32 v252, v252, v253
 v_mov_b32 v253, v252
 s_nop 1
 v_permlane32_swap_b32 v252, v253
 v_max_f32 v252, v252, v253
 v_max_f32 v252, 0, v252
 v_sub_f32 v254, 0, v252
 v_exp_f32 v254, v254
 v_add_f32 v7, v7, v252
 v_mul_f32 v11, v11, v254
 v_sub_f32 v20, v100, v252
 v_sub_f32 v21, v101, v252
 v_exp_f32 v20, v20
 v_exp_f32 v21, v21
 s_nop 0
 v_add_f32 v15, v20, v21
 v_cvt_pk_bf16_f32 v64, v20, v21
 v_sub_f32 v20, v102, v252
 v_sub_f32 v21, v103, v252
 v_exp_f32 v20, v20
 v_exp_f32 v21, v21
 s_nop 0
 v_add_f32 v15, v15, v20
 v_add_f32 v15, v15, v21
 v_cvt_pk_bf16_f32 v65, v20, v21
 v_sub_f32 v20, v104, v252
 v_sub_f32 v21, v105, v252
 v_exp_f32 v20, v20
 v_exp_f32 v21, v21
 s_nop 0
 v_add_f32 v15, v15, v20
 v_add_f32 v15, v15, v21
 v_cvt_pk_bf16_f32 v66, v20, v21
 v_sub_f32 v20, v106, v252
 v_sub_f32 v21, v107, v252
 v_exp_f32 v20, v20
 v_exp_f32 v21, v21
 s_nop 0
 v_add_f32 v15, v15, v20
 v_add_f32 v15, v15, v21
 v_cvt_pk_bf16_f32 v67, v20, v21
 v_mul_f32 v188, v188, v254
 v_mul_f32 v189, v189, v254
 v_mul_f32 v190, v190, v254
 v_mul_f32 v191, v191, v254
 v_mul_f32 v192, v192, v254
 v_mul_f32 v193, v193, v254
 v_mul_f32 v194, v194, v254
 v_mul_f32 v195, v195, v254
 v_mul_f32 v196, v196, v254
 v_mul_f32 v197, v197, v254
 v_mul_f32 v198, v198, v254
 v_mul_f32 v199, v199, v254
 v_mul_f32 v200, v200, v254
 v_mul_f32 v201, v201, v254
 v_mul_f32 v202, v202, v254
 v_mul_f32 v203, v203, v254
 v_mul_f32 v204, v204, v254
 v_mul_f32 v205, v205, v254
 v_mul_f32 v206, v206, v254
 v_mul_f32 v207, v207, v254
 v_mul_f32 v208, v208, v254
 v_mul_f32 v209, v209, v254
 v_mul_f32 v210, v210, v254
 v_mul_f32 v211, v211, v254
 v_mul_f32 v212, v212, v254
 v_mul_f32 v213, v213, v254
 v_mul_f32 v214, v214, v254
 v_mul_f32 v215, v215, v254
 v_mul_f32 v216, v216, v254
 v_mul_f32 v217, v217, v254
 v_mul_f32 v218, v218, v254
 v_mul_f32 v219, v219, v254
 v_mul_f32 v220, v220, v254
 v_mul_f32 v221, v221, v254
 v_mul_f32 v222, v222, v254
 v_mul_f32 v223, v223, v254
 v_mul_f32 v224, v224, v254
 v_mul_f32 v225, v225, v254
 v_mul_f32 v226, v226, v254
 v_mul_f32 v227, v227, v254
 v_mul_f32 v228, v228, v254
 v_mul_f32 v229, v229, v254
 v_mul_f32 v230, v230, v254
 v_mul_f32 v231, v231, v254
 v_mul_f32 v232, v232, v254
 v_mul_f32 v233, v233, v254
 v_mul_f32 v234, v234, v254
 v_mul_f32 v235, v235, v254
 v_mul_f32 v236, v236, v254
 v_mul_f32 v237, v237, v254
 v_mul_f32 v238, v238, v254
 v_mul_f32 v239, v239, v254
 v_mul_f32 v240, v240, v254
 v_mul_f32 v241, v241, v254
 v_mul_f32 v242, v242, v254
 v_mul_f32 v243, v243, v254
 v_mul_f32 v244, v244, v254
 v_mul_f32 v245, v245, v254
 v_mul_f32 v246, v246, v254
 v_mul_f32 v247, v247, v254
 v_mul_f32 v248, v248, v254
 v_mul_f32 v249, v249, v254
 v_mul_f32 v250, v250, v254
 v_mul_f32 v251, v251, v254
 v_max3_f32 v252, v108, v109, v110
 v_max3_f32 v252, v252, v111, v112
 v_max3_f32 v252, v252, v113, v114
 v_max_f32 v252, v252, v115
 v_mov_b32 v253, v252
 s_nop 1
 v_permlane16_swap_b32 v252, v253
 v_max_f32 v252, v252, v253
 v_mov_b32 v253, v252
 s_nop 1
 v_permlane32_swap_b32 v252, v253
 v_max_f32 v252, v252, v253
 v_max_f32 v252, 0, v252
 v_sub_f32 v254, 0, v252
 v_exp_f32 v254, v254
 v_add_f32 v8, v8, v252
 v_mul_f32 v12, v12, v254
 v_sub_f32 v20, v108, v252
 v_sub_f32 v21, v109, v252
 v_exp_f32 v20, v20
 v_exp_f32 v21, v21
 s_nop 0
 v_add_f32 v16, v20, v21
 v_cvt_pk_bf16_f32 v68, v20, v21
 v_sub_f32 v20, v110, v252
 v_sub_f32 v21, v111, v252
 v_exp_f32 v20, v20
 v_exp_f32 v21, v21
 s_nop 0
 v_add_f32 v16, v16, v20
 v_add_f32 v16, v16, v21
 v_cvt_pk_bf16_f32 v69, v20, v21
 v_sub_f32 v20, v112, v252
 v_sub_f32 v21, v113, v252
 v_exp_f32 v20, v20
 v_exp_f32 v21, v21
 s_nop 0
 v_add_f32 v16, v16, v20
 v_add_f32 v16, v16, v21
 v_cvt_pk_bf16_f32 v70, v20, v21
 v_sub_f32 v20, v114, v252
 v_sub_f32 v21, v115, v252
 v_exp_f32 v20, v20
 v_exp_f32 v21, v21
 s_nop 0
 v_add_f32 v16, v16, v20
 v_add_f32 v16, v16, v21
 v_cvt_pk_bf16_f32 v71, v20, v21
 v_accvgpr_read_b32 v20, a128
 v_accvgpr_read_b32 v21, a129
 v_accvgpr_read_b32 v22, a130
 v_accvgpr_read_b32 v23, a131
 v_accvgpr_read_b32 v24, a132
 v_accvgpr_read_b32 v25, a133
 v_accvgpr_read_b32 v26, a134
 v_accvgpr_read_b32 v27, a135
 v_mul_f32 v20, v20, v254
 v_mul_f32 v21, v21, v254
 v_mul_f32 v22, v22, v254
 v_mul_f32 v23, v23, v254
 v_mul_f32 v24, v24, v254
 v_mul_f32 v25, v25, v254
 v_mul_f32 v26, v26, v254
 v_mul_f32 v27, v27, v254
 v_accvgpr_write_b32 a128, v20
 v_accvgpr_write_b32 a129, v21
 v_accvgpr_write_b32 a130, v22
 v_accvgpr_write_b32 a131, v23
 v_accvgpr_write_b32 a132, v24
 v_accvgpr_write_b32 a133, v25
 v_accvgpr_write_b32 a134, v26
 v_accvgpr_write_b32 a135, v27
 v_accvgpr_read_b32 v20, a136
 v_accvgpr_read_b32 v21, a137
 v_accvgpr_read_b32 v22, a138
 v_accvgpr_read_b32 v23, a139
 v_accvgpr_read_b32 v24, a140
 v_accvgpr_read_b32 v25, a141
 v_accvgpr_read_b32 v26, a142
 v_accvgpr_read_b32 v27, a143
 v_mul_f32 v20, v20, v254
 v_mul_f32 v21, v21, v254
 v_mul_f32 v22, v22, v254
 v_mul_f32 v23, v23, v254
 v_mul_f32 v24, v24, v254
 v_mul_f32 v25, v25, v254
 v_mul_f32 v26, v26, v254
 v_mul_f32 v27, v27, v254
 v_accvgpr_write_b32 a136, v20
 v_accvgpr_write_b32 a137, v21
 v_accvgpr_write_b32 a138, v22
 v_accvgpr_write_b32 a139, v23
 v_accvgpr_write_b32 a140, v24
 v_accvgpr_write_b32 a141, v25
 v_accvgpr_write_b32 a142, v26
 v_accvgpr_write_b32 a143, v27
 v_accvgpr_read_b32 v20, a144
 v_accvgpr_read_b32 v21, a145
 v_accvgpr_read_b32 v22, a146
 v_accvgpr_read_b32 v23, a147
 v_accvgpr_read_b32 v24, a148
 v_accvgpr_read_b32 v25, a149
 v_accvgpr_read_b32 v26, a150
 v_accvgpr_read_b32 v27, a151
 v_mul_f32 v20, v20, v254
 v_mul_f32 v21, v21, v254
 v_mul_f32 v22, v22, v254
 v_mul_f32 v23, v23, v254
 v_mul_f32 v24, v24, v254
 v_mul_f32 v25, v25, v254
 v_mul_f32 v26, v26, v254
 v_mul_f32 v27, v27, v254
 v_accvgpr_write_b32 a144, v20
 v_accvgpr_write_b32 a145, v21
 v_accvgpr_write_b32 a146, v22
 v_accvgpr_write_b32 a147, v23
 v_accvgpr_write_b32 a148, v24
 v_accvgpr_write_b32 a149, v25
 v_accvgpr_write_b32 a150, v26
 v_accvgpr_write_b32 a151, v27
 v_accvgpr_read_b32 v20, a152
 v_accvgpr_read_b32 v21, a153
 v_accvgpr_read_b32 v22, a154
 v_accvgpr_read_b32 v23, a155
 v_accvgpr_read_b32 v24, a156
 v_accvgpr_read_b32 v25, a157
 v_accvgpr_read_b32 v26, a158
 v_accvgpr_read_b32 v27, a159
 v_mul_f32 v20, v20, v254
 v_mul_f32 v21, v21, v254
 v_mul_f32 v22, v22, v254
 v_mul_f32 v23, v23, v254
 v_mul_f32 v24, v24, v254
 v_mul_f32 v25, v25, v254
 v_mul_f32 v26, v26, v254
 v_mul_f32 v27, v27, v254
 v_accvgpr_write_b32 a152, v20
 v_accvgpr_write_b32 a153, v21
 v_accvgpr_write_b32 a154, v22
 v_accvgpr_write_b32 a155, v23
 v_accvgpr_write_b32 a156, v24
 v_accvgpr_write_b32 a157, v25
 v_accvgpr_write_b32 a158, v26
 v_accvgpr_write_b32 a159, v27
 v_accvgpr_read_b32 v20, a160
 v_accvgpr_read_b32 v21, a161
 v_accvgpr_read_b32 v22, a162
 v_accvgpr_read_b32 v23, a163
 v_accvgpr_read_b32 v24, a164
 v_accvgpr_read_b32 v25, a165
 v_accvgpr_read_b32 v26, a166
 v_accvgpr_read_b32 v27, a167
 v_mul_f32 v20, v20, v254
 v_mul_f32 v21, v21, v254
 v_mul_f32 v22, v22, v254
 v_mul_f32 v23, v23, v254
 v_mul_f32 v24, v24, v254
 v_mul_f32 v25, v25, v254
 v_mul_f32 v26, v26, v254
 v_mul_f32 v27, v27, v254
 v_accvgpr_write_b32 a160, v20
 v_accvgpr_write_b32 a161, v21
 v_accvgpr_write_b32 a162, v22
 v_accvgpr_write_b32 a163, v23
 v_accvgpr_write_b32 a164, v24
 v_accvgpr_write_b32 a165, v25
 v_accvgpr_write_b32 a166, v26
 v_accvgpr_write_b32 a167, v27
 v_accvgpr_read_b32 v20, a168
 v_accvgpr_read_b32 v21, a169
 v_accvgpr_read_b32 v22, a170
 v_accvgpr_read_b32 v23, a171
 v_accvgpr_read_b32 v24, a172
 v_accvgpr_read_b32 v25, a173
 v_accvgpr_read_b32 v26, a174
 v_accvgpr_read_b32 v27, a175
 v_mul_f32 v20, v20, v254
 v_mul_f32 v21, v21, v254
 v_mul_f32 v22, v22, v254
 v_mul_f32 v23, v23, v254
 v_mul_f32 v24, v24, v254
 v_mul_f32 v25, v25, v254
 v_mul_f32 v26, v26, v254
 v_mul_f32 v27, v27, v254
 v_accvgpr_write_b32 a168, v20
 v_accvgpr_write_b32 a169, v21
 v_accvgpr_write_b32 a170, v22
 v_accvgpr_write_b32 a171, v23
 v_accvgpr_write_b32 a172, v24
 v_accvgpr_write_b32 a173, v25
 v_accvgpr_write_b32 a174, v26
 v_accvgpr_write_b32 a175, v27
 v_accvgpr_read_b32 v20, a176
 v_accvgpr_read_b32 v21, a177
 v_accvgpr_read_b32 v22, a178
 v_accvgpr_read_b32 v23, a179
 v_accvgpr_read_b32 v24, a180
 v_accvgpr_read_b32 v25, a181
 v_accvgpr_read_b32 v26, a182
 v_accvgpr_read_b32 v27, a183
 v_mul_f32 v20, v20, v254
 v_mul_f32 v21, v21, v254
 v_mul_f32 v22, v22, v254
 v_mul_f32 v23, v23, v254
 v_mul_f32 v24, v24, v254
 v_mul_f32 v25, v25, v254
 v_mul_f32 v26, v26, v254
 v_mul_f32 v27, v27, v254
 v_accvgpr_write_b32 a176, v20
 v_accvgpr_write_b32 a177, v21
 v_accvgpr_write_b32 a178, v22
 v_accvgpr_write_b32 a179, v23
 v_accvgpr_write_b32 a180, v24
 v_accvgpr_write_b32 a181, v25
 v_accvgpr_write_b32 a182, v26
 v_accvgpr_write_b32 a183, v27
 v_accvgpr_read_b32 v20, a184
 v_accvgpr_read_b32 v21, a185
 v_accvgpr_read_b32 v22, a186
 v_accvgpr_read_b32 v23, a187
 v_accvgpr_read_b32 v24, a188
 v_accvgpr_read_b32 v25, a189
 v_accvgpr_read_b32 v26, a190
 v_accvgpr_read_b32 v27, a191
 v_mul_f32 v20, v20, v254
 v_mul_f32 v21, v21, v254
 v_mul_f32 v22, v22, v254
 v_mul_f32 v23, v23, v254
 v_mul_f32 v24, v24, v254
 v_mul_f32 v25, v25, v254
 v_mul_f32 v26, v26, v254
 v_mul_f32 v27, v27, v254
 v_accvgpr_write_b32 a184, v20
 v_accvgpr_write_b32 a185, v21
 v_accvgpr_write_b32 a186, v22
 v_accvgpr_write_b32 a187, v23
 v_accvgpr_write_b32 a188, v24
 v_accvgpr_write_b32 a189, v25
 v_accvgpr_write_b32 a190, v26
 v_accvgpr_write_b32 a191, v27
 v_max3_f32 v252, v116, v117, v118
 v_max3_f32 v252, v252, v119, v120
 v_max3_f32 v252, v252, v121, v122
 v_max_f32 v252, v252, v123
 v_mov_b32 v253, v252
 s_nop 1
 v_permlane16_swap_b32 v252, v253
 v_max_f32 v252, v252, v253
 v_mov_b32 v253, v252
 s_nop 1
 v_permlane32_swap_b32 v252, v253
 v_max_f32 v252, v252, v253
 v_max_f32 v252, 0, v252
 v_sub_f32 v254, 0, v252
 v_exp_f32 v254, v254
 v_add_f32 v9, v9, v252
 v_mul_f32 v13, v13, v254
 v_sub_f32 v20, v116, v252
 v_sub_f32 v21, v117, v252
 v_exp_f32 v20, v20
 v_exp_f32 v21, v21
 s_nop 0
 v_add_f32 v17, v20, v21
 v_cvt_pk_bf16_f32 v72, v20, v21
 v_sub_f32 v20, v118, v252
 v_sub_f32 v21, v119, v252
 v_exp_f32 v20, v20
 v_exp_f32 v21, v21
 s_nop 0
 v_add_f32 v17, v17, v20
 v_add_f32 v17, v17, v21
 v_cvt_pk_bf16_f32 v73, v20, v21
 v_sub_f32 v20, v120, v252
 v_sub_f32 v21, v121, v252
 v_exp_f32 v20, v20
 v_exp_f32 v21, v21
 s_nop 0
 v_add_f32 v17, v17, v20
 v_add_f32 v17, v17, v21
 v_cvt_pk_bf16_f32 v74, v20, v21
 v_sub_f32 v20, v122, v252
 v_sub_f32 v21, v123, v252
 v_exp_f32 v20, v20
 v_exp_f32 v21, v21
 s_nop 0
 v_add_f32 v17, v17, v20
 v_add_f32 v17, v17, v21
 v_cvt_pk_bf16_f32 v75, v20, v21
 v_accvgpr_read_b32 v20, a192
 v_accvgpr_read_b32 v21, a193
 v_accvgpr_read_b32 v22, a194
 v_accvgpr_read_b32 v23, a195
 v_accvgpr_read_b32 v24, a196
 v_accvgpr_read_b32 v25, a197
 v_accvgpr_read_b32 v26, a198
 v_accvgpr_read_b32 v27, a199
 v_mul_f32 v20, v20, v254
 v_mul_f32 v21, v21, v254
 v_mul_f32 v22, v22, v254
 v_mul_f32 v23, v23, v254
 v_mul_f32 v24, v24, v254
 v_mul_f32 v25, v25, v254
 v_mul_f32 v26, v26, v254
 v_mul_f32 v27, v27, v254
 v_accvgpr_write_b32 a192, v20
 v_accvgpr_write_b32 a193, v21
 v_accvgpr_write_b32 a194, v22
 v_accvgpr_write_b32 a195, v23
 v_accvgpr_write_b32 a196, v24
 v_accvgpr_write_b32 a197, v25
 v_accvgpr_write_b32 a198, v26
 v_accvgpr_write_b32 a199, v27
 v_accvgpr_read_b32 v20, a200
 v_accvgpr_read_b32 v21, a201
 v_accvgpr_read_b32 v22, a202
 v_accvgpr_read_b32 v23, a203
 v_accvgpr_read_b32 v24, a204
 v_accvgpr_read_b32 v25, a205
 v_accvgpr_read_b32 v26, a206
 v_accvgpr_read_b32 v27, a207
 v_mul_f32 v20, v20, v254
 v_mul_f32 v21, v21, v254
 v_mul_f32 v22, v22, v254
 v_mul_f32 v23, v23, v254
 v_mul_f32 v24, v24, v254
 v_mul_f32 v25, v25, v254
 v_mul_f32 v26, v26, v254
 v_mul_f32 v27, v27, v254
 v_accvgpr_write_b32 a200, v20
 v_accvgpr_write_b32 a201, v21
 v_accvgpr_write_b32 a202, v22
 v_accvgpr_write_b32 a203, v23
 v_accvgpr_write_b32 a204, v24
 v_accvgpr_write_b32 a205, v25
 v_accvgpr_write_b32 a206, v26
 v_accvgpr_write_b32 a207, v27
 v_accvgpr_read_b32 v20, a208
 v_accvgpr_read_b32 v21, a209
 v_accvgpr_read_b32 v22, a210
 v_accvgpr_read_b32 v23, a211
 v_accvgpr_read_b32 v24, a212
 v_accvgpr_read_b32 v25, a213
 v_accvgpr_read_b32 v26, a214
 v_accvgpr_read_b32 v27, a215
 v_mul_f32 v20, v20, v254
 v_mul_f32 v21, v21, v254
 v_mul_f32 v22, v22, v254
 v_mul_f32 v23, v23, v254
 v_mul_f32 v24, v24, v254
 v_mul_f32 v25, v25, v254
 v_mul_f32 v26, v26, v254
 v_mul_f32 v27, v27, v254
 v_accvgpr_write_b32 a208, v20
 v_accvgpr_write_b32 a209, v21
 v_accvgpr_write_b32 a210, v22
 v_accvgpr_write_b32 a211, v23
 v_accvgpr_write_b32 a212, v24
 v_accvgpr_write_b32 a213, v25
 v_accvgpr_write_b32 a214, v26
 v_accvgpr_write_b32 a215, v27
 v_accvgpr_read_b32 v20, a216
 v_accvgpr_read_b32 v21, a217
 v_accvgpr_read_b32 v22, a218
 v_accvgpr_read_b32 v23, a219
 v_accvgpr_read_b32 v24, a220
 v_accvgpr_read_b32 v25, a221
 v_accvgpr_read_b32 v26, a222
 v_accvgpr_read_b32 v27, a223
 v_mul_f32 v20, v20, v254
 v_mul_f32 v21, v21, v254
 v_mul_f32 v22, v22, v254
 v_mul_f32 v23, v23, v254
 v_mul_f32 v24, v24, v254
 v_mul_f32 v25, v25, v254
 v_mul_f32 v26, v26, v254
 v_mul_f32 v27, v27, v254
 v_accvgpr_write_b32 a216, v20
 v_accvgpr_write_b32 a217, v21
 v_accvgpr_write_b32 a218, v22
 v_accvgpr_write_b32 a219, v23
 v_accvgpr_write_b32 a220, v24
 v_accvgpr_write_b32 a221, v25
 v_accvgpr_write_b32 a222, v26
 v_accvgpr_write_b32 a223, v27
 v_accvgpr_read_b32 v20, a224
 v_accvgpr_read_b32 v21, a225
 v_accvgpr_read_b32 v22, a226
 v_accvgpr_read_b32 v23, a227
 v_accvgpr_read_b32 v24, a228
 v_accvgpr_read_b32 v25, a229
 v_accvgpr_read_b32 v26, a230
 v_accvgpr_read_b32 v27, a231
 v_mul_f32 v20, v20, v254
 v_mul_f32 v21, v21, v254
 v_mul_f32 v22, v22, v254
 v_mul_f32 v23, v23, v254
 v_mul_f32 v24, v24, v254
 v_mul_f32 v25, v25, v254
 v_mul_f32 v26, v26, v254
 v_mul_f32 v27, v27, v254
 v_accvgpr_write_b32 a224, v20
 v_accvgpr_write_b32 a225, v21
 v_accvgpr_write_b32 a226, v22
 v_accvgpr_write_b32 a227, v23
 v_accvgpr_write_b32 a228, v24
 v_accvgpr_write_b32 a229, v25
 v_accvgpr_write_b32 a230, v26
 v_accvgpr_write_b32 a231, v27
 v_accvgpr_read_b32 v20, a232
 v_accvgpr_read_b32 v21, a233
 v_accvgpr_read_b32 v22, a234
 v_accvgpr_read_b32 v23, a235
 v_accvgpr_read_b32 v24, a236
 v_accvgpr_read_b32 v25, a237
 v_accvgpr_read_b32 v26, a238
 v_accvgpr_read_b32 v27, a239
 v_mul_f32 v20, v20, v254
 v_mul_f32 v21, v21, v254
 v_mul_f32 v22, v22, v254
 v_mul_f32 v23, v23, v254
 v_mul_f32 v24, v24, v254
 v_mul_f32 v25, v25, v254
 v_mul_f32 v26, v26, v254
 v_mul_f32 v27, v27, v254
 v_accvgpr_write_b32 a232, v20
 v_accvgpr_write_b32 a233, v21
 v_accvgpr_write_b32 a234, v22
 v_accvgpr_write_b32 a235, v23
 v_accvgpr_write_b32 a236, v24
 v_accvgpr_write_b32 a237, v25
 v_accvgpr_write_b32 a238, v26
 v_accvgpr_write_b32 a239, v27
 v_accvgpr_read_b32 v20, a240
 v_accvgpr_read_b32 v21, a241
 v_accvgpr_read_b32 v22, a242
 v_accvgpr_read_b32 v23, a243
 v_accvgpr_read_b32 v24, a244
 v_accvgpr_read_b32 v25, a245
 v_accvgpr_read_b32 v26, a246
 v_accvgpr_read_b32 v27, a247
 v_mul_f32 v20, v20, v254
 v_mul_f32 v21, v21, v254
 v_mul_f32 v22, v22, v254
 v_mul_f32 v23, v23, v254
 v_mul_f32 v24, v24, v254
 v_mul_f32 v25, v25, v254
 v_mul_f32 v26, v26, v254
 v_mul_f32 v27, v27, v254
 v_accvgpr_write_b32 a240, v20
 v_accvgpr_write_b32 a241, v21
 v_accvgpr_write_b32 a242, v22
 v_accvgpr_write_b32 a243, v23
 v_accvgpr_write_b32 a244, v24
 v_accvgpr_write_b32 a245, v25
 v_accvgpr_write_b32 a246, v26
 v_accvgpr_write_b32 a247, v27
 v_accvgpr_read_b32 v20, a248
 v_accvgpr_read_b32 v21, a249
 v_accvgpr_read_b32 v22, a250
 v_accvgpr_read_b32 v23, a251
 v_accvgpr_read_b32 v24, a252
 v_accvgpr_read_b32 v25, a253
 v_accvgpr_read_b32 v26, a254
 v_accvgpr_read_b32 v27, a255
 v_mul_f32 v20, v20, v254
 v_mul_f32 v21, v21, v254
 v_mul_f32 v22, v22, v254
 v_mul_f32 v23, v23, v254
 v_mul_f32 v24, v24, v254
 v_mul_f32 v25, v25, v254
 v_mul_f32 v26, v26, v254
 v_mul_f32 v27, v27, v254
 v_accvgpr_write_b32 a248, v20
 v_accvgpr_write_b32 a249, v21
 v_accvgpr_write_b32 a250, v22
 v_accvgpr_write_b32 a251, v23
 v_accvgpr_write_b32 a252, v24
 v_accvgpr_write_b32 a253, v25
 v_accvgpr_write_b32 a254, v26
 v_accvgpr_write_b32 a255, v27
 s_nop 3
 s_setpc_b64 s[40:41]

.section .rodata,"a"
.p2align 6
.amdhsa_kernel standalone__mha_softmax__near_ridge_kernel
  .amdhsa_next_free_vgpr 512
  .amdhsa_next_free_sgpr 96
  .amdhsa_accum_offset 256
  .amdhsa_group_segment_fixed_size 0
  .amdhsa_kernarg_size 48
  .amdhsa_user_sgpr_count 2
  .amdhsa_user_sgpr_kernarg_segment_ptr 1
  .amdhsa_system_sgpr_workgroup_id_x 1
.end_amdhsa_kernel
```
